```python
import torch

def _softmax(x, axis=-1):
    return torch.softmax(x, dim=axis)
def _gelu(x):
    return torch.nn.functional.gelu(x, approximate="tanh")
def _silu(x):
    return torch.nn.functional.silu(x)
def _sigmoid(x):
    return torch.sigmoid(x)
def _layernorm(x, axis=-1, eps=1e-5):
    m = x.mean(dim=axis, keepdim=True)
    v = x.var(dim=axis, keepdim=True, unbiased=False)
    return (x - m) / torch.sqrt(v + eps)
def _scatter_add(tgt, idx, src, axis=0):
    return tgt.clone().index_add_(axis, idx, src)
def _segment_sum(src, seg, n):
    out = torch.zeros((n,) + src.shape[1:], dtype=src.dtype)
    return out.index_add_(0, seg, src)
def _pad(x, pw):
    flat = tuple(v for pair in reversed(pw) for v in pair)
    return torch.nn.functional.pad(x, flat)

kernel_name = 'concat_heads__mha_block_cached__gqa_block_cached__near_ridge'

def setup_inputs():

    _w = (lambda a: (lambda t: t.to(torch.bfloat16) if t.is_floating_point() else t)(torch.as_tensor(a)))
    def _A_setup():
        B, Sq, D = 8, 224, 512
        H, Sk, Dh = 32, 1024, 128
        return {
            "x": _w((lambda *s: torch.randn(*s, dtype=torch.bfloat16) * 0.8)(B, Sq, D)),
            "k_cache": _w((lambda *s: torch.randn(*s, dtype=torch.bfloat16) * 0.8)(B, H, Sk, Dh)),
            "v_cache": _w((lambda *s: torch.randn(*s, dtype=torch.bfloat16) * 0.05)(B, H, Sk, Dh)),
            "wq": _w((lambda *s: torch.randn(*s, dtype=torch.bfloat16) * 0.8)(D, H * Dh) * (D ** -0.5)),
            "wo": _w((lambda *s: torch.randn(*s, dtype=torch.bfloat16) * 0.05)(H * Dh, D) * ((H * Dh) ** -0.5)),
        }
    _A_in = _A_setup()

    def _B_setup():
        B, Sq, D = 8, 224, 512
        Hq, Hkv, Sk, Dh = 32, 32, 1024, 128
        assert Hq % Hkv == 0, (Hq, Hkv)
        return {
            "x": _w((lambda *s: torch.randn(*s, dtype=torch.bfloat16) * 0.8)(B, Sq, D)),
            "k_cache": _w((lambda *s: torch.randn(*s, dtype=torch.bfloat16) * 0.8)(B, Hkv, Sk, Dh)),
            "v_cache": _w((lambda *s: torch.randn(*s, dtype=torch.bfloat16) * 0.05)(B, Hkv, Sk, Dh)),
            "wq": _w((lambda *s: torch.randn(*s, dtype=torch.bfloat16) * 0.8)(D, Hq * Dh) * (D ** -0.5)),
            "wo": _w((lambda *s: torch.randn(*s, dtype=torch.bfloat16) * 0.05)(Hq * Dh, D) * ((Hq * Dh) ** -0.5)),
        }
    _B_in = _B_setup()

    return {
        "A_x": _A_in["x"],
        "A_k_cache": _A_in["k_cache"],
        "A_v_cache": _A_in["v_cache"],
        "A_wq": _A_in["wq"],
        "A_wo": _A_in["wo"],
        "B_x": _B_in["x"],
        "B_k_cache": _B_in["k_cache"],
        "B_v_cache": _B_in["v_cache"],
        "B_wq": _B_in["wq"],
        "B_wo": _B_in["wo"],
    }

def reference(A_x, A_k_cache, A_v_cache, A_wq, A_wo, B_x, B_k_cache, B_v_cache, B_wq, B_wo):
    def _A_ref(x, k_cache, v_cache, wq, wo):
        B, Sq, D = x.shape
        H, Dh = 32, 128
        q = (lambda x, *d: x.permute(*d))((x @ wq).reshape(B, Sq, H, Dh), 0, 2, 1, 3)
        scores = torch.einsum("bhqd,bhkd->bhqk", q, k_cache) * (Dh ** -0.5)
        p = _softmax(scores, axis=-1)
        o = torch.einsum("bhqk,bhkd->bhqd", p, v_cache)
        return (lambda x, *d: x.permute(*d))(o, 0, 2, 1, 3).reshape(B, Sq, H * Dh) @ wo

    def _B_ref(x, k_cache, v_cache, wq, wo):
        B, Sq, D = x.shape
        Hq, Dh = 32, 128
        Hkv = k_cache.shape[1]
        rep = Hq // Hkv
        q = (lambda x, *d: x.permute(*d))((x @ wq).reshape(B, Sq, Hq, Dh), 0, 2, 1, 3)
        k = (lambda x, n, axis: torch.repeat_interleave(x, n, dim=axis))(k_cache, rep, axis=1)
        v = (lambda x, n, axis: torch.repeat_interleave(x, n, dim=axis))(v_cache, rep, axis=1)
        scores = torch.einsum("bhqd,bhkd->bhqk", q, k) * (Dh ** -0.5)
        p = _softmax(scores, axis=-1)
        o = torch.einsum("bhqk,bhkd->bhqd", p, v)
        return (lambda x, *d: x.permute(*d))(o, 0, 2, 1, 3).reshape(B, Sq, Hq * Dh) @ wo

    a = _A_ref(A_x, A_k_cache, A_v_cache, A_wq, A_wo)
    b = _B_ref(B_x, B_k_cache, B_v_cache, B_wq, B_wo)
    return torch.concatenate([a, b], axis=-1)
```

```asm
; @launch kernel=attn_kernel grid=(256,1,1) block=(512,1,1) lds=163840
; @launch kernel=oproj_kernel grid=(224,1,1) block=(256,1,1) lds=131072
.amdgcn_target "amdgcn-amd-amdhsa--gfx950"
.text
.globl attn_kernel
.p2align 8
.type attn_kernel,@function
attn_kernel:
s_cmp_ge_u32 s2, 256
s_cbranch_scc1 K1_EXIT
s_load_dwordx8 s[32:39], s[0:1], 0
s_load_dwordx8 s[40:47], s[0:1], 40
s_load_dwordx2 s[48:49], s[0:1], 96
v_and_b32 v245, 63, v0
v_lshrrev_b32 v1, 6, v0
s_nop 0
v_readfirstlane_b32 s5, v1
s_and_b32 s28, s2, 7
s_lshr_b32 s29, s2, 3
s_and_b32 s6, s28, 1
s_lshl_b32 s6, s6, 2
s_and_b32 s7, s29, 3
s_add_u32 s6, s6, s7
s_lshr_b32 s7, s28, 1
s_lshl_b32 s7, s7, 3
s_lshr_b32 s29, s29, 2
s_add_u32 s7, s7, s29
s_mov_b32 s4, 0
s_mov_b32 s57, 0x41000000
s_mov_b32 s58, 4096
s_mov_b32 s59, 0x3e0293ee
s_waitcnt lgkmcnt(0)
s_cmp_eq_u32 s5, 7
s_cbranch_scc1 LOADER
s_lshl_b32 s30, s5, 12
s_add_u32 s31, s30, 131072
s_add_u32 s30, s30, 32768
s_lshl_b32 s55, s5, 15
v_lshrrev_b32 v1, 4, v245
v_and_b32 v2, 7, v245
v_lshrrev_b32 v4, 3, v245
v_add_u32 v3, 0, v1
v_xor_b32 v3, v3, v2
v_lshlrev_b32 v3, 4, v3
v_lshl_add_u32 v236, v4, 10, v3
v_add_u32 v3, 4, v1
v_xor_b32 v3, v3, v2
v_lshlrev_b32 v3, 4, v3
v_lshl_add_u32 v237, v4, 10, v3
s_mul_i32 s28, s6, 229376
s_add_u32 s20, s32, s28
s_addc_u32 s21, s33, 0
s_mov_b32 s22, 229376
s_mov_b32 s23, 0x20000
s_add_u32 m0, s30, 0
s_add_u32 s52, s55, 0
buffer_load_dwordx4 v236, s[20:23], s52 offen lds
s_add_u32 m0, s30, 1024
s_add_u32 s52, s55, 8192
buffer_load_dwordx4 v237, s[20:23], s52 offen lds
s_add_u32 m0, s30, 2048
s_add_u32 s52, s55, 16384
buffer_load_dwordx4 v236, s[20:23], s52 offen lds
s_add_u32 m0, s30, 3072
s_add_u32 s52, s55, 24576
buffer_load_dwordx4 v237, s[20:23], s52 offen lds
s_add_u32 m0, s31, 0
s_add_u32 s52, s55, 128
buffer_load_dwordx4 v236, s[20:23], s52 offen lds
s_add_u32 m0, s31, 1024
s_add_u32 s52, s55, 8320
buffer_load_dwordx4 v237, s[20:23], s52 offen lds
s_add_u32 m0, s31, 2048
s_add_u32 s52, s55, 16512
buffer_load_dwordx4 v236, s[20:23], s52 offen lds
s_add_u32 m0, s31, 3072
s_add_u32 s52, s55, 24704
buffer_load_dwordx4 v237, s[20:23], s52 offen lds
v_and_b32 v1, 31, v245
v_lshrrev_b32 v2, 5, v245
v_and_b32 v3, 15, v245
v_xor_b32 v3, v3, v2
v_lshlrev_b32 v3, 4, v3
v_lshl_add_u32 v3, v1, 8, v3
v_xor_b32 v224, 0, v3
v_xor_b32 v225, 32, v3
v_xor_b32 v226, 64, v3
v_xor_b32 v227, 96, v3
v_xor_b32 v228, 128, v3
v_xor_b32 v229, 160, v3
v_xor_b32 v230, 192, v3
v_xor_b32 v231, 224, v3
v_bfe_u32 v3, v245, 2, 2
v_and_b32 v4, 3, v245
v_bfe_u32 v5, v245, 4, 1
v_lshrrev_b32 v2, 5, v245
v_lshl_add_u32 v6, v2, 2, v3
v_lshlrev_b32 v6, 8, v6
v_lshl_add_u32 v6, v5, 5, v6
v_lshl_add_u32 v6, v4, 3, v6
v_add_u32 v6, 65536, v6
v_xor_b32 v7, 0, v3
v_lshl_add_u32 v232, v7, 6, v6
v_xor_b32 v7, 1, v3
v_lshl_add_u32 v233, v7, 6, v6
v_xor_b32 v7, 2, v3
v_lshl_add_u32 v234, v7, 6, v6
v_xor_b32 v7, 3, v3
v_lshl_add_u32 v235, v7, 6, v6
ROUND:
v_bfe_u32 v3, v245, 2, 2
v_and_b32 v4, 3, v245
v_bfe_u32 v5, v245, 4, 1
v_lshrrev_b32 v2, 5, v245
v_lshlrev_b32 v6, 1, v4
v_and_b32 v6, 2, v6
v_lshrrev_b32 v4, 1, v4
v_or_b32 v4, v4, v6
v_lshl_add_u32 v6, v2, 3, v3
v_lshlrev_b32 v6, 8, v6
v_lshl_add_u32 v6, v5, 5, v6
v_lshl_add_u32 v6, v4, 3, v6
v_add_u32 v6, 65536, v6
v_xor_b32 v7, 0, v3
v_lshl_add_u32 v96, v7, 6, v6
v_xor_b32 v7, 1, v3
v_lshl_add_u32 v97, v7, 6, v6
v_xor_b32 v7, 2, v3
v_lshl_add_u32 v98, v7, 6, v6
v_xor_b32 v7, 3, v3
v_lshl_add_u32 v99, v7, 6, v6
v_and_b32 v1, 31, v245
v_lshrrev_b32 v2, 5, v245
v_bfe_u32 v3, v245, 1, 3
v_add_u32 v4, 0, v2
v_xor_b32 v4, v4, v3
v_lshlrev_b32 v4, 4, v4
v_lshl_add_u32 v4, v1, 7, v4
v_add_u32 v100, s30, v4
v_add_u32 v104, s31, v4
v_add_u32 v4, 2, v2
v_xor_b32 v4, v4, v3
v_lshlrev_b32 v4, 4, v4
v_lshl_add_u32 v4, v1, 7, v4
v_add_u32 v101, s30, v4
v_add_u32 v105, s31, v4
v_add_u32 v4, 4, v2
v_xor_b32 v4, v4, v3
v_lshlrev_b32 v4, 4, v4
v_lshl_add_u32 v4, v1, 7, v4
v_add_u32 v102, s30, v4
v_add_u32 v106, s31, v4
v_add_u32 v4, 6, v2
v_xor_b32 v4, v4, v3
v_lshlrev_b32 v4, 4, v4
v_lshl_add_u32 v4, v1, 7, v4
v_add_u32 v103, s30, v4
v_add_u32 v107, s31, v4
s_waitcnt vmcnt(12)
s_cmp_lg_u32 s4, 0
s_cbranch_scc1 QW0
s_waitcnt vmcnt(4)
QW0:
s_barrier
ds_read_b128 v[64:67], v100
ds_read_b128 v[68:71], v101
ds_read_b128 v[72:75], v102
ds_read_b128 v[76:79], v103
ds_read_b64_tr_b16 v[192:193], v96 offset:16384
ds_read_b64_tr_b16 v[194:195], v96 offset:17408
ds_read_b64_tr_b16 v[196:197], v97 offset:16384
ds_read_b64_tr_b16 v[198:199], v97 offset:17408
ds_read_b64_tr_b16 v[200:201], v98 offset:16384
ds_read_b64_tr_b16 v[202:203], v98 offset:17408
s_waitcnt lgkmcnt(4)
v_mfma_f32_32x32x16_bf16 v[0:15], v[192:195], v[64:67], 0
s_add_u32 m0, s30, 0
s_add_u32 s52, s55, 256
buffer_load_dwordx4 v236, s[20:23], s52 offen lds
s_add_u32 m0, s30, 1024
s_add_u32 s52, s55, 8448
buffer_load_dwordx4 v237, s[20:23], s52 offen lds
ds_read_b64_tr_b16 v[204:205], v99 offset:16384
ds_read_b64_tr_b16 v[206:207], v99 offset:17408
s_add_u32 m0, s30, 2048
s_add_u32 s52, s55, 16640
buffer_load_dwordx4 v236, s[20:23], s52 offen lds
s_add_u32 m0, s30, 3072
s_add_u32 s52, s55, 24832
buffer_load_dwordx4 v237, s[20:23], s52 offen lds
s_waitcnt lgkmcnt(4)
v_mfma_f32_32x32x16_bf16 v[16:31], v[196:199], v[64:67], 0
ds_read_b64_tr_b16 v[192:193], v96 offset:20480
ds_read_b64_tr_b16 v[194:195], v96 offset:21504
s_waitcnt lgkmcnt(4)
v_mfma_f32_32x32x16_bf16 v[32:47], v[200:203], v[64:67], 0
ds_read_b64_tr_b16 v[196:197], v97 offset:20480
ds_read_b64_tr_b16 v[198:199], v97 offset:21504
s_waitcnt lgkmcnt(4)
v_mfma_f32_32x32x16_bf16 v[48:63], v[204:207], v[64:67], 0
ds_read_b64_tr_b16 v[200:201], v98 offset:20480
ds_read_b64_tr_b16 v[202:203], v98 offset:21504
s_waitcnt lgkmcnt(4)
v_mfma_f32_32x32x16_bf16 v[0:15], v[192:195], v[68:71], v[0:15]
ds_read_b64_tr_b16 v[204:205], v99 offset:20480
ds_read_b64_tr_b16 v[206:207], v99 offset:21504
s_waitcnt lgkmcnt(4)
v_mfma_f32_32x32x16_bf16 v[16:31], v[196:199], v[68:71], v[16:31]
ds_read_b64_tr_b16 v[192:193], v96 offset:24576
ds_read_b64_tr_b16 v[194:195], v96 offset:25600
s_waitcnt lgkmcnt(4)
v_mfma_f32_32x32x16_bf16 v[32:47], v[200:203], v[68:71], v[32:47]
ds_read_b64_tr_b16 v[196:197], v97 offset:24576
ds_read_b64_tr_b16 v[198:199], v97 offset:25600
s_waitcnt lgkmcnt(4)
v_mfma_f32_32x32x16_bf16 v[48:63], v[204:207], v[68:71], v[48:63]
ds_read_b64_tr_b16 v[200:201], v98 offset:24576
ds_read_b64_tr_b16 v[202:203], v98 offset:25600
s_waitcnt lgkmcnt(4)
v_mfma_f32_32x32x16_bf16 v[0:15], v[192:195], v[72:75], v[0:15]
ds_read_b64_tr_b16 v[204:205], v99 offset:24576
ds_read_b64_tr_b16 v[206:207], v99 offset:25600
s_waitcnt lgkmcnt(4)
v_mfma_f32_32x32x16_bf16 v[16:31], v[196:199], v[72:75], v[16:31]
ds_read_b64_tr_b16 v[192:193], v96 offset:28672
ds_read_b64_tr_b16 v[194:195], v96 offset:29696
s_waitcnt lgkmcnt(4)
v_mfma_f32_32x32x16_bf16 v[32:47], v[200:203], v[72:75], v[32:47]
ds_read_b64_tr_b16 v[196:197], v97 offset:28672
ds_read_b64_tr_b16 v[198:199], v97 offset:29696
s_waitcnt lgkmcnt(4)
v_mfma_f32_32x32x16_bf16 v[48:63], v[204:207], v[72:75], v[48:63]
ds_read_b64_tr_b16 v[200:201], v98 offset:28672
ds_read_b64_tr_b16 v[202:203], v98 offset:29696
s_waitcnt lgkmcnt(4)
v_mfma_f32_32x32x16_bf16 v[0:15], v[192:195], v[76:79], v[0:15]
ds_read_b64_tr_b16 v[204:205], v99 offset:28672
ds_read_b64_tr_b16 v[206:207], v99 offset:29696
s_waitcnt lgkmcnt(4)
v_mfma_f32_32x32x16_bf16 v[16:31], v[196:199], v[76:79], v[16:31]
s_waitcnt vmcnt(12)
s_cmp_lg_u32 s4, 0
s_cbranch_scc1 QW1
s_waitcnt vmcnt(4)
QW1:
s_barrier
ds_read_b128 v[80:83], v104
ds_read_b128 v[84:87], v105
ds_read_b128 v[88:91], v106
ds_read_b128 v[92:95], v107
ds_read_b64_tr_b16 v[192:193], v96 offset:32768
ds_read_b64_tr_b16 v[194:195], v96 offset:33792
s_waitcnt lgkmcnt(8)
v_mfma_f32_32x32x16_bf16 v[32:47], v[200:203], v[76:79], v[32:47]
ds_read_b64_tr_b16 v[196:197], v97 offset:32768
ds_read_b64_tr_b16 v[198:199], v97 offset:33792
s_waitcnt lgkmcnt(8)
v_mfma_f32_32x32x16_bf16 v[48:63], v[204:207], v[76:79], v[48:63]
ds_read_b64_tr_b16 v[200:201], v98 offset:32768
ds_read_b64_tr_b16 v[202:203], v98 offset:33792
s_waitcnt lgkmcnt(4)
v_mfma_f32_32x32x16_bf16 v[0:15], v[192:195], v[80:83], v[0:15]
s_add_u32 m0, s31, 0
s_add_u32 s52, s55, 384
buffer_load_dwordx4 v236, s[20:23], s52 offen lds
s_add_u32 m0, s31, 1024
s_add_u32 s52, s55, 8576
buffer_load_dwordx4 v237, s[20:23], s52 offen lds
ds_read_b64_tr_b16 v[204:205], v99 offset:32768
ds_read_b64_tr_b16 v[206:207], v99 offset:33792
s_add_u32 m0, s31, 2048
s_add_u32 s52, s55, 16768
buffer_load_dwordx4 v236, s[20:23], s52 offen lds
s_add_u32 m0, s31, 3072
s_add_u32 s52, s55, 24960
buffer_load_dwordx4 v237, s[20:23], s52 offen lds
s_waitcnt lgkmcnt(4)
v_mfma_f32_32x32x16_bf16 v[16:31], v[196:199], v[80:83], v[16:31]
ds_read_b64_tr_b16 v[192:193], v96 offset:36864
ds_read_b64_tr_b16 v[194:195], v96 offset:37888
s_waitcnt lgkmcnt(4)
v_mfma_f32_32x32x16_bf16 v[32:47], v[200:203], v[80:83], v[32:47]
ds_read_b64_tr_b16 v[196:197], v97 offset:36864
ds_read_b64_tr_b16 v[198:199], v97 offset:37888
s_waitcnt lgkmcnt(4)
v_mfma_f32_32x32x16_bf16 v[48:63], v[204:207], v[80:83], v[48:63]
ds_read_b64_tr_b16 v[200:201], v98 offset:36864
ds_read_b64_tr_b16 v[202:203], v98 offset:37888
s_waitcnt lgkmcnt(4)
v_mfma_f32_32x32x16_bf16 v[0:15], v[192:195], v[84:87], v[0:15]
ds_read_b64_tr_b16 v[204:205], v99 offset:36864
ds_read_b64_tr_b16 v[206:207], v99 offset:37888
s_waitcnt lgkmcnt(4)
v_mfma_f32_32x32x16_bf16 v[16:31], v[196:199], v[84:87], v[16:31]
ds_read_b64_tr_b16 v[192:193], v96 offset:40960
ds_read_b64_tr_b16 v[194:195], v96 offset:41984
s_waitcnt lgkmcnt(4)
v_mfma_f32_32x32x16_bf16 v[32:47], v[200:203], v[84:87], v[32:47]
ds_read_b64_tr_b16 v[196:197], v97 offset:40960
ds_read_b64_tr_b16 v[198:199], v97 offset:41984
s_waitcnt lgkmcnt(4)
v_mfma_f32_32x32x16_bf16 v[48:63], v[204:207], v[84:87], v[48:63]
ds_read_b64_tr_b16 v[200:201], v98 offset:40960
ds_read_b64_tr_b16 v[202:203], v98 offset:41984
s_waitcnt lgkmcnt(4)
v_mfma_f32_32x32x16_bf16 v[0:15], v[192:195], v[88:91], v[0:15]
ds_read_b64_tr_b16 v[204:205], v99 offset:40960
ds_read_b64_tr_b16 v[206:207], v99 offset:41984
s_waitcnt lgkmcnt(4)
v_mfma_f32_32x32x16_bf16 v[16:31], v[196:199], v[88:91], v[16:31]
ds_read_b64_tr_b16 v[192:193], v96 offset:45056
ds_read_b64_tr_b16 v[194:195], v96 offset:46080
s_waitcnt lgkmcnt(4)
v_mfma_f32_32x32x16_bf16 v[32:47], v[200:203], v[88:91], v[32:47]
ds_read_b64_tr_b16 v[196:197], v97 offset:45056
ds_read_b64_tr_b16 v[198:199], v97 offset:46080
s_waitcnt lgkmcnt(4)
v_mfma_f32_32x32x16_bf16 v[48:63], v[204:207], v[88:91], v[48:63]
ds_read_b64_tr_b16 v[200:201], v98 offset:45056
ds_read_b64_tr_b16 v[202:203], v98 offset:46080
s_waitcnt lgkmcnt(4)
v_mfma_f32_32x32x16_bf16 v[0:15], v[192:195], v[92:95], v[0:15]
ds_read_b64_tr_b16 v[204:205], v99 offset:45056
ds_read_b64_tr_b16 v[206:207], v99 offset:46080
s_waitcnt lgkmcnt(4)
v_mfma_f32_32x32x16_bf16 v[16:31], v[196:199], v[92:95], v[16:31]
s_waitcnt vmcnt(4)
s_barrier
ds_read_b128 v[64:67], v100
ds_read_b128 v[68:71], v101
ds_read_b128 v[72:75], v102
ds_read_b128 v[76:79], v103
ds_read_b64_tr_b16 v[192:193], v96 offset:49152
ds_read_b64_tr_b16 v[194:195], v96 offset:50176
s_waitcnt lgkmcnt(8)
v_mfma_f32_32x32x16_bf16 v[32:47], v[200:203], v[92:95], v[32:47]
ds_read_b64_tr_b16 v[196:197], v97 offset:49152
ds_read_b64_tr_b16 v[198:199], v97 offset:50176
s_waitcnt lgkmcnt(8)
v_mfma_f32_32x32x16_bf16 v[48:63], v[204:207], v[92:95], v[48:63]
ds_read_b64_tr_b16 v[200:201], v98 offset:49152
ds_read_b64_tr_b16 v[202:203], v98 offset:50176
s_waitcnt lgkmcnt(4)
v_mfma_f32_32x32x16_bf16 v[0:15], v[192:195], v[64:67], v[0:15]
s_add_u32 m0, s30, 0
s_add_u32 s52, s55, 512
buffer_load_dwordx4 v236, s[20:23], s52 offen lds
s_add_u32 m0, s30, 1024
s_add_u32 s52, s55, 8704
buffer_load_dwordx4 v237, s[20:23], s52 offen lds
ds_read_b64_tr_b16 v[204:205], v99 offset:49152
ds_read_b64_tr_b16 v[206:207], v99 offset:50176
s_add_u32 m0, s30, 2048
s_add_u32 s52, s55, 16896
buffer_load_dwordx4 v236, s[20:23], s52 offen lds
s_add_u32 m0, s30, 3072
s_add_u32 s52, s55, 25088
buffer_load_dwordx4 v237, s[20:23], s52 offen lds
s_waitcnt lgkmcnt(4)
v_mfma_f32_32x32x16_bf16 v[16:31], v[196:199], v[64:67], v[16:31]
ds_read_b64_tr_b16 v[192:193], v96 offset:53248
ds_read_b64_tr_b16 v[194:195], v96 offset:54272
s_waitcnt lgkmcnt(4)
v_mfma_f32_32x32x16_bf16 v[32:47], v[200:203], v[64:67], v[32:47]
ds_read_b64_tr_b16 v[196:197], v97 offset:53248
ds_read_b64_tr_b16 v[198:199], v97 offset:54272
s_waitcnt lgkmcnt(4)
v_mfma_f32_32x32x16_bf16 v[48:63], v[204:207], v[64:67], v[48:63]
ds_read_b64_tr_b16 v[200:201], v98 offset:53248
ds_read_b64_tr_b16 v[202:203], v98 offset:54272
s_waitcnt lgkmcnt(4)
v_mfma_f32_32x32x16_bf16 v[0:15], v[192:195], v[68:71], v[0:15]
ds_read_b64_tr_b16 v[204:205], v99 offset:53248
ds_read_b64_tr_b16 v[206:207], v99 offset:54272
s_waitcnt lgkmcnt(4)
v_mfma_f32_32x32x16_bf16 v[16:31], v[196:199], v[68:71], v[16:31]
ds_read_b64_tr_b16 v[192:193], v96 offset:57344
ds_read_b64_tr_b16 v[194:195], v96 offset:58368
s_waitcnt lgkmcnt(4)
v_mfma_f32_32x32x16_bf16 v[32:47], v[200:203], v[68:71], v[32:47]
ds_read_b64_tr_b16 v[196:197], v97 offset:57344
ds_read_b64_tr_b16 v[198:199], v97 offset:58368
s_waitcnt lgkmcnt(4)
v_mfma_f32_32x32x16_bf16 v[48:63], v[204:207], v[68:71], v[48:63]
ds_read_b64_tr_b16 v[200:201], v98 offset:57344
ds_read_b64_tr_b16 v[202:203], v98 offset:58368
s_waitcnt lgkmcnt(4)
v_mfma_f32_32x32x16_bf16 v[0:15], v[192:195], v[72:75], v[0:15]
ds_read_b64_tr_b16 v[204:205], v99 offset:57344
ds_read_b64_tr_b16 v[206:207], v99 offset:58368
s_waitcnt lgkmcnt(4)
v_mfma_f32_32x32x16_bf16 v[16:31], v[196:199], v[72:75], v[16:31]
ds_read_b64_tr_b16 v[192:193], v96 offset:61440
ds_read_b64_tr_b16 v[194:195], v96 offset:62464
s_waitcnt lgkmcnt(4)
v_mfma_f32_32x32x16_bf16 v[32:47], v[200:203], v[72:75], v[32:47]
ds_read_b64_tr_b16 v[196:197], v97 offset:61440
ds_read_b64_tr_b16 v[198:199], v97 offset:62464
s_waitcnt lgkmcnt(4)
v_mfma_f32_32x32x16_bf16 v[48:63], v[204:207], v[72:75], v[48:63]
ds_read_b64_tr_b16 v[200:201], v98 offset:61440
ds_read_b64_tr_b16 v[202:203], v98 offset:62464
s_waitcnt lgkmcnt(4)
v_mfma_f32_32x32x16_bf16 v[0:15], v[192:195], v[76:79], v[0:15]
ds_read_b64_tr_b16 v[204:205], v99 offset:61440
ds_read_b64_tr_b16 v[206:207], v99 offset:62464
s_waitcnt lgkmcnt(4)
v_mfma_f32_32x32x16_bf16 v[16:31], v[196:199], v[76:79], v[16:31]
s_waitcnt vmcnt(4)
s_barrier
ds_read_b128 v[80:83], v104
ds_read_b128 v[84:87], v105
ds_read_b128 v[88:91], v106
ds_read_b128 v[92:95], v107
ds_read_b64_tr_b16 v[192:193], v96 offset:16384
ds_read_b64_tr_b16 v[194:195], v96 offset:17408
s_waitcnt lgkmcnt(8)
v_mfma_f32_32x32x16_bf16 v[32:47], v[200:203], v[76:79], v[32:47]
ds_read_b64_tr_b16 v[196:197], v97 offset:16384
ds_read_b64_tr_b16 v[198:199], v97 offset:17408
s_waitcnt lgkmcnt(8)
v_mfma_f32_32x32x16_bf16 v[48:63], v[204:207], v[76:79], v[48:63]
ds_read_b64_tr_b16 v[200:201], v98 offset:16384
ds_read_b64_tr_b16 v[202:203], v98 offset:17408
s_waitcnt lgkmcnt(4)
v_mfma_f32_32x32x16_bf16 v[0:15], v[192:195], v[80:83], v[0:15]
s_add_u32 m0, s31, 0
s_add_u32 s52, s55, 640
buffer_load_dwordx4 v236, s[20:23], s52 offen lds
s_add_u32 m0, s31, 1024
s_add_u32 s52, s55, 8832
buffer_load_dwordx4 v237, s[20:23], s52 offen lds
ds_read_b64_tr_b16 v[204:205], v99 offset:16384
ds_read_b64_tr_b16 v[206:207], v99 offset:17408
s_add_u32 m0, s31, 2048
s_add_u32 s52, s55, 17024
buffer_load_dwordx4 v236, s[20:23], s52 offen lds
s_add_u32 m0, s31, 3072
s_add_u32 s52, s55, 25216
buffer_load_dwordx4 v237, s[20:23], s52 offen lds
s_waitcnt lgkmcnt(4)
v_mfma_f32_32x32x16_bf16 v[16:31], v[196:199], v[80:83], v[16:31]
ds_read_b64_tr_b16 v[192:193], v96 offset:20480
ds_read_b64_tr_b16 v[194:195], v96 offset:21504
s_waitcnt lgkmcnt(4)
v_mfma_f32_32x32x16_bf16 v[32:47], v[200:203], v[80:83], v[32:47]
ds_read_b64_tr_b16 v[196:197], v97 offset:20480
ds_read_b64_tr_b16 v[198:199], v97 offset:21504
s_waitcnt lgkmcnt(4)
v_mfma_f32_32x32x16_bf16 v[48:63], v[204:207], v[80:83], v[48:63]
ds_read_b64_tr_b16 v[200:201], v98 offset:20480
ds_read_b64_tr_b16 v[202:203], v98 offset:21504
s_waitcnt lgkmcnt(4)
v_mfma_f32_32x32x16_bf16 v[0:15], v[192:195], v[84:87], v[0:15]
ds_read_b64_tr_b16 v[204:205], v99 offset:20480
ds_read_b64_tr_b16 v[206:207], v99 offset:21504
s_waitcnt lgkmcnt(4)
v_mfma_f32_32x32x16_bf16 v[16:31], v[196:199], v[84:87], v[16:31]
ds_read_b64_tr_b16 v[192:193], v96 offset:24576
ds_read_b64_tr_b16 v[194:195], v96 offset:25600
s_waitcnt lgkmcnt(4)
v_mfma_f32_32x32x16_bf16 v[32:47], v[200:203], v[84:87], v[32:47]
ds_read_b64_tr_b16 v[196:197], v97 offset:24576
ds_read_b64_tr_b16 v[198:199], v97 offset:25600
s_waitcnt lgkmcnt(4)
v_mfma_f32_32x32x16_bf16 v[48:63], v[204:207], v[84:87], v[48:63]
ds_read_b64_tr_b16 v[200:201], v98 offset:24576
ds_read_b64_tr_b16 v[202:203], v98 offset:25600
s_waitcnt lgkmcnt(4)
v_mfma_f32_32x32x16_bf16 v[0:15], v[192:195], v[88:91], v[0:15]
ds_read_b64_tr_b16 v[204:205], v99 offset:24576
ds_read_b64_tr_b16 v[206:207], v99 offset:25600
s_waitcnt lgkmcnt(4)
v_mfma_f32_32x32x16_bf16 v[16:31], v[196:199], v[88:91], v[16:31]
ds_read_b64_tr_b16 v[192:193], v96 offset:28672
ds_read_b64_tr_b16 v[194:195], v96 offset:29696
s_waitcnt lgkmcnt(4)
v_mfma_f32_32x32x16_bf16 v[32:47], v[200:203], v[88:91], v[32:47]
ds_read_b64_tr_b16 v[196:197], v97 offset:28672
ds_read_b64_tr_b16 v[198:199], v97 offset:29696
s_waitcnt lgkmcnt(4)
v_mfma_f32_32x32x16_bf16 v[48:63], v[204:207], v[88:91], v[48:63]
ds_read_b64_tr_b16 v[200:201], v98 offset:28672
ds_read_b64_tr_b16 v[202:203], v98 offset:29696
s_waitcnt lgkmcnt(4)
v_mfma_f32_32x32x16_bf16 v[0:15], v[192:195], v[92:95], v[0:15]
ds_read_b64_tr_b16 v[204:205], v99 offset:28672
ds_read_b64_tr_b16 v[206:207], v99 offset:29696
s_waitcnt lgkmcnt(4)
v_mfma_f32_32x32x16_bf16 v[16:31], v[196:199], v[92:95], v[16:31]
s_waitcnt vmcnt(4)
s_barrier
ds_read_b128 v[64:67], v100
ds_read_b128 v[68:71], v101
ds_read_b128 v[72:75], v102
ds_read_b128 v[76:79], v103
ds_read_b64_tr_b16 v[192:193], v96 offset:32768
ds_read_b64_tr_b16 v[194:195], v96 offset:33792
s_waitcnt lgkmcnt(8)
v_mfma_f32_32x32x16_bf16 v[32:47], v[200:203], v[92:95], v[32:47]
ds_read_b64_tr_b16 v[196:197], v97 offset:32768
ds_read_b64_tr_b16 v[198:199], v97 offset:33792
s_waitcnt lgkmcnt(8)
v_mfma_f32_32x32x16_bf16 v[48:63], v[204:207], v[92:95], v[48:63]
ds_read_b64_tr_b16 v[200:201], v98 offset:32768
ds_read_b64_tr_b16 v[202:203], v98 offset:33792
s_waitcnt lgkmcnt(4)
v_mfma_f32_32x32x16_bf16 v[0:15], v[192:195], v[64:67], v[0:15]
s_add_u32 m0, s30, 0
s_add_u32 s52, s55, 768
buffer_load_dwordx4 v236, s[20:23], s52 offen lds
s_add_u32 m0, s30, 1024
s_add_u32 s52, s55, 8960
buffer_load_dwordx4 v237, s[20:23], s52 offen lds
ds_read_b64_tr_b16 v[204:205], v99 offset:32768
ds_read_b64_tr_b16 v[206:207], v99 offset:33792
s_add_u32 m0, s30, 2048
s_add_u32 s52, s55, 17152
buffer_load_dwordx4 v236, s[20:23], s52 offen lds
s_add_u32 m0, s30, 3072
s_add_u32 s52, s55, 25344
buffer_load_dwordx4 v237, s[20:23], s52 offen lds
s_waitcnt lgkmcnt(4)
v_mfma_f32_32x32x16_bf16 v[16:31], v[196:199], v[64:67], v[16:31]
ds_read_b64_tr_b16 v[192:193], v96 offset:36864
ds_read_b64_tr_b16 v[194:195], v96 offset:37888
s_waitcnt lgkmcnt(4)
v_mfma_f32_32x32x16_bf16 v[32:47], v[200:203], v[64:67], v[32:47]
ds_read_b64_tr_b16 v[196:197], v97 offset:36864
ds_read_b64_tr_b16 v[198:199], v97 offset:37888
s_waitcnt lgkmcnt(4)
v_mfma_f32_32x32x16_bf16 v[48:63], v[204:207], v[64:67], v[48:63]
ds_read_b64_tr_b16 v[200:201], v98 offset:36864
ds_read_b64_tr_b16 v[202:203], v98 offset:37888
s_waitcnt lgkmcnt(4)
v_mfma_f32_32x32x16_bf16 v[0:15], v[192:195], v[68:71], v[0:15]
ds_read_b64_tr_b16 v[204:205], v99 offset:36864
ds_read_b64_tr_b16 v[206:207], v99 offset:37888
s_waitcnt lgkmcnt(4)
v_mfma_f32_32x32x16_bf16 v[16:31], v[196:199], v[68:71], v[16:31]
ds_read_b64_tr_b16 v[192:193], v96 offset:40960
ds_read_b64_tr_b16 v[194:195], v96 offset:41984
s_waitcnt lgkmcnt(4)
v_mfma_f32_32x32x16_bf16 v[32:47], v[200:203], v[68:71], v[32:47]
ds_read_b64_tr_b16 v[196:197], v97 offset:40960
ds_read_b64_tr_b16 v[198:199], v97 offset:41984
s_waitcnt lgkmcnt(4)
v_mfma_f32_32x32x16_bf16 v[48:63], v[204:207], v[68:71], v[48:63]
ds_read_b64_tr_b16 v[200:201], v98 offset:40960
ds_read_b64_tr_b16 v[202:203], v98 offset:41984
s_waitcnt lgkmcnt(4)
v_mfma_f32_32x32x16_bf16 v[0:15], v[192:195], v[72:75], v[0:15]
ds_read_b64_tr_b16 v[204:205], v99 offset:40960
ds_read_b64_tr_b16 v[206:207], v99 offset:41984
s_waitcnt lgkmcnt(4)
v_mfma_f32_32x32x16_bf16 v[16:31], v[196:199], v[72:75], v[16:31]
ds_read_b64_tr_b16 v[192:193], v96 offset:45056
ds_read_b64_tr_b16 v[194:195], v96 offset:46080
s_waitcnt lgkmcnt(4)
v_mfma_f32_32x32x16_bf16 v[32:47], v[200:203], v[72:75], v[32:47]
ds_read_b64_tr_b16 v[196:197], v97 offset:45056
ds_read_b64_tr_b16 v[198:199], v97 offset:46080
s_waitcnt lgkmcnt(4)
v_mfma_f32_32x32x16_bf16 v[48:63], v[204:207], v[72:75], v[48:63]
ds_read_b64_tr_b16 v[200:201], v98 offset:45056
ds_read_b64_tr_b16 v[202:203], v98 offset:46080
s_waitcnt lgkmcnt(4)
v_mfma_f32_32x32x16_bf16 v[0:15], v[192:195], v[76:79], v[0:15]
ds_read_b64_tr_b16 v[204:205], v99 offset:45056
ds_read_b64_tr_b16 v[206:207], v99 offset:46080
s_waitcnt lgkmcnt(4)
v_mfma_f32_32x32x16_bf16 v[16:31], v[196:199], v[76:79], v[16:31]
s_waitcnt vmcnt(4)
s_barrier
ds_read_b128 v[80:83], v104
ds_read_b128 v[84:87], v105
ds_read_b128 v[88:91], v106
ds_read_b128 v[92:95], v107
ds_read_b64_tr_b16 v[192:193], v96 offset:49152
ds_read_b64_tr_b16 v[194:195], v96 offset:50176
s_waitcnt lgkmcnt(8)
v_mfma_f32_32x32x16_bf16 v[32:47], v[200:203], v[76:79], v[32:47]
ds_read_b64_tr_b16 v[196:197], v97 offset:49152
ds_read_b64_tr_b16 v[198:199], v97 offset:50176
s_waitcnt lgkmcnt(8)
v_mfma_f32_32x32x16_bf16 v[48:63], v[204:207], v[76:79], v[48:63]
ds_read_b64_tr_b16 v[200:201], v98 offset:49152
ds_read_b64_tr_b16 v[202:203], v98 offset:50176
s_waitcnt lgkmcnt(4)
v_mfma_f32_32x32x16_bf16 v[0:15], v[192:195], v[80:83], v[0:15]
s_add_u32 m0, s31, 0
s_add_u32 s52, s55, 896
buffer_load_dwordx4 v236, s[20:23], s52 offen lds
s_add_u32 m0, s31, 1024
s_add_u32 s52, s55, 9088
buffer_load_dwordx4 v237, s[20:23], s52 offen lds
ds_read_b64_tr_b16 v[204:205], v99 offset:49152
ds_read_b64_tr_b16 v[206:207], v99 offset:50176
s_add_u32 m0, s31, 2048
s_add_u32 s52, s55, 17280
buffer_load_dwordx4 v236, s[20:23], s52 offen lds
s_add_u32 m0, s31, 3072
s_add_u32 s52, s55, 25472
buffer_load_dwordx4 v237, s[20:23], s52 offen lds
s_waitcnt lgkmcnt(4)
v_mfma_f32_32x32x16_bf16 v[16:31], v[196:199], v[80:83], v[16:31]
ds_read_b64_tr_b16 v[192:193], v96 offset:53248
ds_read_b64_tr_b16 v[194:195], v96 offset:54272
s_waitcnt lgkmcnt(4)
v_mfma_f32_32x32x16_bf16 v[32:47], v[200:203], v[80:83], v[32:47]
ds_read_b64_tr_b16 v[196:197], v97 offset:53248
ds_read_b64_tr_b16 v[198:199], v97 offset:54272
s_waitcnt lgkmcnt(4)
v_mfma_f32_32x32x16_bf16 v[48:63], v[204:207], v[80:83], v[48:63]
ds_read_b64_tr_b16 v[200:201], v98 offset:53248
ds_read_b64_tr_b16 v[202:203], v98 offset:54272
s_waitcnt lgkmcnt(4)
v_mfma_f32_32x32x16_bf16 v[0:15], v[192:195], v[84:87], v[0:15]
ds_read_b64_tr_b16 v[204:205], v99 offset:53248
ds_read_b64_tr_b16 v[206:207], v99 offset:54272
s_waitcnt lgkmcnt(4)
v_mfma_f32_32x32x16_bf16 v[16:31], v[196:199], v[84:87], v[16:31]
ds_read_b64_tr_b16 v[192:193], v96 offset:57344
ds_read_b64_tr_b16 v[194:195], v96 offset:58368
s_waitcnt lgkmcnt(4)
v_mfma_f32_32x32x16_bf16 v[32:47], v[200:203], v[84:87], v[32:47]
ds_read_b64_tr_b16 v[196:197], v97 offset:57344
ds_read_b64_tr_b16 v[198:199], v97 offset:58368
s_waitcnt lgkmcnt(4)
v_mfma_f32_32x32x16_bf16 v[48:63], v[204:207], v[84:87], v[48:63]
ds_read_b64_tr_b16 v[200:201], v98 offset:57344
ds_read_b64_tr_b16 v[202:203], v98 offset:58368
s_waitcnt lgkmcnt(4)
v_mfma_f32_32x32x16_bf16 v[0:15], v[192:195], v[88:91], v[0:15]
ds_read_b64_tr_b16 v[204:205], v99 offset:57344
ds_read_b64_tr_b16 v[206:207], v99 offset:58368
s_waitcnt lgkmcnt(4)
v_mfma_f32_32x32x16_bf16 v[16:31], v[196:199], v[88:91], v[16:31]
ds_read_b64_tr_b16 v[192:193], v96 offset:61440
ds_read_b64_tr_b16 v[194:195], v96 offset:62464
s_waitcnt lgkmcnt(4)
v_mfma_f32_32x32x16_bf16 v[32:47], v[200:203], v[88:91], v[32:47]
ds_read_b64_tr_b16 v[196:197], v97 offset:61440
ds_read_b64_tr_b16 v[198:199], v97 offset:62464
s_waitcnt lgkmcnt(4)
v_mfma_f32_32x32x16_bf16 v[48:63], v[204:207], v[88:91], v[48:63]
ds_read_b64_tr_b16 v[200:201], v98 offset:61440
ds_read_b64_tr_b16 v[202:203], v98 offset:62464
s_waitcnt lgkmcnt(4)
v_mfma_f32_32x32x16_bf16 v[0:15], v[192:195], v[92:95], v[0:15]
ds_read_b64_tr_b16 v[204:205], v99 offset:61440
ds_read_b64_tr_b16 v[206:207], v99 offset:62464
s_waitcnt lgkmcnt(4)
v_mfma_f32_32x32x16_bf16 v[16:31], v[196:199], v[92:95], v[16:31]
s_waitcnt vmcnt(4)
s_barrier
ds_read_b128 v[64:67], v100
ds_read_b128 v[68:71], v101
ds_read_b128 v[72:75], v102
ds_read_b128 v[76:79], v103
ds_read_b64_tr_b16 v[192:193], v96 offset:16384
ds_read_b64_tr_b16 v[194:195], v96 offset:17408
s_waitcnt lgkmcnt(8)
v_mfma_f32_32x32x16_bf16 v[32:47], v[200:203], v[92:95], v[32:47]
ds_read_b64_tr_b16 v[196:197], v97 offset:16384
ds_read_b64_tr_b16 v[198:199], v97 offset:17408
s_waitcnt lgkmcnt(8)
v_mfma_f32_32x32x16_bf16 v[48:63], v[204:207], v[92:95], v[48:63]
ds_read_b64_tr_b16 v[200:201], v98 offset:16384
ds_read_b64_tr_b16 v[202:203], v98 offset:17408
s_waitcnt lgkmcnt(4)
v_mfma_f32_32x32x16_bf16 v[0:15], v[192:195], v[64:67], v[0:15]
ds_read_b64_tr_b16 v[204:205], v99 offset:16384
ds_read_b64_tr_b16 v[206:207], v99 offset:17408
s_waitcnt lgkmcnt(4)
v_mfma_f32_32x32x16_bf16 v[16:31], v[196:199], v[64:67], v[16:31]
ds_read_b64_tr_b16 v[192:193], v96 offset:20480
ds_read_b64_tr_b16 v[194:195], v96 offset:21504
s_waitcnt lgkmcnt(4)
v_mfma_f32_32x32x16_bf16 v[32:47], v[200:203], v[64:67], v[32:47]
ds_read_b64_tr_b16 v[196:197], v97 offset:20480
ds_read_b64_tr_b16 v[198:199], v97 offset:21504
s_waitcnt lgkmcnt(4)
v_mfma_f32_32x32x16_bf16 v[48:63], v[204:207], v[64:67], v[48:63]
ds_read_b64_tr_b16 v[200:201], v98 offset:20480
ds_read_b64_tr_b16 v[202:203], v98 offset:21504
s_waitcnt lgkmcnt(4)
v_mfma_f32_32x32x16_bf16 v[0:15], v[192:195], v[68:71], v[0:15]
ds_read_b64_tr_b16 v[204:205], v99 offset:20480
ds_read_b64_tr_b16 v[206:207], v99 offset:21504
s_waitcnt lgkmcnt(4)
v_mfma_f32_32x32x16_bf16 v[16:31], v[196:199], v[68:71], v[16:31]
ds_read_b64_tr_b16 v[192:193], v96 offset:24576
ds_read_b64_tr_b16 v[194:195], v96 offset:25600
s_waitcnt lgkmcnt(4)
v_mfma_f32_32x32x16_bf16 v[32:47], v[200:203], v[68:71], v[32:47]
ds_read_b64_tr_b16 v[196:197], v97 offset:24576
ds_read_b64_tr_b16 v[198:199], v97 offset:25600
s_waitcnt lgkmcnt(4)
v_mfma_f32_32x32x16_bf16 v[48:63], v[204:207], v[68:71], v[48:63]
ds_read_b64_tr_b16 v[200:201], v98 offset:24576
ds_read_b64_tr_b16 v[202:203], v98 offset:25600
s_waitcnt lgkmcnt(4)
v_mfma_f32_32x32x16_bf16 v[0:15], v[192:195], v[72:75], v[0:15]
ds_read_b64_tr_b16 v[204:205], v99 offset:24576
ds_read_b64_tr_b16 v[206:207], v99 offset:25600
s_waitcnt lgkmcnt(4)
v_mfma_f32_32x32x16_bf16 v[16:31], v[196:199], v[72:75], v[16:31]
ds_read_b64_tr_b16 v[192:193], v96 offset:28672
ds_read_b64_tr_b16 v[194:195], v96 offset:29696
s_waitcnt lgkmcnt(4)
v_mfma_f32_32x32x16_bf16 v[32:47], v[200:203], v[72:75], v[32:47]
ds_read_b64_tr_b16 v[196:197], v97 offset:28672
ds_read_b64_tr_b16 v[198:199], v97 offset:29696
s_waitcnt lgkmcnt(4)
v_mfma_f32_32x32x16_bf16 v[48:63], v[204:207], v[72:75], v[48:63]
ds_read_b64_tr_b16 v[200:201], v98 offset:28672
ds_read_b64_tr_b16 v[202:203], v98 offset:29696
s_waitcnt lgkmcnt(4)
v_mfma_f32_32x32x16_bf16 v[0:15], v[192:195], v[76:79], v[0:15]
ds_read_b64_tr_b16 v[204:205], v99 offset:28672
ds_read_b64_tr_b16 v[206:207], v99 offset:29696
s_waitcnt lgkmcnt(4)
v_mfma_f32_32x32x16_bf16 v[16:31], v[196:199], v[76:79], v[16:31]
s_waitcnt vmcnt(0)
s_barrier
ds_read_b128 v[80:83], v104
ds_read_b128 v[84:87], v105
ds_read_b128 v[88:91], v106
ds_read_b128 v[92:95], v107
ds_read_b64_tr_b16 v[192:193], v96 offset:32768
ds_read_b64_tr_b16 v[194:195], v96 offset:33792
s_waitcnt lgkmcnt(8)
v_mfma_f32_32x32x16_bf16 v[32:47], v[200:203], v[76:79], v[32:47]
ds_read_b64_tr_b16 v[196:197], v97 offset:32768
ds_read_b64_tr_b16 v[198:199], v97 offset:33792
s_waitcnt lgkmcnt(8)
v_mfma_f32_32x32x16_bf16 v[48:63], v[204:207], v[76:79], v[48:63]
ds_read_b64_tr_b16 v[200:201], v98 offset:32768
ds_read_b64_tr_b16 v[202:203], v98 offset:33792
s_waitcnt lgkmcnt(4)
v_mfma_f32_32x32x16_bf16 v[0:15], v[192:195], v[80:83], v[0:15]
ds_read_b64_tr_b16 v[204:205], v99 offset:32768
ds_read_b64_tr_b16 v[206:207], v99 offset:33792
s_waitcnt lgkmcnt(4)
v_mfma_f32_32x32x16_bf16 v[16:31], v[196:199], v[80:83], v[16:31]
ds_read_b64_tr_b16 v[192:193], v96 offset:36864
ds_read_b64_tr_b16 v[194:195], v96 offset:37888
s_waitcnt lgkmcnt(4)
v_mfma_f32_32x32x16_bf16 v[32:47], v[200:203], v[80:83], v[32:47]
ds_read_b64_tr_b16 v[196:197], v97 offset:36864
ds_read_b64_tr_b16 v[198:199], v97 offset:37888
s_waitcnt lgkmcnt(4)
v_mfma_f32_32x32x16_bf16 v[48:63], v[204:207], v[80:83], v[48:63]
ds_read_b64_tr_b16 v[200:201], v98 offset:36864
ds_read_b64_tr_b16 v[202:203], v98 offset:37888
s_waitcnt lgkmcnt(4)
v_mfma_f32_32x32x16_bf16 v[0:15], v[192:195], v[84:87], v[0:15]
ds_read_b64_tr_b16 v[204:205], v99 offset:36864
ds_read_b64_tr_b16 v[206:207], v99 offset:37888
s_waitcnt lgkmcnt(4)
v_mfma_f32_32x32x16_bf16 v[16:31], v[196:199], v[84:87], v[16:31]
ds_read_b64_tr_b16 v[192:193], v96 offset:40960
ds_read_b64_tr_b16 v[194:195], v96 offset:41984
s_waitcnt lgkmcnt(4)
v_mfma_f32_32x32x16_bf16 v[32:47], v[200:203], v[84:87], v[32:47]
ds_read_b64_tr_b16 v[196:197], v97 offset:40960
ds_read_b64_tr_b16 v[198:199], v97 offset:41984
s_waitcnt lgkmcnt(4)
v_mfma_f32_32x32x16_bf16 v[48:63], v[204:207], v[84:87], v[48:63]
ds_read_b64_tr_b16 v[200:201], v98 offset:40960
ds_read_b64_tr_b16 v[202:203], v98 offset:41984
s_waitcnt lgkmcnt(4)
v_mfma_f32_32x32x16_bf16 v[0:15], v[192:195], v[88:91], v[0:15]
ds_read_b64_tr_b16 v[204:205], v99 offset:40960
ds_read_b64_tr_b16 v[206:207], v99 offset:41984
s_waitcnt lgkmcnt(4)
v_mfma_f32_32x32x16_bf16 v[16:31], v[196:199], v[88:91], v[16:31]
ds_read_b64_tr_b16 v[192:193], v96 offset:45056
ds_read_b64_tr_b16 v[194:195], v96 offset:46080
s_waitcnt lgkmcnt(4)
v_mfma_f32_32x32x16_bf16 v[32:47], v[200:203], v[88:91], v[32:47]
ds_read_b64_tr_b16 v[196:197], v97 offset:45056
ds_read_b64_tr_b16 v[198:199], v97 offset:46080
s_waitcnt lgkmcnt(4)
v_mfma_f32_32x32x16_bf16 v[48:63], v[204:207], v[88:91], v[48:63]
ds_read_b64_tr_b16 v[200:201], v98 offset:45056
ds_read_b64_tr_b16 v[202:203], v98 offset:46080
s_waitcnt lgkmcnt(4)
v_mfma_f32_32x32x16_bf16 v[0:15], v[192:195], v[92:95], v[0:15]
ds_read_b64_tr_b16 v[204:205], v99 offset:45056
ds_read_b64_tr_b16 v[206:207], v99 offset:46080
s_waitcnt lgkmcnt(4)
v_mfma_f32_32x32x16_bf16 v[16:31], v[196:199], v[92:95], v[16:31]
s_waitcnt lgkmcnt(2)
v_mfma_f32_32x32x16_bf16 v[32:47], v[200:203], v[92:95], v[32:47]
s_waitcnt lgkmcnt(0)
v_mfma_f32_32x32x16_bf16 v[48:63], v[204:207], v[92:95], v[48:63]
s_nop 3
v_mul_f32 v0, s59, v0
v_mul_f32 v1, s59, v1
v_mul_f32 v2, s59, v2
v_mul_f32 v3, s59, v3
v_mul_f32 v4, s59, v4
v_mul_f32 v5, s59, v5
v_mul_f32 v6, s59, v6
v_mul_f32 v7, s59, v7
v_cvt_pk_bf16_f32 v144, v0, v1
v_cvt_pk_bf16_f32 v145, v2, v3
v_cvt_pk_bf16_f32 v146, v4, v5
v_cvt_pk_bf16_f32 v147, v6, v7
v_mul_f32 v8, s59, v8
v_mul_f32 v9, s59, v9
v_mul_f32 v10, s59, v10
v_mul_f32 v11, s59, v11
v_mul_f32 v12, s59, v12
v_mul_f32 v13, s59, v13
v_mul_f32 v14, s59, v14
v_mul_f32 v15, s59, v15
v_cvt_pk_bf16_f32 v148, v8, v9
v_cvt_pk_bf16_f32 v149, v10, v11
v_cvt_pk_bf16_f32 v150, v12, v13
v_cvt_pk_bf16_f32 v151, v14, v15
v_mul_f32 v16, s59, v16
v_mul_f32 v17, s59, v17
v_mul_f32 v18, s59, v18
v_mul_f32 v19, s59, v19
v_mul_f32 v20, s59, v20
v_mul_f32 v21, s59, v21
v_mul_f32 v22, s59, v22
v_mul_f32 v23, s59, v23
v_cvt_pk_bf16_f32 v152, v16, v17
v_cvt_pk_bf16_f32 v153, v18, v19
v_cvt_pk_bf16_f32 v154, v20, v21
v_cvt_pk_bf16_f32 v155, v22, v23
v_mul_f32 v24, s59, v24
v_mul_f32 v25, s59, v25
v_mul_f32 v26, s59, v26
v_mul_f32 v27, s59, v27
v_mul_f32 v28, s59, v28
v_mul_f32 v29, s59, v29
v_mul_f32 v30, s59, v30
v_mul_f32 v31, s59, v31
v_cvt_pk_bf16_f32 v156, v24, v25
v_cvt_pk_bf16_f32 v157, v26, v27
v_cvt_pk_bf16_f32 v158, v28, v29
v_cvt_pk_bf16_f32 v159, v30, v31
v_mul_f32 v32, s59, v32
v_mul_f32 v33, s59, v33
v_mul_f32 v34, s59, v34
v_mul_f32 v35, s59, v35
v_mul_f32 v36, s59, v36
v_mul_f32 v37, s59, v37
v_mul_f32 v38, s59, v38
v_mul_f32 v39, s59, v39
v_cvt_pk_bf16_f32 v160, v32, v33
v_cvt_pk_bf16_f32 v161, v34, v35
v_cvt_pk_bf16_f32 v162, v36, v37
v_cvt_pk_bf16_f32 v163, v38, v39
v_mul_f32 v40, s59, v40
v_mul_f32 v41, s59, v41
v_mul_f32 v42, s59, v42
v_mul_f32 v43, s59, v43
v_mul_f32 v44, s59, v44
v_mul_f32 v45, s59, v45
v_mul_f32 v46, s59, v46
v_mul_f32 v47, s59, v47
v_cvt_pk_bf16_f32 v164, v40, v41
v_cvt_pk_bf16_f32 v165, v42, v43
v_cvt_pk_bf16_f32 v166, v44, v45
v_cvt_pk_bf16_f32 v167, v46, v47
v_mul_f32 v48, s59, v48
v_mul_f32 v49, s59, v49
v_mul_f32 v50, s59, v50
v_mul_f32 v51, s59, v51
v_mul_f32 v52, s59, v52
v_mul_f32 v53, s59, v53
v_mul_f32 v54, s59, v54
v_mul_f32 v55, s59, v55
v_cvt_pk_bf16_f32 v168, v48, v49
v_cvt_pk_bf16_f32 v169, v50, v51
v_cvt_pk_bf16_f32 v170, v52, v53
v_cvt_pk_bf16_f32 v171, v54, v55
v_mul_f32 v56, s59, v56
v_mul_f32 v57, s59, v57
v_mul_f32 v58, s59, v58
v_mul_f32 v59, s59, v59
v_mul_f32 v60, s59, v60
v_mul_f32 v61, s59, v61
v_mul_f32 v62, s59, v62
v_mul_f32 v63, s59, v63
v_cvt_pk_bf16_f32 v172, v56, v57
v_cvt_pk_bf16_f32 v173, v58, v59
v_cvt_pk_bf16_f32 v174, v60, v61
v_cvt_pk_bf16_f32 v175, v62, v63
s_barrier
ds_read_b128 v[192:195], v224 offset:0
ds_read_b128 v[196:199], v225 offset:0
ds_read_b128 v[200:203], v226 offset:0
s_waitcnt lgkmcnt(2)
v_mfma_f32_32x32x16_bf16 v[64:79], v[192:195], v[144:147], 0
v_mov_b32 v0, 0
v_mov_b32 v1, 0
v_mov_b32 v2, 0
ds_read_b128 v[204:207], v227 offset:0
v_mov_b32 v3, 0
v_mov_b32 v4, 0
s_waitcnt lgkmcnt(2)
v_mfma_f32_32x32x16_bf16 v[64:79], v[196:199], v[148:151], v[64:79]
v_mov_b32 v5, 0
v_mov_b32 v6, 0
v_mov_b32 v7, 0
ds_read_b128 v[192:195], v228 offset:0
v_mov_b32 v8, 0
v_mov_b32 v9, 0
s_waitcnt lgkmcnt(2)
v_mfma_f32_32x32x16_bf16 v[64:79], v[200:203], v[152:155], v[64:79]
v_mov_b32 v10, 0
v_mov_b32 v11, 0
v_mov_b32 v12, 0
ds_read_b128 v[196:199], v229 offset:0
v_mov_b32 v13, 0
v_mov_b32 v14, 0
s_waitcnt lgkmcnt(2)
v_mfma_f32_32x32x16_bf16 v[64:79], v[204:207], v[156:159], v[64:79]
v_mov_b32 v15, 0
v_mov_b32 v16, 0
v_mov_b32 v17, 0
ds_read_b128 v[200:203], v230 offset:0
v_mov_b32 v18, 0
v_mov_b32 v19, 0
s_waitcnt lgkmcnt(2)
v_mfma_f32_32x32x16_bf16 v[64:79], v[192:195], v[160:163], v[64:79]
v_mov_b32 v20, 0
v_mov_b32 v21, 0
v_mov_b32 v22, 0
ds_read_b128 v[204:207], v231 offset:0
v_mov_b32 v23, 0
v_mov_b32 v24, 0
s_waitcnt lgkmcnt(2)
v_mfma_f32_32x32x16_bf16 v[64:79], v[196:199], v[164:167], v[64:79]
v_mov_b32 v25, 0
v_mov_b32 v26, 0
v_mov_b32 v27, 0
ds_read_b128 v[192:195], v224 offset:8192
v_mov_b32 v28, 0
v_mov_b32 v29, 0
s_waitcnt lgkmcnt(2)
v_mfma_f32_32x32x16_bf16 v[64:79], v[200:203], v[168:171], v[64:79]
v_mov_b32 v30, 0
v_mov_b32 v31, 0
v_mov_b32 v32, 0
ds_read_b128 v[196:199], v225 offset:8192
v_mov_b32 v33, 0
v_mov_b32 v34, 0
s_waitcnt lgkmcnt(2)
v_mfma_f32_32x32x16_bf16 v[64:79], v[204:207], v[172:175], v[64:79]
v_mov_b32 v35, 0
v_mov_b32 v36, 0
v_mov_b32 v37, 0
ds_read_b128 v[200:203], v226 offset:8192
v_mov_b32 v38, 0
v_mov_b32 v39, 0
s_waitcnt lgkmcnt(2)
v_mfma_f32_32x32x16_bf16 v[80:95], v[192:195], v[144:147], 0
v_mov_b32 v40, 0
v_mov_b32 v41, 0
v_mov_b32 v42, 0
ds_read_b128 v[204:207], v227 offset:8192
v_mov_b32 v43, 0
v_mov_b32 v44, 0
s_waitcnt lgkmcnt(2)
v_mfma_f32_32x32x16_bf16 v[80:95], v[196:199], v[148:151], v[80:95]
v_mov_b32 v45, 0
v_mov_b32 v46, 0
v_mov_b32 v47, 0
ds_read_b128 v[192:195], v228 offset:8192
v_mov_b32 v48, 0
v_mov_b32 v49, 0
s_waitcnt lgkmcnt(2)
v_mfma_f32_32x32x16_bf16 v[80:95], v[200:203], v[152:155], v[80:95]
v_mov_b32 v50, 0
v_mov_b32 v51, 0
v_mov_b32 v52, 0
ds_read_b128 v[196:199], v229 offset:8192
v_mov_b32 v53, 0
v_mov_b32 v54, 0
s_waitcnt lgkmcnt(2)
v_mfma_f32_32x32x16_bf16 v[80:95], v[204:207], v[156:159], v[80:95]
v_mov_b32 v55, 0
v_mov_b32 v56, 0
v_mov_b32 v57, 0
ds_read_b128 v[200:203], v230 offset:8192
v_mov_b32 v58, 0
v_mov_b32 v59, 0
s_waitcnt lgkmcnt(2)
v_mfma_f32_32x32x16_bf16 v[80:95], v[192:195], v[160:163], v[80:95]
v_mov_b32 v60, 0
v_mov_b32 v61, 0
v_mov_b32 v62, 0
ds_read_b128 v[204:207], v231 offset:8192
v_mov_b32 v63, 0
v_mov_b32 v238, 0
s_waitcnt lgkmcnt(2)
v_mfma_f32_32x32x16_bf16 v[80:95], v[196:199], v[164:167], v[80:95]
v_mov_b32 v239, 0
v_mov_b32 v240, 0
ds_read_b128 v[192:195], v224 offset:16384
v_mov_b32 v241, 0
s_waitcnt lgkmcnt(2)
v_mfma_f32_32x32x16_bf16 v[80:95], v[200:203], v[168:171], v[80:95]
ds_read_b128 v[196:199], v225 offset:16384
s_waitcnt lgkmcnt(2)
v_mfma_f32_32x32x16_bf16 v[80:95], v[204:207], v[172:175], v[80:95]
ds_read_b128 v[200:203], v226 offset:16384
v_max3_f32 v242, v64, v65, v66
v_max3_f32 v242, v242, v67, v68
v_max3_f32 v242, v242, v69, v70
v_max3_f32 v242, v242, v71, v72
v_max3_f32 v242, v242, v73, v74
v_max3_f32 v242, v242, v75, v76
v_max3_f32 v242, v242, v77, v78
s_nop 3
v_max3_f32 v242, v242, v79, v80
v_max3_f32 v242, v242, v81, v82
v_max3_f32 v242, v242, v83, v84
v_max3_f32 v242, v242, v85, v86
v_max3_f32 v242, v242, v87, v88
v_max3_f32 v242, v242, v89, v90
v_max3_f32 v242, v242, v91, v92
v_max3_f32 v242, v242, v93, v94
v_max3_f32 v242, v242, v95, v95
v_mov_b32 v243, v242
s_nop 1
v_permlane32_swap_b32 v242, v243
v_max_f32 v242, v242, v243
v_sub_f32 v64, v64, v242
v_sub_f32 v65, v65, v242
v_sub_f32 v66, v66, v242
v_sub_f32 v67, v67, v242
v_sub_f32 v68, v68, v242
v_sub_f32 v69, v69, v242
v_sub_f32 v70, v70, v242
v_sub_f32 v71, v71, v242
v_sub_f32 v72, v72, v242
v_sub_f32 v73, v73, v242
v_sub_f32 v74, v74, v242
v_sub_f32 v75, v75, v242
v_sub_f32 v76, v76, v242
v_sub_f32 v77, v77, v242
v_sub_f32 v78, v78, v242
v_sub_f32 v79, v79, v242
v_sub_f32 v80, v80, v242
v_sub_f32 v81, v81, v242
v_sub_f32 v82, v82, v242
v_sub_f32 v83, v83, v242
v_sub_f32 v84, v84, v242
v_sub_f32 v85, v85, v242
v_sub_f32 v86, v86, v242
v_sub_f32 v87, v87, v242
v_sub_f32 v88, v88, v242
v_sub_f32 v89, v89, v242
v_sub_f32 v90, v90, v242
v_sub_f32 v91, v91, v242
v_sub_f32 v92, v92, v242
v_sub_f32 v93, v93, v242
v_sub_f32 v94, v94, v242
v_sub_f32 v95, v95, v242
v_sub_f32 v128, 0, v242
v_sub_f32 v129, 0, v242
v_sub_f32 v130, 0, v242
v_sub_f32 v131, 0, v242
v_sub_f32 v132, 0, v242
v_sub_f32 v133, 0, v242
v_sub_f32 v134, 0, v242
v_sub_f32 v135, 0, v242
v_sub_f32 v136, 0, v242
v_sub_f32 v137, 0, v242
v_sub_f32 v138, 0, v242
v_sub_f32 v139, 0, v242
v_sub_f32 v140, 0, v242
v_sub_f32 v141, 0, v242
v_sub_f32 v142, 0, v242
v_sub_f32 v143, 0, v242
s_mov_b32 s100, 99
s_mov_b32 s96, s40
s_mov_b32 s97, s41
s_mov_b32 s98, 4
s_mov_b32 s99, 0x20000
v_mov_b32 v246, 0
s_cmp_lg_u32 s4, 0
s_cbranch_scc1 SP_R1
s_cmp_ge_u32 s5, 3
s_cbranch_scc1 TO_SB
s_lshl_b32 s28, s2, 1
s_add_u32 s28, s28, s5
s_cmp_eq_u32 s5, 2
s_cselect_b32 s96, s40, s46
s_cselect_b32 s97, s41, s47
s_mov_b32 s98, 0x400000
s_cselect_b32 s98, 1835008, s98
s_cselect_b32 s28, s2, s28
s_mov_b32 s99, 0x20000
s_lshl_b32 s28, s28, 13
v_lshlrev_b32 v246, 7, v245
v_add_u32 v246, s28, v246
s_mov_b32 s100, s5
TO_SB:
s_nop 1
s_branch SP_END
SP_R1:
s_cmp_ge_u32 s5, 4
s_cbranch_scc1 SP_END
s_load_dwordx2 s[28:29], s[0:1], 32
s_load_dwordx2 s[96:97], s[0:1], 72
s_waitcnt lgkmcnt(0)
s_cmp_lt_u32 s2, 128
s_cselect_b32 s96, s28, s96
s_cselect_b32 s97, s29, s97
s_mov_b32 s98, 0x400000
s_mov_b32 s99, 0x20000
s_and_b32 s28, s2, 127
s_lshl_b32 s28, s28, 15
s_lshl_b32 s29, s5, 13
s_add_u32 s28, s28, s29
v_lshlrev_b32 v246, 7, v245
v_add_u32 v246, s28, v246
s_min_u32 s100, s5, 2
SP_END:
s_nop 1
s_mov_b32 s56, 0
LOOP:
s_waitcnt lgkmcnt(2)
v_mfma_f32_32x32x16_bf16 v[96:111], v[192:195], v[144:147], v[128:143]
v_exp_f32 v64, v64
ds_read_b128 v[204:207], v227 offset:16384
v_exp_f32 v65, v65
s_waitcnt lgkmcnt(2)
v_mfma_f32_32x32x16_bf16 v[96:111], v[196:199], v[148:151], v[96:111]
v_exp_f32 v66, v66
v_add_f32 v238, v238, v64
ds_read_b128 v[192:195], v228 offset:16384
v_add_f32 v239, v239, v65
v_cvt_pk_bf16_f32 v176, v64, v65
s_waitcnt lgkmcnt(2)
v_mfma_f32_32x32x16_bf16 v[96:111], v[200:203], v[152:155], v[96:111]
v_exp_f32 v67, v67
ds_read_b128 v[196:199], v229 offset:16384
v_add_f32 v240, v240, v66
s_waitcnt lgkmcnt(2)
v_mfma_f32_32x32x16_bf16 v[96:111], v[204:207], v[156:159], v[96:111]
v_exp_f32 v68, v68
v_add_f32 v241, v241, v67
ds_read_b128 v[200:203], v230 offset:16384
v_cvt_pk_bf16_f32 v177, v66, v67
s_waitcnt lgkmcnt(2)
v_mfma_f32_32x32x16_bf16 v[96:111], v[192:195], v[160:163], v[96:111]
v_exp_f32 v69, v69
v_add_f32 v238, v238, v68
ds_read_b128 v[204:207], v231 offset:16384
v_exp_f32 v70, v70
s_waitcnt lgkmcnt(2)
v_mfma_f32_32x32x16_bf16 v[96:111], v[196:199], v[164:167], v[96:111]
v_exp_f32 v71, v71
v_add_f32 v239, v239, v69
ds_read_b128 v[192:195], v224 offset:24576
v_add_f32 v240, v240, v70
v_cvt_pk_bf16_f32 v178, v68, v69
s_waitcnt lgkmcnt(2)
v_mfma_f32_32x32x16_bf16 v[96:111], v[200:203], v[168:171], v[96:111]
v_exp_f32 v72, v72
v_add_f32 v241, v241, v71
ds_read_b128 v[196:199], v225 offset:24576
v_cvt_pk_bf16_f32 v179, v70, v71
s_waitcnt lgkmcnt(2)
v_mfma_f32_32x32x16_bf16 v[96:111], v[204:207], v[172:175], v[96:111]
v_exp_f32 v73, v73
ds_read_b128 v[200:203], v226 offset:24576
v_add_f32 v238, v238, v72
s_waitcnt lgkmcnt(2)
v_mfma_f32_32x32x16_bf16 v[112:127], v[192:195], v[144:147], v[128:143]
v_exp_f32 v74, v74
v_add_f32 v239, v239, v73
ds_read_b128 v[204:207], v227 offset:24576
v_exp_f32 v75, v75
v_cvt_pk_bf16_f32 v180, v72, v73
s_waitcnt lgkmcnt(2)
v_mfma_f32_32x32x16_bf16 v[112:127], v[196:199], v[148:151], v[112:127]
v_exp_f32 v76, v76
v_add_f32 v240, v240, v74
ds_read_b128 v[192:195], v228 offset:24576
v_add_f32 v241, v241, v75
v_cvt_pk_bf16_f32 v181, v74, v75
s_waitcnt lgkmcnt(2)
v_mfma_f32_32x32x16_bf16 v[112:127], v[200:203], v[152:155], v[112:127]
v_exp_f32 v77, v77
ds_read_b128 v[196:199], v229 offset:24576
v_add_f32 v238, v238, v76
s_waitcnt lgkmcnt(2)
v_mfma_f32_32x32x16_bf16 v[112:127], v[204:207], v[156:159], v[112:127]
v_exp_f32 v78, v78
v_add_f32 v239, v239, v77
ds_read_b128 v[200:203], v230 offset:24576
v_cvt_pk_bf16_f32 v182, v76, v77
v_max3_f32 v242, v96, v97, v98
s_waitcnt lgkmcnt(2)
v_mfma_f32_32x32x16_bf16 v[112:127], v[192:195], v[160:163], v[112:127]
v_exp_f32 v79, v79
v_add_f32 v240, v240, v78
ds_read_b128 v[204:207], v231 offset:24576
v_max3_f32 v242, v242, v99, v100
s_waitcnt lgkmcnt(2)
v_mfma_f32_32x32x16_bf16 v[112:127], v[196:199], v[164:167], v[112:127]
v_exp_f32 v80, v80
v_add_f32 v241, v241, v79
v_exp_f32 v81, v81
ds_read_b64_tr_b16 v[192:193], v232 offset:0
ds_read_b64_tr_b16 v[194:195], v232 offset:2048
v_cvt_pk_bf16_f32 v183, v78, v79
v_max3_f32 v242, v242, v101, v102
s_waitcnt lgkmcnt(3)
v_mfma_f32_32x32x16_bf16 v[112:127], v[200:203], v[168:171], v[112:127]
v_exp_f32 v82, v82
v_add_f32 v238, v238, v80
v_add_f32 v239, v239, v81
ds_read_b64_tr_b16 v[196:197], v233 offset:0
ds_read_b64_tr_b16 v[198:199], v233 offset:2048
v_cvt_pk_bf16_f32 v184, v80, v81
v_max3_f32 v242, v242, v103, v104
s_waitcnt lgkmcnt(4)
v_mfma_f32_32x32x16_bf16 v[112:127], v[204:207], v[172:175], v[112:127]
v_exp_f32 v83, v83
v_add_f32 v240, v240, v82
ds_read_b64_tr_b16 v[200:201], v234 offset:0
ds_read_b64_tr_b16 v[202:203], v234 offset:2048
v_max3_f32 v242, v242, v105, v106
s_waitcnt lgkmcnt(4)
v_mfma_f32_32x32x16_bf16 v[0:15], v[192:195], v[176:179], v[0:15]
v_exp_f32 v84, v84
v_add_f32 v241, v241, v83
ds_read_b64_tr_b16 v[204:205], v235 offset:0
ds_read_b64_tr_b16 v[206:207], v235 offset:2048
v_cvt_pk_bf16_f32 v185, v82, v83
v_max3_f32 v242, v242, v107, v108
s_waitcnt lgkmcnt(4)
v_mfma_f32_32x32x16_bf16 v[16:31], v[196:199], v[176:179], v[16:31]
v_exp_f32 v85, v85
v_add_f32 v238, v238, v84
ds_read_b64_tr_b16 v[192:193], v232 offset:4096
ds_read_b64_tr_b16 v[194:195], v232 offset:6144
v_exp_f32 v86, v86
v_max3_f32 v242, v242, v109, v110
s_waitcnt lgkmcnt(4)
v_mfma_f32_32x32x16_bf16 v[32:47], v[200:203], v[176:179], v[32:47]
v_exp_f32 v87, v87
v_add_f32 v239, v239, v85
ds_read_b64_tr_b16 v[196:197], v233 offset:4096
ds_read_b64_tr_b16 v[198:199], v233 offset:6144
v_add_f32 v240, v240, v86
v_cvt_pk_bf16_f32 v186, v84, v85
s_waitcnt lgkmcnt(4)
v_mfma_f32_32x32x16_bf16 v[48:63], v[204:207], v[176:179], v[48:63]
v_exp_f32 v88, v88
v_add_f32 v241, v241, v87
ds_read_b64_tr_b16 v[200:201], v234 offset:4096
ds_read_b64_tr_b16 v[202:203], v234 offset:6144
v_cvt_pk_bf16_f32 v187, v86, v87
v_max3_f32 v242, v242, v111, v112
s_waitcnt lgkmcnt(4)
v_mfma_f32_32x32x16_bf16 v[0:15], v[192:195], v[180:183], v[0:15]
v_exp_f32 v89, v89
v_add_f32 v238, v238, v88
ds_read_b64_tr_b16 v[204:205], v235 offset:4096
ds_read_b64_tr_b16 v[206:207], v235 offset:6144
v_max3_f32 v242, v242, v113, v114
s_waitcnt lgkmcnt(4)
v_mfma_f32_32x32x16_bf16 v[16:31], v[196:199], v[180:183], v[16:31]
v_exp_f32 v90, v90
v_add_f32 v239, v239, v89
v_exp_f32 v91, v91
ds_read_b64_tr_b16 v[192:193], v232 offset:8192
ds_read_b64_tr_b16 v[194:195], v232 offset:10240
v_cvt_pk_bf16_f32 v188, v88, v89
v_max3_f32 v242, v242, v115, v116
s_waitcnt lgkmcnt(4)
v_mfma_f32_32x32x16_bf16 v[32:47], v[200:203], v[180:183], v[32:47]
v_exp_f32 v92, v92
v_add_f32 v240, v240, v90
v_add_f32 v241, v241, v91
ds_read_b64_tr_b16 v[196:197], v233 offset:8192
ds_read_b64_tr_b16 v[198:199], v233 offset:10240
v_cvt_pk_bf16_f32 v189, v90, v91
v_max3_f32 v242, v242, v117, v118
s_waitcnt lgkmcnt(4)
v_mfma_f32_32x32x16_bf16 v[48:63], v[204:207], v[180:183], v[48:63]
v_exp_f32 v93, v93
v_add_f32 v238, v238, v92
ds_read_b64_tr_b16 v[200:201], v234 offset:8192
ds_read_b64_tr_b16 v[202:203], v234 offset:10240
v_max3_f32 v242, v242, v119, v120
s_waitcnt lgkmcnt(4)
v_mfma_f32_32x32x16_bf16 v[0:15], v[192:195], v[184:187], v[0:15]
v_exp_f32 v94, v94
v_add_f32 v239, v239, v93
ds_read_b64_tr_b16 v[204:205], v235 offset:8192
ds_read_b64_tr_b16 v[206:207], v235 offset:10240
v_cvt_pk_bf16_f32 v190, v92, v93
v_max3_f32 v242, v242, v121, v122
s_waitcnt lgkmcnt(4)
v_mfma_f32_32x32x16_bf16 v[16:31], v[196:199], v[184:187], v[16:31]
v_exp_f32 v95, v95
v_add_f32 v240, v240, v94
ds_read_b64_tr_b16 v[192:193], v232 offset:12288
ds_read_b64_tr_b16 v[194:195], v232 offset:14336
v_max3_f32 v242, v242, v123, v124
s_waitcnt lgkmcnt(4)
v_mfma_f32_32x32x16_bf16 v[32:47], v[200:203], v[184:187], v[32:47]
v_add_f32 v241, v241, v95
v_cvt_pk_bf16_f32 v191, v94, v95
ds_read_b64_tr_b16 v[196:197], v233 offset:12288
ds_read_b64_tr_b16 v[198:199], v233 offset:14336
v_max3_f32 v242, v242, v125, v126
s_waitcnt lgkmcnt(4)
v_mfma_f32_32x32x16_bf16 v[48:63], v[204:207], v[184:187], v[48:63]
v_max3_f32 v242, v242, v127, v127
ds_read_b64_tr_b16 v[200:201], v234 offset:12288
ds_read_b64_tr_b16 v[202:203], v234 offset:14336
s_waitcnt lgkmcnt(4)
v_mfma_f32_32x32x16_bf16 v[0:15], v[192:195], v[188:191], v[0:15]
v_mov_b32 v243, v242
ds_read_b64_tr_b16 v[204:205], v235 offset:12288
ds_read_b64_tr_b16 v[206:207], v235 offset:14336
s_waitcnt lgkmcnt(4)
v_mfma_f32_32x32x16_bf16 v[16:31], v[196:199], v[188:191], v[16:31]
v_permlane32_swap_b32 v242, v243
s_barrier
ds_read_b128 v[192:195], v224 offset:32768
s_waitcnt lgkmcnt(3)
v_mfma_f32_32x32x16_bf16 v[32:47], v[200:203], v[188:191], v[32:47]
v_max_f32 v242, v242, v243
ds_read_b128 v[196:199], v225 offset:32768
v_cmp_lt_f32 vcc, s57, v242
s_waitcnt lgkmcnt(2)
v_mfma_f32_32x32x16_bf16 v[48:63], v[204:207], v[188:191], v[48:63]
ds_read_b128 v[200:203], v226 offset:32768
s_cbranch_vccnz RESC0
BACK0:
s_waitcnt lgkmcnt(2)
v_mfma_f32_32x32x16_bf16 v[64:79], v[192:195], v[144:147], v[128:143]
v_exp_f32 v96, v96
ds_read_b128 v[204:207], v227 offset:32768
v_exp_f32 v97, v97
s_waitcnt lgkmcnt(2)
v_mfma_f32_32x32x16_bf16 v[64:79], v[196:199], v[148:151], v[64:79]
v_exp_f32 v98, v98
v_add_f32 v238, v238, v96
ds_read_b128 v[192:195], v228 offset:32768
v_add_f32 v239, v239, v97
v_cvt_pk_bf16_f32 v176, v96, v97
s_waitcnt lgkmcnt(2)
v_mfma_f32_32x32x16_bf16 v[64:79], v[200:203], v[152:155], v[64:79]
v_exp_f32 v99, v99
ds_read_b128 v[196:199], v229 offset:32768
v_add_f32 v240, v240, v98
s_waitcnt lgkmcnt(2)
v_mfma_f32_32x32x16_bf16 v[64:79], v[204:207], v[156:159], v[64:79]
v_exp_f32 v100, v100
v_add_f32 v241, v241, v99
ds_read_b128 v[200:203], v230 offset:32768
v_cvt_pk_bf16_f32 v177, v98, v99
s_waitcnt lgkmcnt(2)
v_mfma_f32_32x32x16_bf16 v[64:79], v[192:195], v[160:163], v[64:79]
v_exp_f32 v101, v101
v_add_f32 v238, v238, v100
ds_read_b128 v[204:207], v231 offset:32768
v_exp_f32 v102, v102
s_waitcnt lgkmcnt(2)
v_mfma_f32_32x32x16_bf16 v[64:79], v[196:199], v[164:167], v[64:79]
v_exp_f32 v103, v103
v_add_f32 v239, v239, v101
ds_read_b128 v[192:195], v224 offset:40960
v_add_f32 v240, v240, v102
v_cvt_pk_bf16_f32 v178, v100, v101
s_waitcnt lgkmcnt(2)
v_mfma_f32_32x32x16_bf16 v[64:79], v[200:203], v[168:171], v[64:79]
v_exp_f32 v104, v104
v_add_f32 v241, v241, v103
ds_read_b128 v[196:199], v225 offset:40960
v_cvt_pk_bf16_f32 v179, v102, v103
s_waitcnt lgkmcnt(2)
v_mfma_f32_32x32x16_bf16 v[64:79], v[204:207], v[172:175], v[64:79]
v_exp_f32 v105, v105
ds_read_b128 v[200:203], v226 offset:40960
v_add_f32 v238, v238, v104
s_waitcnt lgkmcnt(2)
v_mfma_f32_32x32x16_bf16 v[80:95], v[192:195], v[144:147], v[128:143]
v_exp_f32 v106, v106
v_add_f32 v239, v239, v105
ds_read_b128 v[204:207], v227 offset:40960
v_exp_f32 v107, v107
v_cvt_pk_bf16_f32 v180, v104, v105
s_waitcnt lgkmcnt(2)
v_mfma_f32_32x32x16_bf16 v[80:95], v[196:199], v[148:151], v[80:95]
v_exp_f32 v108, v108
v_add_f32 v240, v240, v106
ds_read_b128 v[192:195], v228 offset:40960
v_add_f32 v241, v241, v107
v_cvt_pk_bf16_f32 v181, v106, v107
s_waitcnt lgkmcnt(2)
v_mfma_f32_32x32x16_bf16 v[80:95], v[200:203], v[152:155], v[80:95]
v_exp_f32 v109, v109
ds_read_b128 v[196:199], v229 offset:40960
v_add_f32 v238, v238, v108
s_waitcnt lgkmcnt(2)
v_mfma_f32_32x32x16_bf16 v[80:95], v[204:207], v[156:159], v[80:95]
v_exp_f32 v110, v110
v_add_f32 v239, v239, v109
ds_read_b128 v[200:203], v230 offset:40960
v_cvt_pk_bf16_f32 v182, v108, v109
v_max3_f32 v242, v64, v65, v66
s_waitcnt lgkmcnt(2)
v_mfma_f32_32x32x16_bf16 v[80:95], v[192:195], v[160:163], v[80:95]
v_exp_f32 v111, v111
v_add_f32 v240, v240, v110
ds_read_b128 v[204:207], v231 offset:40960
v_max3_f32 v242, v242, v67, v68
s_waitcnt lgkmcnt(2)
v_mfma_f32_32x32x16_bf16 v[80:95], v[196:199], v[164:167], v[80:95]
v_exp_f32 v112, v112
v_add_f32 v241, v241, v111
v_exp_f32 v113, v113
ds_read_b64_tr_b16 v[192:193], v232 offset:16384
ds_read_b64_tr_b16 v[194:195], v232 offset:18432
v_cvt_pk_bf16_f32 v183, v110, v111
v_max3_f32 v242, v242, v69, v70
s_waitcnt lgkmcnt(3)
v_mfma_f32_32x32x16_bf16 v[80:95], v[200:203], v[168:171], v[80:95]
v_exp_f32 v114, v114
v_add_f32 v238, v238, v112
v_add_f32 v239, v239, v113
ds_read_b64_tr_b16 v[196:197], v233 offset:16384
ds_read_b64_tr_b16 v[198:199], v233 offset:18432
v_cvt_pk_bf16_f32 v184, v112, v113
v_max3_f32 v242, v242, v71, v72
s_waitcnt lgkmcnt(4)
v_mfma_f32_32x32x16_bf16 v[80:95], v[204:207], v[172:175], v[80:95]
v_exp_f32 v115, v115
v_add_f32 v240, v240, v114
ds_read_b64_tr_b16 v[200:201], v234 offset:16384
ds_read_b64_tr_b16 v[202:203], v234 offset:18432
v_max3_f32 v242, v242, v73, v74
s_waitcnt lgkmcnt(4)
v_mfma_f32_32x32x16_bf16 v[0:15], v[192:195], v[176:179], v[0:15]
v_exp_f32 v116, v116
v_add_f32 v241, v241, v115
ds_read_b64_tr_b16 v[204:205], v235 offset:16384
ds_read_b64_tr_b16 v[206:207], v235 offset:18432
v_cvt_pk_bf16_f32 v185, v114, v115
v_max3_f32 v242, v242, v75, v76
s_waitcnt lgkmcnt(4)
v_mfma_f32_32x32x16_bf16 v[16:31], v[196:199], v[176:179], v[16:31]
v_exp_f32 v117, v117
v_add_f32 v238, v238, v116
ds_read_b64_tr_b16 v[192:193], v232 offset:20480
ds_read_b64_tr_b16 v[194:195], v232 offset:22528
v_exp_f32 v118, v118
v_max3_f32 v242, v242, v77, v78
s_waitcnt lgkmcnt(4)
v_mfma_f32_32x32x16_bf16 v[32:47], v[200:203], v[176:179], v[32:47]
v_exp_f32 v119, v119
v_add_f32 v239, v239, v117
ds_read_b64_tr_b16 v[196:197], v233 offset:20480
ds_read_b64_tr_b16 v[198:199], v233 offset:22528
v_add_f32 v240, v240, v118
v_cvt_pk_bf16_f32 v186, v116, v117
s_waitcnt lgkmcnt(4)
v_mfma_f32_32x32x16_bf16 v[48:63], v[204:207], v[176:179], v[48:63]
v_exp_f32 v120, v120
v_add_f32 v241, v241, v119
ds_read_b64_tr_b16 v[200:201], v234 offset:20480
ds_read_b64_tr_b16 v[202:203], v234 offset:22528
v_cvt_pk_bf16_f32 v187, v118, v119
v_max3_f32 v242, v242, v79, v80
s_waitcnt lgkmcnt(4)
v_mfma_f32_32x32x16_bf16 v[0:15], v[192:195], v[180:183], v[0:15]
v_exp_f32 v121, v121
v_add_f32 v238, v238, v120
ds_read_b64_tr_b16 v[204:205], v235 offset:20480
ds_read_b64_tr_b16 v[206:207], v235 offset:22528
v_max3_f32 v242, v242, v81, v82
s_waitcnt lgkmcnt(4)
v_mfma_f32_32x32x16_bf16 v[16:31], v[196:199], v[180:183], v[16:31]
v_exp_f32 v122, v122
v_add_f32 v239, v239, v121
v_exp_f32 v123, v123
ds_read_b64_tr_b16 v[192:193], v232 offset:24576
ds_read_b64_tr_b16 v[194:195], v232 offset:26624
v_cvt_pk_bf16_f32 v188, v120, v121
v_max3_f32 v242, v242, v83, v84
s_waitcnt lgkmcnt(4)
v_mfma_f32_32x32x16_bf16 v[32:47], v[200:203], v[180:183], v[32:47]
v_exp_f32 v124, v124
v_add_f32 v240, v240, v122
v_add_f32 v241, v241, v123
ds_read_b64_tr_b16 v[196:197], v233 offset:24576
ds_read_b64_tr_b16 v[198:199], v233 offset:26624
v_cvt_pk_bf16_f32 v189, v122, v123
v_max3_f32 v242, v242, v85, v86
s_waitcnt lgkmcnt(4)
v_mfma_f32_32x32x16_bf16 v[48:63], v[204:207], v[180:183], v[48:63]
v_exp_f32 v125, v125
v_add_f32 v238, v238, v124
ds_read_b64_tr_b16 v[200:201], v234 offset:24576
ds_read_b64_tr_b16 v[202:203], v234 offset:26624
v_max3_f32 v242, v242, v87, v88
s_waitcnt lgkmcnt(4)
v_mfma_f32_32x32x16_bf16 v[0:15], v[192:195], v[184:187], v[0:15]
v_exp_f32 v126, v126
v_add_f32 v239, v239, v125
ds_read_b64_tr_b16 v[204:205], v235 offset:24576
ds_read_b64_tr_b16 v[206:207], v235 offset:26624
v_cvt_pk_bf16_f32 v190, v124, v125
v_max3_f32 v242, v242, v89, v90
s_waitcnt lgkmcnt(4)
v_mfma_f32_32x32x16_bf16 v[16:31], v[196:199], v[184:187], v[16:31]
v_exp_f32 v127, v127
v_add_f32 v240, v240, v126
ds_read_b64_tr_b16 v[192:193], v232 offset:28672
ds_read_b64_tr_b16 v[194:195], v232 offset:30720
v_max3_f32 v242, v242, v91, v92
s_waitcnt lgkmcnt(4)
v_mfma_f32_32x32x16_bf16 v[32:47], v[200:203], v[184:187], v[32:47]
v_add_f32 v241, v241, v127
v_cvt_pk_bf16_f32 v191, v126, v127
ds_read_b64_tr_b16 v[196:197], v233 offset:28672
ds_read_b64_tr_b16 v[198:199], v233 offset:30720
v_max3_f32 v242, v242, v93, v94
s_waitcnt lgkmcnt(4)
v_mfma_f32_32x32x16_bf16 v[48:63], v[204:207], v[184:187], v[48:63]
v_max3_f32 v242, v242, v95, v95
ds_read_b64_tr_b16 v[200:201], v234 offset:28672
ds_read_b64_tr_b16 v[202:203], v234 offset:30720
s_waitcnt lgkmcnt(4)
v_mfma_f32_32x32x16_bf16 v[0:15], v[192:195], v[188:191], v[0:15]
v_mov_b32 v243, v242
ds_read_b64_tr_b16 v[204:205], v235 offset:28672
ds_read_b64_tr_b16 v[206:207], v235 offset:30720
s_waitcnt lgkmcnt(4)
v_mfma_f32_32x32x16_bf16 v[16:31], v[196:199], v[188:191], v[16:31]
v_permlane32_swap_b32 v242, v243
s_barrier
ds_read_b128 v[192:195], v224 offset:49152
s_waitcnt lgkmcnt(3)
v_mfma_f32_32x32x16_bf16 v[32:47], v[200:203], v[188:191], v[32:47]
v_max_f32 v242, v242, v243
ds_read_b128 v[196:199], v225 offset:49152
v_cmp_lt_f32 vcc, s57, v242
s_waitcnt lgkmcnt(2)
v_mfma_f32_32x32x16_bf16 v[48:63], v[204:207], v[188:191], v[48:63]
ds_read_b128 v[200:203], v226 offset:49152
s_cbranch_vccnz RESC1
BACK1:
s_waitcnt lgkmcnt(2)
v_mfma_f32_32x32x16_bf16 v[96:111], v[192:195], v[144:147], v[128:143]
v_exp_f32 v64, v64
ds_read_b128 v[204:207], v227 offset:49152
v_exp_f32 v65, v65
s_waitcnt lgkmcnt(2)
v_mfma_f32_32x32x16_bf16 v[96:111], v[196:199], v[148:151], v[96:111]
v_exp_f32 v66, v66
v_add_f32 v238, v238, v64
ds_read_b128 v[192:195], v228 offset:49152
v_add_f32 v239, v239, v65
v_cvt_pk_bf16_f32 v176, v64, v65
s_waitcnt lgkmcnt(2)
v_mfma_f32_32x32x16_bf16 v[96:111], v[200:203], v[152:155], v[96:111]
v_exp_f32 v67, v67
ds_read_b128 v[196:199], v229 offset:49152
v_add_f32 v240, v240, v66
s_waitcnt lgkmcnt(2)
v_mfma_f32_32x32x16_bf16 v[96:111], v[204:207], v[156:159], v[96:111]
v_exp_f32 v68, v68
v_add_f32 v241, v241, v67
ds_read_b128 v[200:203], v230 offset:49152
v_cvt_pk_bf16_f32 v177, v66, v67
s_waitcnt lgkmcnt(2)
v_mfma_f32_32x32x16_bf16 v[96:111], v[192:195], v[160:163], v[96:111]
v_exp_f32 v69, v69
v_add_f32 v238, v238, v68
ds_read_b128 v[204:207], v231 offset:49152
v_exp_f32 v70, v70
s_waitcnt lgkmcnt(2)
v_mfma_f32_32x32x16_bf16 v[96:111], v[196:199], v[164:167], v[96:111]
v_exp_f32 v71, v71
v_add_f32 v239, v239, v69
ds_read_b128 v[192:195], v224 offset:57344
v_add_f32 v240, v240, v70
v_cvt_pk_bf16_f32 v178, v68, v69
s_waitcnt lgkmcnt(2)
v_mfma_f32_32x32x16_bf16 v[96:111], v[200:203], v[168:171], v[96:111]
v_exp_f32 v72, v72
v_add_f32 v241, v241, v71
ds_read_b128 v[196:199], v225 offset:57344
v_cvt_pk_bf16_f32 v179, v70, v71
s_waitcnt lgkmcnt(2)
v_mfma_f32_32x32x16_bf16 v[96:111], v[204:207], v[172:175], v[96:111]
v_exp_f32 v73, v73
ds_read_b128 v[200:203], v226 offset:57344
v_add_f32 v238, v238, v72
s_waitcnt lgkmcnt(2)
v_mfma_f32_32x32x16_bf16 v[112:127], v[192:195], v[144:147], v[128:143]
v_exp_f32 v74, v74
v_add_f32 v239, v239, v73
ds_read_b128 v[204:207], v227 offset:57344
v_exp_f32 v75, v75
v_cvt_pk_bf16_f32 v180, v72, v73
s_waitcnt lgkmcnt(2)
v_mfma_f32_32x32x16_bf16 v[112:127], v[196:199], v[148:151], v[112:127]
v_exp_f32 v76, v76
v_add_f32 v240, v240, v74
ds_read_b128 v[192:195], v228 offset:57344
v_add_f32 v241, v241, v75
v_cvt_pk_bf16_f32 v181, v74, v75
s_waitcnt lgkmcnt(2)
v_mfma_f32_32x32x16_bf16 v[112:127], v[200:203], v[152:155], v[112:127]
v_exp_f32 v77, v77
ds_read_b128 v[196:199], v229 offset:57344
v_add_f32 v238, v238, v76
s_waitcnt lgkmcnt(2)
v_mfma_f32_32x32x16_bf16 v[112:127], v[204:207], v[156:159], v[112:127]
v_exp_f32 v78, v78
v_add_f32 v239, v239, v77
ds_read_b128 v[200:203], v230 offset:57344
v_cvt_pk_bf16_f32 v182, v76, v77
v_max3_f32 v242, v96, v97, v98
s_waitcnt lgkmcnt(2)
v_mfma_f32_32x32x16_bf16 v[112:127], v[192:195], v[160:163], v[112:127]
v_exp_f32 v79, v79
v_add_f32 v240, v240, v78
ds_read_b128 v[204:207], v231 offset:57344
v_max3_f32 v242, v242, v99, v100
s_waitcnt lgkmcnt(2)
v_mfma_f32_32x32x16_bf16 v[112:127], v[196:199], v[164:167], v[112:127]
v_exp_f32 v80, v80
v_add_f32 v241, v241, v79
v_exp_f32 v81, v81
ds_read_b64_tr_b16 v[192:193], v232 offset:32768
ds_read_b64_tr_b16 v[194:195], v232 offset:34816
v_cvt_pk_bf16_f32 v183, v78, v79
v_max3_f32 v242, v242, v101, v102
s_waitcnt lgkmcnt(3)
v_mfma_f32_32x32x16_bf16 v[112:127], v[200:203], v[168:171], v[112:127]
v_exp_f32 v82, v82
v_add_f32 v238, v238, v80
v_add_f32 v239, v239, v81
ds_read_b64_tr_b16 v[196:197], v233 offset:32768
ds_read_b64_tr_b16 v[198:199], v233 offset:34816
v_cvt_pk_bf16_f32 v184, v80, v81
v_max3_f32 v242, v242, v103, v104
s_waitcnt lgkmcnt(4)
v_mfma_f32_32x32x16_bf16 v[112:127], v[204:207], v[172:175], v[112:127]
v_exp_f32 v83, v83
v_add_f32 v240, v240, v82
ds_read_b64_tr_b16 v[200:201], v234 offset:32768
ds_read_b64_tr_b16 v[202:203], v234 offset:34816
v_max3_f32 v242, v242, v105, v106
s_waitcnt lgkmcnt(4)
v_mfma_f32_32x32x16_bf16 v[0:15], v[192:195], v[176:179], v[0:15]
v_exp_f32 v84, v84
v_add_f32 v241, v241, v83
ds_read_b64_tr_b16 v[204:205], v235 offset:32768
ds_read_b64_tr_b16 v[206:207], v235 offset:34816
v_cvt_pk_bf16_f32 v185, v82, v83
v_max3_f32 v242, v242, v107, v108
s_waitcnt lgkmcnt(4)
v_mfma_f32_32x32x16_bf16 v[16:31], v[196:199], v[176:179], v[16:31]
v_exp_f32 v85, v85
v_add_f32 v238, v238, v84
ds_read_b64_tr_b16 v[192:193], v232 offset:36864
ds_read_b64_tr_b16 v[194:195], v232 offset:38912
v_exp_f32 v86, v86
v_max3_f32 v242, v242, v109, v110
s_waitcnt lgkmcnt(4)
v_mfma_f32_32x32x16_bf16 v[32:47], v[200:203], v[176:179], v[32:47]
v_exp_f32 v87, v87
v_add_f32 v239, v239, v85
ds_read_b64_tr_b16 v[196:197], v233 offset:36864
ds_read_b64_tr_b16 v[198:199], v233 offset:38912
v_add_f32 v240, v240, v86
v_cvt_pk_bf16_f32 v186, v84, v85
s_waitcnt lgkmcnt(4)
v_mfma_f32_32x32x16_bf16 v[48:63], v[204:207], v[176:179], v[48:63]
v_exp_f32 v88, v88
v_add_f32 v241, v241, v87
ds_read_b64_tr_b16 v[200:201], v234 offset:36864
ds_read_b64_tr_b16 v[202:203], v234 offset:38912
v_cvt_pk_bf16_f32 v187, v86, v87
v_max3_f32 v242, v242, v111, v112
s_waitcnt lgkmcnt(4)
v_mfma_f32_32x32x16_bf16 v[0:15], v[192:195], v[180:183], v[0:15]
v_exp_f32 v89, v89
v_add_f32 v238, v238, v88
ds_read_b64_tr_b16 v[204:205], v235 offset:36864
ds_read_b64_tr_b16 v[206:207], v235 offset:38912
v_max3_f32 v242, v242, v113, v114
s_waitcnt lgkmcnt(4)
v_mfma_f32_32x32x16_bf16 v[16:31], v[196:199], v[180:183], v[16:31]
v_exp_f32 v90, v90
v_add_f32 v239, v239, v89
v_exp_f32 v91, v91
ds_read_b64_tr_b16 v[192:193], v232 offset:40960
ds_read_b64_tr_b16 v[194:195], v232 offset:43008
v_cvt_pk_bf16_f32 v188, v88, v89
v_max3_f32 v242, v242, v115, v116
s_waitcnt lgkmcnt(4)
v_mfma_f32_32x32x16_bf16 v[32:47], v[200:203], v[180:183], v[32:47]
v_exp_f32 v92, v92
v_add_f32 v240, v240, v90
v_add_f32 v241, v241, v91
ds_read_b64_tr_b16 v[196:197], v233 offset:40960
ds_read_b64_tr_b16 v[198:199], v233 offset:43008
v_cvt_pk_bf16_f32 v189, v90, v91
v_max3_f32 v242, v242, v117, v118
s_waitcnt lgkmcnt(4)
v_mfma_f32_32x32x16_bf16 v[48:63], v[204:207], v[180:183], v[48:63]
v_exp_f32 v93, v93
v_add_f32 v238, v238, v92
ds_read_b64_tr_b16 v[200:201], v234 offset:40960
ds_read_b64_tr_b16 v[202:203], v234 offset:43008
v_max3_f32 v242, v242, v119, v120
s_waitcnt lgkmcnt(4)
v_mfma_f32_32x32x16_bf16 v[0:15], v[192:195], v[184:187], v[0:15]
v_exp_f32 v94, v94
v_add_f32 v239, v239, v93
ds_read_b64_tr_b16 v[204:205], v235 offset:40960
ds_read_b64_tr_b16 v[206:207], v235 offset:43008
v_cvt_pk_bf16_f32 v190, v92, v93
v_max3_f32 v242, v242, v121, v122
s_waitcnt lgkmcnt(4)
v_mfma_f32_32x32x16_bf16 v[16:31], v[196:199], v[184:187], v[16:31]
v_exp_f32 v95, v95
v_add_f32 v240, v240, v94
ds_read_b64_tr_b16 v[192:193], v232 offset:45056
ds_read_b64_tr_b16 v[194:195], v232 offset:47104
v_max3_f32 v242, v242, v123, v124
s_waitcnt lgkmcnt(4)
v_mfma_f32_32x32x16_bf16 v[32:47], v[200:203], v[184:187], v[32:47]
v_add_f32 v241, v241, v95
v_cvt_pk_bf16_f32 v191, v94, v95
ds_read_b64_tr_b16 v[196:197], v233 offset:45056
ds_read_b64_tr_b16 v[198:199], v233 offset:47104
v_max3_f32 v242, v242, v125, v126
s_waitcnt lgkmcnt(4)
v_mfma_f32_32x32x16_bf16 v[48:63], v[204:207], v[184:187], v[48:63]
v_max3_f32 v242, v242, v127, v127
ds_read_b64_tr_b16 v[200:201], v234 offset:45056
ds_read_b64_tr_b16 v[202:203], v234 offset:47104
s_waitcnt lgkmcnt(4)
v_mfma_f32_32x32x16_bf16 v[0:15], v[192:195], v[188:191], v[0:15]
v_mov_b32 v243, v242
ds_read_b64_tr_b16 v[204:205], v235 offset:45056
ds_read_b64_tr_b16 v[206:207], v235 offset:47104
s_waitcnt lgkmcnt(4)
v_mfma_f32_32x32x16_bf16 v[16:31], v[196:199], v[188:191], v[16:31]
v_permlane32_swap_b32 v242, v243
s_barrier
ds_read_b128 v[192:195], v224 offset:0
s_waitcnt lgkmcnt(3)
v_mfma_f32_32x32x16_bf16 v[32:47], v[200:203], v[188:191], v[32:47]
v_max_f32 v242, v242, v243
ds_read_b128 v[196:199], v225 offset:0
v_cmp_lt_f32 vcc, s57, v242
s_waitcnt lgkmcnt(2)
v_mfma_f32_32x32x16_bf16 v[48:63], v[204:207], v[188:191], v[48:63]
ds_read_b128 v[200:203], v226 offset:0
s_cbranch_vccnz RESC2
BACK2:
s_waitcnt lgkmcnt(2)
v_mfma_f32_32x32x16_bf16 v[64:79], v[192:195], v[144:147], v[128:143]
v_exp_f32 v96, v96
ds_read_b128 v[204:207], v227 offset:0
v_exp_f32 v97, v97
s_waitcnt lgkmcnt(2)
v_mfma_f32_32x32x16_bf16 v[64:79], v[196:199], v[148:151], v[64:79]
v_exp_f32 v98, v98
v_add_f32 v238, v238, v96
ds_read_b128 v[192:195], v228 offset:0
v_add_f32 v239, v239, v97
v_cvt_pk_bf16_f32 v176, v96, v97
s_waitcnt lgkmcnt(2)
v_mfma_f32_32x32x16_bf16 v[64:79], v[200:203], v[152:155], v[64:79]
v_exp_f32 v99, v99
ds_read_b128 v[196:199], v229 offset:0
v_add_f32 v240, v240, v98
s_waitcnt lgkmcnt(2)
v_mfma_f32_32x32x16_bf16 v[64:79], v[204:207], v[156:159], v[64:79]
v_exp_f32 v100, v100
v_add_f32 v241, v241, v99
ds_read_b128 v[200:203], v230 offset:0
v_cvt_pk_bf16_f32 v177, v98, v99
s_waitcnt lgkmcnt(2)
v_mfma_f32_32x32x16_bf16 v[64:79], v[192:195], v[160:163], v[64:79]
v_exp_f32 v101, v101
v_add_f32 v238, v238, v100
ds_read_b128 v[204:207], v231 offset:0
v_exp_f32 v102, v102
s_waitcnt lgkmcnt(2)
v_mfma_f32_32x32x16_bf16 v[64:79], v[196:199], v[164:167], v[64:79]
v_exp_f32 v103, v103
v_add_f32 v239, v239, v101
ds_read_b128 v[192:195], v224 offset:8192
v_add_f32 v240, v240, v102
v_cvt_pk_bf16_f32 v178, v100, v101
s_waitcnt lgkmcnt(2)
v_mfma_f32_32x32x16_bf16 v[64:79], v[200:203], v[168:171], v[64:79]
v_exp_f32 v104, v104
v_add_f32 v241, v241, v103
ds_read_b128 v[196:199], v225 offset:8192
v_cvt_pk_bf16_f32 v179, v102, v103
s_waitcnt lgkmcnt(2)
v_mfma_f32_32x32x16_bf16 v[64:79], v[204:207], v[172:175], v[64:79]
v_exp_f32 v105, v105
ds_read_b128 v[200:203], v226 offset:8192
v_add_f32 v238, v238, v104
s_waitcnt lgkmcnt(2)
v_mfma_f32_32x32x16_bf16 v[80:95], v[192:195], v[144:147], v[128:143]
v_exp_f32 v106, v106
v_add_f32 v239, v239, v105
ds_read_b128 v[204:207], v227 offset:8192
v_exp_f32 v107, v107
v_cvt_pk_bf16_f32 v180, v104, v105
s_waitcnt lgkmcnt(2)
v_mfma_f32_32x32x16_bf16 v[80:95], v[196:199], v[148:151], v[80:95]
v_exp_f32 v108, v108
v_add_f32 v240, v240, v106
ds_read_b128 v[192:195], v228 offset:8192
v_add_f32 v241, v241, v107
v_cvt_pk_bf16_f32 v181, v106, v107
s_waitcnt lgkmcnt(2)
v_mfma_f32_32x32x16_bf16 v[80:95], v[200:203], v[152:155], v[80:95]
v_exp_f32 v109, v109
ds_read_b128 v[196:199], v229 offset:8192
v_add_f32 v238, v238, v108
s_waitcnt lgkmcnt(2)
v_mfma_f32_32x32x16_bf16 v[80:95], v[204:207], v[156:159], v[80:95]
v_exp_f32 v110, v110
v_add_f32 v239, v239, v109
ds_read_b128 v[200:203], v230 offset:8192
v_cvt_pk_bf16_f32 v182, v108, v109
v_max3_f32 v242, v64, v65, v66
s_waitcnt lgkmcnt(2)
v_mfma_f32_32x32x16_bf16 v[80:95], v[192:195], v[160:163], v[80:95]
v_exp_f32 v111, v111
v_add_f32 v240, v240, v110
ds_read_b128 v[204:207], v231 offset:8192
v_max3_f32 v242, v242, v67, v68
s_waitcnt lgkmcnt(2)
v_mfma_f32_32x32x16_bf16 v[80:95], v[196:199], v[164:167], v[80:95]
v_exp_f32 v112, v112
v_add_f32 v241, v241, v111
v_exp_f32 v113, v113
ds_read_b64_tr_b16 v[192:193], v232 offset:49152
ds_read_b64_tr_b16 v[194:195], v232 offset:51200
v_cvt_pk_bf16_f32 v183, v110, v111
v_max3_f32 v242, v242, v69, v70
s_waitcnt lgkmcnt(3)
v_mfma_f32_32x32x16_bf16 v[80:95], v[200:203], v[168:171], v[80:95]
v_exp_f32 v114, v114
v_add_f32 v238, v238, v112
v_add_f32 v239, v239, v113
ds_read_b64_tr_b16 v[196:197], v233 offset:49152
ds_read_b64_tr_b16 v[198:199], v233 offset:51200
v_cvt_pk_bf16_f32 v184, v112, v113
v_max3_f32 v242, v242, v71, v72
s_waitcnt lgkmcnt(4)
v_mfma_f32_32x32x16_bf16 v[80:95], v[204:207], v[172:175], v[80:95]
v_exp_f32 v115, v115
v_add_f32 v240, v240, v114
ds_read_b64_tr_b16 v[200:201], v234 offset:49152
ds_read_b64_tr_b16 v[202:203], v234 offset:51200
v_max3_f32 v242, v242, v73, v74
s_waitcnt lgkmcnt(4)
v_mfma_f32_32x32x16_bf16 v[0:15], v[192:195], v[176:179], v[0:15]
v_exp_f32 v116, v116
v_add_f32 v241, v241, v115
ds_read_b64_tr_b16 v[204:205], v235 offset:49152
ds_read_b64_tr_b16 v[206:207], v235 offset:51200
v_cvt_pk_bf16_f32 v185, v114, v115
v_max3_f32 v242, v242, v75, v76
s_waitcnt lgkmcnt(4)
v_mfma_f32_32x32x16_bf16 v[16:31], v[196:199], v[176:179], v[16:31]
v_exp_f32 v117, v117
v_add_f32 v238, v238, v116
ds_read_b64_tr_b16 v[192:193], v232 offset:53248
ds_read_b64_tr_b16 v[194:195], v232 offset:55296
v_exp_f32 v118, v118
v_max3_f32 v242, v242, v77, v78
s_waitcnt lgkmcnt(4)
v_mfma_f32_32x32x16_bf16 v[32:47], v[200:203], v[176:179], v[32:47]
v_exp_f32 v119, v119
v_add_f32 v239, v239, v117
ds_read_b64_tr_b16 v[196:197], v233 offset:53248
ds_read_b64_tr_b16 v[198:199], v233 offset:55296
v_add_f32 v240, v240, v118
v_cvt_pk_bf16_f32 v186, v116, v117
s_waitcnt lgkmcnt(4)
v_mfma_f32_32x32x16_bf16 v[48:63], v[204:207], v[176:179], v[48:63]
v_exp_f32 v120, v120
v_add_f32 v241, v241, v119
ds_read_b64_tr_b16 v[200:201], v234 offset:53248
ds_read_b64_tr_b16 v[202:203], v234 offset:55296
v_cvt_pk_bf16_f32 v187, v118, v119
v_max3_f32 v242, v242, v79, v80
s_waitcnt lgkmcnt(4)
v_mfma_f32_32x32x16_bf16 v[0:15], v[192:195], v[180:183], v[0:15]
v_exp_f32 v121, v121
v_add_f32 v238, v238, v120
ds_read_b64_tr_b16 v[204:205], v235 offset:53248
ds_read_b64_tr_b16 v[206:207], v235 offset:55296
v_max3_f32 v242, v242, v81, v82
s_waitcnt lgkmcnt(4)
v_mfma_f32_32x32x16_bf16 v[16:31], v[196:199], v[180:183], v[16:31]
v_exp_f32 v122, v122
v_add_f32 v239, v239, v121
v_exp_f32 v123, v123
ds_read_b64_tr_b16 v[192:193], v232 offset:57344
ds_read_b64_tr_b16 v[194:195], v232 offset:59392
v_cvt_pk_bf16_f32 v188, v120, v121
v_max3_f32 v242, v242, v83, v84
s_waitcnt lgkmcnt(4)
v_mfma_f32_32x32x16_bf16 v[32:47], v[200:203], v[180:183], v[32:47]
v_exp_f32 v124, v124
v_add_f32 v240, v240, v122
v_add_f32 v241, v241, v123
ds_read_b64_tr_b16 v[196:197], v233 offset:57344
ds_read_b64_tr_b16 v[198:199], v233 offset:59392
v_cvt_pk_bf16_f32 v189, v122, v123
v_max3_f32 v242, v242, v85, v86
s_waitcnt lgkmcnt(4)
v_mfma_f32_32x32x16_bf16 v[48:63], v[204:207], v[180:183], v[48:63]
v_exp_f32 v125, v125
v_add_f32 v238, v238, v124
ds_read_b64_tr_b16 v[200:201], v234 offset:57344
ds_read_b64_tr_b16 v[202:203], v234 offset:59392
v_max3_f32 v242, v242, v87, v88
s_waitcnt lgkmcnt(4)
v_mfma_f32_32x32x16_bf16 v[0:15], v[192:195], v[184:187], v[0:15]
v_exp_f32 v126, v126
v_add_f32 v239, v239, v125
ds_read_b64_tr_b16 v[204:205], v235 offset:57344
ds_read_b64_tr_b16 v[206:207], v235 offset:59392
v_cvt_pk_bf16_f32 v190, v124, v125
v_max3_f32 v242, v242, v89, v90
s_waitcnt lgkmcnt(4)
v_mfma_f32_32x32x16_bf16 v[16:31], v[196:199], v[184:187], v[16:31]
v_exp_f32 v127, v127
v_add_f32 v240, v240, v126
ds_read_b64_tr_b16 v[192:193], v232 offset:61440
ds_read_b64_tr_b16 v[194:195], v232 offset:63488
v_max3_f32 v242, v242, v91, v92
s_waitcnt lgkmcnt(4)
v_mfma_f32_32x32x16_bf16 v[32:47], v[200:203], v[184:187], v[32:47]
v_add_f32 v241, v241, v127
v_cvt_pk_bf16_f32 v191, v126, v127
ds_read_b64_tr_b16 v[196:197], v233 offset:61440
ds_read_b64_tr_b16 v[198:199], v233 offset:63488
v_max3_f32 v242, v242, v93, v94
s_waitcnt lgkmcnt(4)
v_mfma_f32_32x32x16_bf16 v[48:63], v[204:207], v[184:187], v[48:63]
v_max3_f32 v242, v242, v95, v95
ds_read_b64_tr_b16 v[200:201], v234 offset:61440
ds_read_b64_tr_b16 v[202:203], v234 offset:63488
s_waitcnt lgkmcnt(4)
v_mfma_f32_32x32x16_bf16 v[0:15], v[192:195], v[188:191], v[0:15]
v_mov_b32 v243, v242
ds_read_b64_tr_b16 v[204:205], v235 offset:61440
ds_read_b64_tr_b16 v[206:207], v235 offset:63488
s_waitcnt lgkmcnt(4)
v_mfma_f32_32x32x16_bf16 v[16:31], v[196:199], v[188:191], v[16:31]
v_permlane32_swap_b32 v242, v243
s_barrier
ds_read_b128 v[192:195], v224 offset:16384
s_waitcnt lgkmcnt(3)
v_mfma_f32_32x32x16_bf16 v[32:47], v[200:203], v[188:191], v[32:47]
v_max_f32 v242, v242, v243
ds_read_b128 v[196:199], v225 offset:16384
v_cmp_lt_f32 vcc, s57, v242
s_waitcnt lgkmcnt(2)
v_mfma_f32_32x32x16_bf16 v[48:63], v[204:207], v[188:191], v[48:63]
ds_read_b128 v[200:203], v226 offset:16384
s_cbranch_vccnz RESC3
BACK3:
s_add_u32 s56, s56, 1
s_cmp_lt_u32 s56, 3
s_cbranch_scc1 LOOP
s_waitcnt lgkmcnt(2)
v_mfma_f32_32x32x16_bf16 v[96:111], v[192:195], v[144:147], v[128:143]
v_exp_f32 v64, v64
ds_read_b128 v[204:207], v227 offset:16384
v_exp_f32 v65, v65
s_waitcnt lgkmcnt(2)
v_mfma_f32_32x32x16_bf16 v[96:111], v[196:199], v[148:151], v[96:111]
v_exp_f32 v66, v66
v_add_f32 v238, v238, v64
ds_read_b128 v[192:195], v228 offset:16384
v_add_f32 v239, v239, v65
v_cvt_pk_bf16_f32 v176, v64, v65
s_waitcnt lgkmcnt(2)
v_mfma_f32_32x32x16_bf16 v[96:111], v[200:203], v[152:155], v[96:111]
v_exp_f32 v67, v67
ds_read_b128 v[196:199], v229 offset:16384
v_add_f32 v240, v240, v66
s_waitcnt lgkmcnt(2)
v_mfma_f32_32x32x16_bf16 v[96:111], v[204:207], v[156:159], v[96:111]
v_exp_f32 v68, v68
v_add_f32 v241, v241, v67
ds_read_b128 v[200:203], v230 offset:16384
v_cvt_pk_bf16_f32 v177, v66, v67
s_waitcnt lgkmcnt(2)
v_mfma_f32_32x32x16_bf16 v[96:111], v[192:195], v[160:163], v[96:111]
v_exp_f32 v69, v69
v_add_f32 v238, v238, v68
ds_read_b128 v[204:207], v231 offset:16384
v_exp_f32 v70, v70
s_waitcnt lgkmcnt(2)
v_mfma_f32_32x32x16_bf16 v[96:111], v[196:199], v[164:167], v[96:111]
v_exp_f32 v71, v71
v_add_f32 v239, v239, v69
ds_read_b128 v[192:195], v224 offset:24576
v_add_f32 v240, v240, v70
v_cvt_pk_bf16_f32 v178, v68, v69
s_waitcnt lgkmcnt(2)
v_mfma_f32_32x32x16_bf16 v[96:111], v[200:203], v[168:171], v[96:111]
v_exp_f32 v72, v72
v_add_f32 v241, v241, v71
ds_read_b128 v[196:199], v225 offset:24576
v_cvt_pk_bf16_f32 v179, v70, v71
s_waitcnt lgkmcnt(2)
v_mfma_f32_32x32x16_bf16 v[96:111], v[204:207], v[172:175], v[96:111]
v_exp_f32 v73, v73
ds_read_b128 v[200:203], v226 offset:24576
v_add_f32 v238, v238, v72
s_waitcnt lgkmcnt(2)
v_mfma_f32_32x32x16_bf16 v[112:127], v[192:195], v[144:147], v[128:143]
v_exp_f32 v74, v74
v_add_f32 v239, v239, v73
ds_read_b128 v[204:207], v227 offset:24576
v_exp_f32 v75, v75
v_cvt_pk_bf16_f32 v180, v72, v73
s_waitcnt lgkmcnt(2)
v_mfma_f32_32x32x16_bf16 v[112:127], v[196:199], v[148:151], v[112:127]
v_exp_f32 v76, v76
v_add_f32 v240, v240, v74
ds_read_b128 v[192:195], v228 offset:24576
v_add_f32 v241, v241, v75
v_cvt_pk_bf16_f32 v181, v74, v75
s_waitcnt lgkmcnt(2)
v_mfma_f32_32x32x16_bf16 v[112:127], v[200:203], v[152:155], v[112:127]
v_exp_f32 v77, v77
ds_read_b128 v[196:199], v229 offset:24576
v_add_f32 v238, v238, v76
s_waitcnt lgkmcnt(2)
v_mfma_f32_32x32x16_bf16 v[112:127], v[204:207], v[156:159], v[112:127]
v_exp_f32 v78, v78
v_add_f32 v239, v239, v77
ds_read_b128 v[200:203], v230 offset:24576
v_cvt_pk_bf16_f32 v182, v76, v77
v_max3_f32 v242, v96, v97, v98
s_waitcnt lgkmcnt(2)
v_mfma_f32_32x32x16_bf16 v[112:127], v[192:195], v[160:163], v[112:127]
v_exp_f32 v79, v79
v_add_f32 v240, v240, v78
ds_read_b128 v[204:207], v231 offset:24576
v_max3_f32 v242, v242, v99, v100
s_waitcnt lgkmcnt(2)
v_mfma_f32_32x32x16_bf16 v[112:127], v[196:199], v[164:167], v[112:127]
v_exp_f32 v80, v80
v_add_f32 v241, v241, v79
v_exp_f32 v81, v81
ds_read_b64_tr_b16 v[192:193], v232 offset:0
ds_read_b64_tr_b16 v[194:195], v232 offset:2048
v_cvt_pk_bf16_f32 v183, v78, v79
v_max3_f32 v242, v242, v101, v102
s_waitcnt lgkmcnt(3)
v_mfma_f32_32x32x16_bf16 v[112:127], v[200:203], v[168:171], v[112:127]
v_exp_f32 v82, v82
v_add_f32 v238, v238, v80
v_add_f32 v239, v239, v81
ds_read_b64_tr_b16 v[196:197], v233 offset:0
ds_read_b64_tr_b16 v[198:199], v233 offset:2048
v_cvt_pk_bf16_f32 v184, v80, v81
v_max3_f32 v242, v242, v103, v104
s_waitcnt lgkmcnt(4)
v_mfma_f32_32x32x16_bf16 v[112:127], v[204:207], v[172:175], v[112:127]
v_exp_f32 v83, v83
v_add_f32 v240, v240, v82
ds_read_b64_tr_b16 v[200:201], v234 offset:0
ds_read_b64_tr_b16 v[202:203], v234 offset:2048
v_max3_f32 v242, v242, v105, v106
s_waitcnt lgkmcnt(4)
v_mfma_f32_32x32x16_bf16 v[0:15], v[192:195], v[176:179], v[0:15]
v_exp_f32 v84, v84
v_add_f32 v241, v241, v83
ds_read_b64_tr_b16 v[204:205], v235 offset:0
ds_read_b64_tr_b16 v[206:207], v235 offset:2048
v_cvt_pk_bf16_f32 v185, v82, v83
v_max3_f32 v242, v242, v107, v108
s_waitcnt lgkmcnt(4)
v_mfma_f32_32x32x16_bf16 v[16:31], v[196:199], v[176:179], v[16:31]
v_exp_f32 v85, v85
v_add_f32 v238, v238, v84
ds_read_b64_tr_b16 v[192:193], v232 offset:4096
ds_read_b64_tr_b16 v[194:195], v232 offset:6144
v_exp_f32 v86, v86
v_max3_f32 v242, v242, v109, v110
s_waitcnt lgkmcnt(4)
v_mfma_f32_32x32x16_bf16 v[32:47], v[200:203], v[176:179], v[32:47]
v_exp_f32 v87, v87
v_add_f32 v239, v239, v85
ds_read_b64_tr_b16 v[196:197], v233 offset:4096
ds_read_b64_tr_b16 v[198:199], v233 offset:6144
v_add_f32 v240, v240, v86
v_cvt_pk_bf16_f32 v186, v84, v85
s_waitcnt lgkmcnt(4)
v_mfma_f32_32x32x16_bf16 v[48:63], v[204:207], v[176:179], v[48:63]
v_exp_f32 v88, v88
v_add_f32 v241, v241, v87
ds_read_b64_tr_b16 v[200:201], v234 offset:4096
ds_read_b64_tr_b16 v[202:203], v234 offset:6144
v_cvt_pk_bf16_f32 v187, v86, v87
v_max3_f32 v242, v242, v111, v112
s_waitcnt lgkmcnt(4)
v_mfma_f32_32x32x16_bf16 v[0:15], v[192:195], v[180:183], v[0:15]
v_exp_f32 v89, v89
v_add_f32 v238, v238, v88
ds_read_b64_tr_b16 v[204:205], v235 offset:4096
ds_read_b64_tr_b16 v[206:207], v235 offset:6144
v_max3_f32 v242, v242, v113, v114
s_waitcnt lgkmcnt(4)
v_mfma_f32_32x32x16_bf16 v[16:31], v[196:199], v[180:183], v[16:31]
v_exp_f32 v90, v90
v_add_f32 v239, v239, v89
v_exp_f32 v91, v91
ds_read_b64_tr_b16 v[192:193], v232 offset:8192
ds_read_b64_tr_b16 v[194:195], v232 offset:10240
v_cvt_pk_bf16_f32 v188, v88, v89
v_max3_f32 v242, v242, v115, v116
s_waitcnt lgkmcnt(4)
v_mfma_f32_32x32x16_bf16 v[32:47], v[200:203], v[180:183], v[32:47]
v_exp_f32 v92, v92
v_add_f32 v240, v240, v90
v_add_f32 v241, v241, v91
ds_read_b64_tr_b16 v[196:197], v233 offset:8192
ds_read_b64_tr_b16 v[198:199], v233 offset:10240
v_cvt_pk_bf16_f32 v189, v90, v91
v_max3_f32 v242, v242, v117, v118
s_waitcnt lgkmcnt(4)
v_mfma_f32_32x32x16_bf16 v[48:63], v[204:207], v[180:183], v[48:63]
v_exp_f32 v93, v93
v_add_f32 v238, v238, v92
ds_read_b64_tr_b16 v[200:201], v234 offset:8192
ds_read_b64_tr_b16 v[202:203], v234 offset:10240
v_max3_f32 v242, v242, v119, v120
s_waitcnt lgkmcnt(4)
v_mfma_f32_32x32x16_bf16 v[0:15], v[192:195], v[184:187], v[0:15]
v_exp_f32 v94, v94
v_add_f32 v239, v239, v93
ds_read_b64_tr_b16 v[204:205], v235 offset:8192
ds_read_b64_tr_b16 v[206:207], v235 offset:10240
v_cvt_pk_bf16_f32 v190, v92, v93
v_max3_f32 v242, v242, v121, v122
s_waitcnt lgkmcnt(4)
v_mfma_f32_32x32x16_bf16 v[16:31], v[196:199], v[184:187], v[16:31]
v_exp_f32 v95, v95
v_add_f32 v240, v240, v94
ds_read_b64_tr_b16 v[192:193], v232 offset:12288
ds_read_b64_tr_b16 v[194:195], v232 offset:14336
v_max3_f32 v242, v242, v123, v124
s_waitcnt lgkmcnt(4)
v_mfma_f32_32x32x16_bf16 v[32:47], v[200:203], v[184:187], v[32:47]
v_add_f32 v241, v241, v95
v_cvt_pk_bf16_f32 v191, v94, v95
ds_read_b64_tr_b16 v[196:197], v233 offset:12288
ds_read_b64_tr_b16 v[198:199], v233 offset:14336
v_max3_f32 v242, v242, v125, v126
s_waitcnt lgkmcnt(4)
v_mfma_f32_32x32x16_bf16 v[48:63], v[204:207], v[184:187], v[48:63]
v_max3_f32 v242, v242, v127, v127
ds_read_b64_tr_b16 v[200:201], v234 offset:12288
ds_read_b64_tr_b16 v[202:203], v234 offset:14336
s_waitcnt lgkmcnt(4)
v_mfma_f32_32x32x16_bf16 v[0:15], v[192:195], v[188:191], v[0:15]
v_mov_b32 v243, v242
ds_read_b64_tr_b16 v[204:205], v235 offset:12288
ds_read_b64_tr_b16 v[206:207], v235 offset:14336
s_waitcnt lgkmcnt(4)
v_mfma_f32_32x32x16_bf16 v[16:31], v[196:199], v[188:191], v[16:31]
v_permlane32_swap_b32 v242, v243
s_barrier
ds_read_b128 v[192:195], v224 offset:32768
s_waitcnt lgkmcnt(3)
v_mfma_f32_32x32x16_bf16 v[32:47], v[200:203], v[188:191], v[32:47]
v_max_f32 v242, v242, v243
ds_read_b128 v[196:199], v225 offset:32768
v_cmp_lt_f32 vcc, s57, v242
s_waitcnt lgkmcnt(2)
v_mfma_f32_32x32x16_bf16 v[48:63], v[204:207], v[188:191], v[48:63]
ds_read_b128 v[200:203], v226 offset:32768
s_cbranch_vccnz RESC12
BACK12:
s_cmp_ge_u32 s100, 99
s_cbranch_scc1 SP_SKIP
buffer_load_dword v250, v246, s[96:99], 0 offen
SP_SKIP:
s_waitcnt lgkmcnt(2)
v_mfma_f32_32x32x16_bf16 v[64:79], v[192:195], v[144:147], v[128:143]
v_exp_f32 v96, v96
ds_read_b128 v[204:207], v227 offset:32768
v_exp_f32 v97, v97
s_waitcnt lgkmcnt(2)
v_mfma_f32_32x32x16_bf16 v[64:79], v[196:199], v[148:151], v[64:79]
v_exp_f32 v98, v98
v_add_f32 v238, v238, v96
ds_read_b128 v[192:195], v228 offset:32768
v_add_f32 v239, v239, v97
v_cvt_pk_bf16_f32 v176, v96, v97
s_waitcnt lgkmcnt(2)
v_mfma_f32_32x32x16_bf16 v[64:79], v[200:203], v[152:155], v[64:79]
v_exp_f32 v99, v99
ds_read_b128 v[196:199], v229 offset:32768
v_add_f32 v240, v240, v98
s_waitcnt lgkmcnt(2)
v_mfma_f32_32x32x16_bf16 v[64:79], v[204:207], v[156:159], v[64:79]
v_exp_f32 v100, v100
v_add_f32 v241, v241, v99
ds_read_b128 v[200:203], v230 offset:32768
v_cvt_pk_bf16_f32 v177, v98, v99
s_waitcnt lgkmcnt(2)
v_mfma_f32_32x32x16_bf16 v[64:79], v[192:195], v[160:163], v[64:79]
v_exp_f32 v101, v101
v_add_f32 v238, v238, v100
ds_read_b128 v[204:207], v231 offset:32768
v_exp_f32 v102, v102
s_waitcnt lgkmcnt(2)
v_mfma_f32_32x32x16_bf16 v[64:79], v[196:199], v[164:167], v[64:79]
v_exp_f32 v103, v103
v_add_f32 v239, v239, v101
ds_read_b128 v[192:195], v224 offset:40960
v_add_f32 v240, v240, v102
v_cvt_pk_bf16_f32 v178, v100, v101
s_waitcnt lgkmcnt(2)
v_mfma_f32_32x32x16_bf16 v[64:79], v[200:203], v[168:171], v[64:79]
v_exp_f32 v104, v104
v_add_f32 v241, v241, v103
ds_read_b128 v[196:199], v225 offset:40960
v_cvt_pk_bf16_f32 v179, v102, v103
s_waitcnt lgkmcnt(2)
v_mfma_f32_32x32x16_bf16 v[64:79], v[204:207], v[172:175], v[64:79]
v_exp_f32 v105, v105
ds_read_b128 v[200:203], v226 offset:40960
v_add_f32 v238, v238, v104
s_waitcnt lgkmcnt(2)
v_mfma_f32_32x32x16_bf16 v[80:95], v[192:195], v[144:147], v[128:143]
v_exp_f32 v106, v106
v_add_f32 v239, v239, v105
ds_read_b128 v[204:207], v227 offset:40960
v_exp_f32 v107, v107
v_cvt_pk_bf16_f32 v180, v104, v105
s_waitcnt lgkmcnt(2)
v_mfma_f32_32x32x16_bf16 v[80:95], v[196:199], v[148:151], v[80:95]
v_exp_f32 v108, v108
v_add_f32 v240, v240, v106
ds_read_b128 v[192:195], v228 offset:40960
v_add_f32 v241, v241, v107
v_cvt_pk_bf16_f32 v181, v106, v107
s_waitcnt lgkmcnt(2)
v_mfma_f32_32x32x16_bf16 v[80:95], v[200:203], v[152:155], v[80:95]
v_exp_f32 v109, v109
ds_read_b128 v[196:199], v229 offset:40960
v_add_f32 v238, v238, v108
s_waitcnt lgkmcnt(2)
v_mfma_f32_32x32x16_bf16 v[80:95], v[204:207], v[156:159], v[80:95]
v_exp_f32 v110, v110
v_add_f32 v239, v239, v109
ds_read_b128 v[200:203], v230 offset:40960
v_cvt_pk_bf16_f32 v182, v108, v109
v_max3_f32 v242, v64, v65, v66
s_waitcnt lgkmcnt(2)
v_mfma_f32_32x32x16_bf16 v[80:95], v[192:195], v[160:163], v[80:95]
v_exp_f32 v111, v111
v_add_f32 v240, v240, v110
ds_read_b128 v[204:207], v231 offset:40960
v_max3_f32 v242, v242, v67, v68
s_waitcnt lgkmcnt(2)
v_mfma_f32_32x32x16_bf16 v[80:95], v[196:199], v[164:167], v[80:95]
v_exp_f32 v112, v112
v_add_f32 v241, v241, v111
v_exp_f32 v113, v113
ds_read_b64_tr_b16 v[192:193], v232 offset:16384
ds_read_b64_tr_b16 v[194:195], v232 offset:18432
v_cvt_pk_bf16_f32 v183, v110, v111
v_max3_f32 v242, v242, v69, v70
s_waitcnt lgkmcnt(3)
v_mfma_f32_32x32x16_bf16 v[80:95], v[200:203], v[168:171], v[80:95]
v_exp_f32 v114, v114
v_add_f32 v238, v238, v112
v_add_f32 v239, v239, v113
ds_read_b64_tr_b16 v[196:197], v233 offset:16384
ds_read_b64_tr_b16 v[198:199], v233 offset:18432
v_cvt_pk_bf16_f32 v184, v112, v113
v_max3_f32 v242, v242, v71, v72
s_waitcnt lgkmcnt(4)
v_mfma_f32_32x32x16_bf16 v[80:95], v[204:207], v[172:175], v[80:95]
v_exp_f32 v115, v115
v_add_f32 v240, v240, v114
ds_read_b64_tr_b16 v[200:201], v234 offset:16384
ds_read_b64_tr_b16 v[202:203], v234 offset:18432
v_max3_f32 v242, v242, v73, v74
s_waitcnt lgkmcnt(4)
v_mfma_f32_32x32x16_bf16 v[0:15], v[192:195], v[176:179], v[0:15]
v_exp_f32 v116, v116
v_add_f32 v241, v241, v115
ds_read_b64_tr_b16 v[204:205], v235 offset:16384
ds_read_b64_tr_b16 v[206:207], v235 offset:18432
v_cvt_pk_bf16_f32 v185, v114, v115
v_max3_f32 v242, v242, v75, v76
s_waitcnt lgkmcnt(4)
v_mfma_f32_32x32x16_bf16 v[16:31], v[196:199], v[176:179], v[16:31]
v_exp_f32 v117, v117
v_add_f32 v238, v238, v116
ds_read_b64_tr_b16 v[192:193], v232 offset:20480
ds_read_b64_tr_b16 v[194:195], v232 offset:22528
v_exp_f32 v118, v118
v_max3_f32 v242, v242, v77, v78
s_waitcnt lgkmcnt(4)
v_mfma_f32_32x32x16_bf16 v[32:47], v[200:203], v[176:179], v[32:47]
v_exp_f32 v119, v119
v_add_f32 v239, v239, v117
ds_read_b64_tr_b16 v[196:197], v233 offset:20480
ds_read_b64_tr_b16 v[198:199], v233 offset:22528
v_add_f32 v240, v240, v118
v_cvt_pk_bf16_f32 v186, v116, v117
s_waitcnt lgkmcnt(4)
v_mfma_f32_32x32x16_bf16 v[48:63], v[204:207], v[176:179], v[48:63]
v_exp_f32 v120, v120
v_add_f32 v241, v241, v119
ds_read_b64_tr_b16 v[200:201], v234 offset:20480
ds_read_b64_tr_b16 v[202:203], v234 offset:22528
v_cvt_pk_bf16_f32 v187, v118, v119
v_max3_f32 v242, v242, v79, v80
s_waitcnt lgkmcnt(4)
v_mfma_f32_32x32x16_bf16 v[0:15], v[192:195], v[180:183], v[0:15]
v_exp_f32 v121, v121
v_add_f32 v238, v238, v120
ds_read_b64_tr_b16 v[204:205], v235 offset:20480
ds_read_b64_tr_b16 v[206:207], v235 offset:22528
v_max3_f32 v242, v242, v81, v82
s_waitcnt lgkmcnt(4)
v_mfma_f32_32x32x16_bf16 v[16:31], v[196:199], v[180:183], v[16:31]
v_exp_f32 v122, v122
v_add_f32 v239, v239, v121
v_exp_f32 v123, v123
ds_read_b64_tr_b16 v[192:193], v232 offset:24576
ds_read_b64_tr_b16 v[194:195], v232 offset:26624
v_cvt_pk_bf16_f32 v188, v120, v121
v_max3_f32 v242, v242, v83, v84
s_waitcnt lgkmcnt(4)
v_mfma_f32_32x32x16_bf16 v[32:47], v[200:203], v[180:183], v[32:47]
v_exp_f32 v124, v124
v_add_f32 v240, v240, v122
v_add_f32 v241, v241, v123
ds_read_b64_tr_b16 v[196:197], v233 offset:24576
ds_read_b64_tr_b16 v[198:199], v233 offset:26624
v_cvt_pk_bf16_f32 v189, v122, v123
v_max3_f32 v242, v242, v85, v86
s_waitcnt lgkmcnt(4)
v_mfma_f32_32x32x16_bf16 v[48:63], v[204:207], v[180:183], v[48:63]
v_exp_f32 v125, v125
v_add_f32 v238, v238, v124
ds_read_b64_tr_b16 v[200:201], v234 offset:24576
ds_read_b64_tr_b16 v[202:203], v234 offset:26624
v_max3_f32 v242, v242, v87, v88
s_waitcnt lgkmcnt(4)
v_mfma_f32_32x32x16_bf16 v[0:15], v[192:195], v[184:187], v[0:15]
v_exp_f32 v126, v126
v_add_f32 v239, v239, v125
ds_read_b64_tr_b16 v[204:205], v235 offset:24576
ds_read_b64_tr_b16 v[206:207], v235 offset:26624
v_cvt_pk_bf16_f32 v190, v124, v125
v_max3_f32 v242, v242, v89, v90
s_waitcnt lgkmcnt(4)
v_mfma_f32_32x32x16_bf16 v[16:31], v[196:199], v[184:187], v[16:31]
v_exp_f32 v127, v127
v_add_f32 v240, v240, v126
ds_read_b64_tr_b16 v[192:193], v232 offset:28672
ds_read_b64_tr_b16 v[194:195], v232 offset:30720
v_max3_f32 v242, v242, v91, v92
s_waitcnt lgkmcnt(4)
v_mfma_f32_32x32x16_bf16 v[32:47], v[200:203], v[184:187], v[32:47]
v_add_f32 v241, v241, v127
v_cvt_pk_bf16_f32 v191, v126, v127
ds_read_b64_tr_b16 v[196:197], v233 offset:28672
ds_read_b64_tr_b16 v[198:199], v233 offset:30720
v_max3_f32 v242, v242, v93, v94
s_waitcnt lgkmcnt(4)
v_mfma_f32_32x32x16_bf16 v[48:63], v[204:207], v[184:187], v[48:63]
v_max3_f32 v242, v242, v95, v95
ds_read_b64_tr_b16 v[200:201], v234 offset:28672
ds_read_b64_tr_b16 v[202:203], v234 offset:30720
s_waitcnt lgkmcnt(4)
v_mfma_f32_32x32x16_bf16 v[0:15], v[192:195], v[188:191], v[0:15]
v_mov_b32 v243, v242
ds_read_b64_tr_b16 v[204:205], v235 offset:28672
ds_read_b64_tr_b16 v[206:207], v235 offset:30720
s_waitcnt lgkmcnt(4)
v_mfma_f32_32x32x16_bf16 v[16:31], v[196:199], v[188:191], v[16:31]
v_permlane32_swap_b32 v242, v243
s_barrier
ds_read_b128 v[192:195], v224 offset:49152
s_waitcnt lgkmcnt(3)
v_mfma_f32_32x32x16_bf16 v[32:47], v[200:203], v[188:191], v[32:47]
v_max_f32 v242, v242, v243
ds_read_b128 v[196:199], v225 offset:49152
v_cmp_lt_f32 vcc, s57, v242
s_waitcnt lgkmcnt(2)
v_mfma_f32_32x32x16_bf16 v[48:63], v[204:207], v[188:191], v[48:63]
ds_read_b128 v[200:203], v226 offset:49152
s_cbranch_vccnz RESC13
BACK13:
s_waitcnt lgkmcnt(2)
v_mfma_f32_32x32x16_bf16 v[96:111], v[192:195], v[144:147], v[128:143]
v_exp_f32 v64, v64
ds_read_b128 v[204:207], v227 offset:49152
v_exp_f32 v65, v65
s_waitcnt lgkmcnt(2)
v_mfma_f32_32x32x16_bf16 v[96:111], v[196:199], v[148:151], v[96:111]
v_exp_f32 v66, v66
v_add_f32 v238, v238, v64
ds_read_b128 v[192:195], v228 offset:49152
v_add_f32 v239, v239, v65
v_cvt_pk_bf16_f32 v176, v64, v65
s_waitcnt lgkmcnt(2)
v_mfma_f32_32x32x16_bf16 v[96:111], v[200:203], v[152:155], v[96:111]
v_exp_f32 v67, v67
ds_read_b128 v[196:199], v229 offset:49152
v_add_f32 v240, v240, v66
s_waitcnt lgkmcnt(2)
v_mfma_f32_32x32x16_bf16 v[96:111], v[204:207], v[156:159], v[96:111]
v_exp_f32 v68, v68
v_add_f32 v241, v241, v67
ds_read_b128 v[200:203], v230 offset:49152
v_cvt_pk_bf16_f32 v177, v66, v67
s_waitcnt lgkmcnt(2)
v_mfma_f32_32x32x16_bf16 v[96:111], v[192:195], v[160:163], v[96:111]
v_exp_f32 v69, v69
v_add_f32 v238, v238, v68
ds_read_b128 v[204:207], v231 offset:49152
v_exp_f32 v70, v70
s_waitcnt lgkmcnt(2)
v_mfma_f32_32x32x16_bf16 v[96:111], v[196:199], v[164:167], v[96:111]
v_exp_f32 v71, v71
v_add_f32 v239, v239, v69
ds_read_b128 v[192:195], v224 offset:57344
v_add_f32 v240, v240, v70
v_cvt_pk_bf16_f32 v178, v68, v69
s_waitcnt lgkmcnt(2)
v_mfma_f32_32x32x16_bf16 v[96:111], v[200:203], v[168:171], v[96:111]
v_exp_f32 v72, v72
v_add_f32 v241, v241, v71
ds_read_b128 v[196:199], v225 offset:57344
v_cvt_pk_bf16_f32 v179, v70, v71
s_waitcnt lgkmcnt(2)
v_mfma_f32_32x32x16_bf16 v[96:111], v[204:207], v[172:175], v[96:111]
v_exp_f32 v73, v73
ds_read_b128 v[200:203], v226 offset:57344
v_add_f32 v238, v238, v72
s_waitcnt lgkmcnt(2)
v_mfma_f32_32x32x16_bf16 v[112:127], v[192:195], v[144:147], v[128:143]
v_exp_f32 v74, v74
v_add_f32 v239, v239, v73
ds_read_b128 v[204:207], v227 offset:57344
v_exp_f32 v75, v75
v_cvt_pk_bf16_f32 v180, v72, v73
s_waitcnt lgkmcnt(2)
v_mfma_f32_32x32x16_bf16 v[112:127], v[196:199], v[148:151], v[112:127]
v_exp_f32 v76, v76
v_add_f32 v240, v240, v74
ds_read_b128 v[192:195], v228 offset:57344
v_add_f32 v241, v241, v75
v_cvt_pk_bf16_f32 v181, v74, v75
s_waitcnt lgkmcnt(2)
v_mfma_f32_32x32x16_bf16 v[112:127], v[200:203], v[152:155], v[112:127]
v_exp_f32 v77, v77
ds_read_b128 v[196:199], v229 offset:57344
v_add_f32 v238, v238, v76
s_waitcnt lgkmcnt(2)
v_mfma_f32_32x32x16_bf16 v[112:127], v[204:207], v[156:159], v[112:127]
v_exp_f32 v78, v78
v_add_f32 v239, v239, v77
ds_read_b128 v[200:203], v230 offset:57344
v_cvt_pk_bf16_f32 v182, v76, v77
v_max3_f32 v242, v96, v97, v98
s_waitcnt lgkmcnt(2)
v_mfma_f32_32x32x16_bf16 v[112:127], v[192:195], v[160:163], v[112:127]
v_exp_f32 v79, v79
v_add_f32 v240, v240, v78
ds_read_b128 v[204:207], v231 offset:57344
v_max3_f32 v242, v242, v99, v100
s_waitcnt lgkmcnt(2)
v_mfma_f32_32x32x16_bf16 v[112:127], v[196:199], v[164:167], v[112:127]
v_exp_f32 v80, v80
v_add_f32 v241, v241, v79
v_exp_f32 v81, v81
ds_read_b64_tr_b16 v[192:193], v232 offset:32768
ds_read_b64_tr_b16 v[194:195], v232 offset:34816
v_cvt_pk_bf16_f32 v183, v78, v79
v_max3_f32 v242, v242, v101, v102
s_waitcnt lgkmcnt(3)
v_mfma_f32_32x32x16_bf16 v[112:127], v[200:203], v[168:171], v[112:127]
v_exp_f32 v82, v82
v_add_f32 v238, v238, v80
v_add_f32 v239, v239, v81
ds_read_b64_tr_b16 v[196:197], v233 offset:32768
ds_read_b64_tr_b16 v[198:199], v233 offset:34816
v_cvt_pk_bf16_f32 v184, v80, v81
v_max3_f32 v242, v242, v103, v104
s_waitcnt lgkmcnt(4)
v_mfma_f32_32x32x16_bf16 v[112:127], v[204:207], v[172:175], v[112:127]
v_exp_f32 v83, v83
v_add_f32 v240, v240, v82
ds_read_b64_tr_b16 v[200:201], v234 offset:32768
ds_read_b64_tr_b16 v[202:203], v234 offset:34816
v_max3_f32 v242, v242, v105, v106
s_waitcnt lgkmcnt(4)
v_mfma_f32_32x32x16_bf16 v[0:15], v[192:195], v[176:179], v[0:15]
v_exp_f32 v84, v84
v_add_f32 v241, v241, v83
ds_read_b64_tr_b16 v[204:205], v235 offset:32768
ds_read_b64_tr_b16 v[206:207], v235 offset:34816
v_cvt_pk_bf16_f32 v185, v82, v83
v_max3_f32 v242, v242, v107, v108
s_waitcnt lgkmcnt(4)
v_mfma_f32_32x32x16_bf16 v[16:31], v[196:199], v[176:179], v[16:31]
v_exp_f32 v85, v85
v_add_f32 v238, v238, v84
ds_read_b64_tr_b16 v[192:193], v232 offset:36864
ds_read_b64_tr_b16 v[194:195], v232 offset:38912
v_exp_f32 v86, v86
v_max3_f32 v242, v242, v109, v110
s_waitcnt lgkmcnt(4)
v_mfma_f32_32x32x16_bf16 v[32:47], v[200:203], v[176:179], v[32:47]
v_exp_f32 v87, v87
v_add_f32 v239, v239, v85
ds_read_b64_tr_b16 v[196:197], v233 offset:36864
ds_read_b64_tr_b16 v[198:199], v233 offset:38912
v_add_f32 v240, v240, v86
v_cvt_pk_bf16_f32 v186, v84, v85
s_waitcnt lgkmcnt(4)
v_mfma_f32_32x32x16_bf16 v[48:63], v[204:207], v[176:179], v[48:63]
v_exp_f32 v88, v88
v_add_f32 v241, v241, v87
ds_read_b64_tr_b16 v[200:201], v234 offset:36864
ds_read_b64_tr_b16 v[202:203], v234 offset:38912
v_cvt_pk_bf16_f32 v187, v86, v87
v_max3_f32 v242, v242, v111, v112
s_waitcnt lgkmcnt(4)
v_mfma_f32_32x32x16_bf16 v[0:15], v[192:195], v[180:183], v[0:15]
v_exp_f32 v89, v89
v_add_f32 v238, v238, v88
ds_read_b64_tr_b16 v[204:205], v235 offset:36864
ds_read_b64_tr_b16 v[206:207], v235 offset:38912
v_max3_f32 v242, v242, v113, v114
s_waitcnt lgkmcnt(4)
v_mfma_f32_32x32x16_bf16 v[16:31], v[196:199], v[180:183], v[16:31]
v_exp_f32 v90, v90
v_add_f32 v239, v239, v89
v_exp_f32 v91, v91
ds_read_b64_tr_b16 v[192:193], v232 offset:40960
ds_read_b64_tr_b16 v[194:195], v232 offset:43008
v_cvt_pk_bf16_f32 v188, v88, v89
v_max3_f32 v242, v242, v115, v116
s_waitcnt lgkmcnt(4)
v_mfma_f32_32x32x16_bf16 v[32:47], v[200:203], v[180:183], v[32:47]
v_exp_f32 v92, v92
v_add_f32 v240, v240, v90
v_add_f32 v241, v241, v91
ds_read_b64_tr_b16 v[196:197], v233 offset:40960
ds_read_b64_tr_b16 v[198:199], v233 offset:43008
v_cvt_pk_bf16_f32 v189, v90, v91
v_max3_f32 v242, v242, v117, v118
s_waitcnt lgkmcnt(4)
v_mfma_f32_32x32x16_bf16 v[48:63], v[204:207], v[180:183], v[48:63]
v_exp_f32 v93, v93
v_add_f32 v238, v238, v92
ds_read_b64_tr_b16 v[200:201], v234 offset:40960
ds_read_b64_tr_b16 v[202:203], v234 offset:43008
v_max3_f32 v242, v242, v119, v120
s_waitcnt lgkmcnt(4)
v_mfma_f32_32x32x16_bf16 v[0:15], v[192:195], v[184:187], v[0:15]
v_exp_f32 v94, v94
v_add_f32 v239, v239, v93
ds_read_b64_tr_b16 v[204:205], v235 offset:40960
ds_read_b64_tr_b16 v[206:207], v235 offset:43008
v_cvt_pk_bf16_f32 v190, v92, v93
v_max3_f32 v242, v242, v121, v122
s_waitcnt lgkmcnt(4)
v_mfma_f32_32x32x16_bf16 v[16:31], v[196:199], v[184:187], v[16:31]
v_exp_f32 v95, v95
v_add_f32 v240, v240, v94
ds_read_b64_tr_b16 v[192:193], v232 offset:45056
ds_read_b64_tr_b16 v[194:195], v232 offset:47104
v_max3_f32 v242, v242, v123, v124
s_waitcnt lgkmcnt(4)
v_mfma_f32_32x32x16_bf16 v[32:47], v[200:203], v[184:187], v[32:47]
v_add_f32 v241, v241, v95
v_cvt_pk_bf16_f32 v191, v94, v95
ds_read_b64_tr_b16 v[196:197], v233 offset:45056
ds_read_b64_tr_b16 v[198:199], v233 offset:47104
v_max3_f32 v242, v242, v125, v126
s_waitcnt lgkmcnt(4)
v_mfma_f32_32x32x16_bf16 v[48:63], v[204:207], v[184:187], v[48:63]
v_max3_f32 v242, v242, v127, v127
ds_read_b64_tr_b16 v[200:201], v234 offset:45056
ds_read_b64_tr_b16 v[202:203], v234 offset:47104
s_waitcnt lgkmcnt(4)
v_mfma_f32_32x32x16_bf16 v[0:15], v[192:195], v[188:191], v[0:15]
v_mov_b32 v243, v242
ds_read_b64_tr_b16 v[204:205], v235 offset:45056
ds_read_b64_tr_b16 v[206:207], v235 offset:47104
s_waitcnt lgkmcnt(4)
v_mfma_f32_32x32x16_bf16 v[16:31], v[196:199], v[188:191], v[16:31]
v_permlane32_swap_b32 v242, v243
s_waitcnt lgkmcnt(0)
s_barrier
ds_read_b64_tr_b16 v[192:193], v232 offset:49152
ds_read_b64_tr_b16 v[194:195], v232 offset:51200
s_waitcnt lgkmcnt(4)
v_mfma_f32_32x32x16_bf16 v[32:47], v[200:203], v[188:191], v[32:47]
v_max_f32 v242, v242, v243
ds_read_b64_tr_b16 v[196:197], v233 offset:49152
ds_read_b64_tr_b16 v[198:199], v233 offset:51200
v_cmp_lt_f32 vcc, s57, v242
s_waitcnt lgkmcnt(4)
v_mfma_f32_32x32x16_bf16 v[48:63], v[204:207], v[188:191], v[48:63]
ds_read_b64_tr_b16 v[200:201], v234 offset:49152
ds_read_b64_tr_b16 v[202:203], v234 offset:51200
s_cbranch_vccnz RESC14
BACK14:
s_cmp_lg_u32 s4, 0
s_cbranch_scc1 NOX
s_mov_b32 s32, s40
s_mov_b32 s33, s41
s_mov_b32 s34, s42
s_mov_b32 s35, s43
s_mov_b32 s36, s44
s_mov_b32 s37, s45
s_mov_b32 s38, s46
s_mov_b32 s39, s47
s_mul_i32 s28, s6, 229376
s_add_u32 s20, s32, s28
s_addc_u32 s21, s33, 0
s_mov_b32 s22, 229376
s_mov_b32 s23, 0x20000
s_add_u32 m0, s30, 0
s_add_u32 s52, s55, 0
buffer_load_dwordx4 v236, s[20:23], s52 offen lds
s_add_u32 m0, s30, 1024
s_add_u32 s52, s55, 8192
buffer_load_dwordx4 v237, s[20:23], s52 offen lds
s_add_u32 m0, s30, 2048
s_add_u32 s52, s55, 16384
buffer_load_dwordx4 v236, s[20:23], s52 offen lds
s_add_u32 m0, s30, 3072
s_add_u32 s52, s55, 24576
buffer_load_dwordx4 v237, s[20:23], s52 offen lds
s_add_u32 m0, s31, 0
s_add_u32 s52, s55, 128
buffer_load_dwordx4 v236, s[20:23], s52 offen lds
s_add_u32 m0, s31, 1024
s_add_u32 s52, s55, 8320
buffer_load_dwordx4 v237, s[20:23], s52 offen lds
s_add_u32 m0, s31, 2048
s_add_u32 s52, s55, 16512
buffer_load_dwordx4 v236, s[20:23], s52 offen lds
s_add_u32 m0, s31, 3072
s_add_u32 s52, s55, 24704
buffer_load_dwordx4 v237, s[20:23], s52 offen lds
NOX:
v_exp_f32 v96, v96
v_exp_f32 v97, v97
v_exp_f32 v98, v98
v_exp_f32 v99, v99
v_exp_f32 v100, v100
v_add_f32 v238, v238, v96
v_exp_f32 v101, v101
v_add_f32 v239, v239, v97
v_exp_f32 v102, v102
v_add_f32 v240, v240, v98
v_add_f32 v241, v241, v99
v_cvt_pk_bf16_f32 v176, v96, v97
v_cvt_pk_bf16_f32 v177, v98, v99
v_exp_f32 v103, v103
v_add_f32 v238, v238, v100
v_exp_f32 v104, v104
v_add_f32 v239, v239, v101
v_exp_f32 v105, v105
v_add_f32 v240, v240, v102
v_cvt_pk_bf16_f32 v178, v100, v101
v_exp_f32 v106, v106
v_add_f32 v241, v241, v103
v_exp_f32 v107, v107
v_add_f32 v238, v238, v104
v_exp_f32 v108, v108
v_add_f32 v239, v239, v105
v_cvt_pk_bf16_f32 v179, v102, v103
v_cvt_pk_bf16_f32 v180, v104, v105
v_exp_f32 v109, v109
v_add_f32 v240, v240, v106
v_exp_f32 v110, v110
v_add_f32 v241, v241, v107
v_exp_f32 v111, v111
v_add_f32 v238, v238, v108
v_cvt_pk_bf16_f32 v181, v106, v107
v_exp_f32 v112, v112
v_add_f32 v239, v239, v109
v_exp_f32 v113, v113
v_add_f32 v240, v240, v110
v_exp_f32 v114, v114
v_add_f32 v241, v241, v111
v_exp_f32 v115, v115
v_cvt_pk_bf16_f32 v182, v108, v109
v_cvt_pk_bf16_f32 v183, v110, v111
v_exp_f32 v116, v116
v_add_f32 v238, v238, v112
v_exp_f32 v117, v117
v_add_f32 v239, v239, v113
v_exp_f32 v118, v118
v_add_f32 v240, v240, v114
v_add_f32 v241, v241, v115
v_cvt_pk_bf16_f32 v184, v112, v113
v_cvt_pk_bf16_f32 v185, v114, v115
v_exp_f32 v119, v119
v_add_f32 v238, v238, v116
v_exp_f32 v120, v120
v_add_f32 v239, v239, v117
v_exp_f32 v121, v121
v_add_f32 v240, v240, v118
v_cvt_pk_bf16_f32 v186, v116, v117
v_exp_f32 v122, v122
v_add_f32 v241, v241, v119
v_exp_f32 v123, v123
v_add_f32 v238, v238, v120
v_exp_f32 v124, v124
v_add_f32 v239, v239, v121
v_cvt_pk_bf16_f32 v187, v118, v119
v_cvt_pk_bf16_f32 v188, v120, v121
v_exp_f32 v125, v125
v_add_f32 v240, v240, v122
v_exp_f32 v126, v126
v_add_f32 v241, v241, v123
v_exp_f32 v127, v127
v_add_f32 v238, v238, v124
v_cvt_pk_bf16_f32 v189, v122, v123
v_add_f32 v239, v239, v125
v_add_f32 v240, v240, v126
v_add_f32 v241, v241, v127
v_cvt_pk_bf16_f32 v190, v124, v125
v_cvt_pk_bf16_f32 v191, v126, v127
s_waitcnt lgkmcnt(4)
v_mfma_f32_32x32x16_bf16 v[0:15], v[192:195], v[176:179], v[0:15]
ds_read_b64_tr_b16 v[204:205], v235 offset:49152
ds_read_b64_tr_b16 v[206:207], v235 offset:51200
s_waitcnt lgkmcnt(4)
v_mfma_f32_32x32x16_bf16 v[16:31], v[196:199], v[176:179], v[16:31]
ds_read_b64_tr_b16 v[192:193], v232 offset:53248
ds_read_b64_tr_b16 v[194:195], v232 offset:55296
s_waitcnt lgkmcnt(4)
v_mfma_f32_32x32x16_bf16 v[32:47], v[200:203], v[176:179], v[32:47]
ds_read_b64_tr_b16 v[196:197], v233 offset:53248
ds_read_b64_tr_b16 v[198:199], v233 offset:55296
s_waitcnt lgkmcnt(4)
v_mfma_f32_32x32x16_bf16 v[48:63], v[204:207], v[176:179], v[48:63]
ds_read_b64_tr_b16 v[200:201], v234 offset:53248
ds_read_b64_tr_b16 v[202:203], v234 offset:55296
s_waitcnt lgkmcnt(4)
v_mfma_f32_32x32x16_bf16 v[0:15], v[192:195], v[180:183], v[0:15]
ds_read_b64_tr_b16 v[204:205], v235 offset:53248
ds_read_b64_tr_b16 v[206:207], v235 offset:55296
s_waitcnt lgkmcnt(4)
v_mfma_f32_32x32x16_bf16 v[16:31], v[196:199], v[180:183], v[16:31]
ds_read_b64_tr_b16 v[192:193], v232 offset:57344
ds_read_b64_tr_b16 v[194:195], v232 offset:59392
s_waitcnt lgkmcnt(4)
v_mfma_f32_32x32x16_bf16 v[32:47], v[200:203], v[180:183], v[32:47]
ds_read_b64_tr_b16 v[196:197], v233 offset:57344
ds_read_b64_tr_b16 v[198:199], v233 offset:59392
s_waitcnt lgkmcnt(4)
v_mfma_f32_32x32x16_bf16 v[48:63], v[204:207], v[180:183], v[48:63]
ds_read_b64_tr_b16 v[200:201], v234 offset:57344
ds_read_b64_tr_b16 v[202:203], v234 offset:59392
s_waitcnt lgkmcnt(4)
v_mfma_f32_32x32x16_bf16 v[0:15], v[192:195], v[184:187], v[0:15]
ds_read_b64_tr_b16 v[204:205], v235 offset:57344
ds_read_b64_tr_b16 v[206:207], v235 offset:59392
s_waitcnt lgkmcnt(4)
v_mfma_f32_32x32x16_bf16 v[16:31], v[196:199], v[184:187], v[16:31]
ds_read_b64_tr_b16 v[192:193], v232 offset:61440
ds_read_b64_tr_b16 v[194:195], v232 offset:63488
s_waitcnt lgkmcnt(4)
v_mfma_f32_32x32x16_bf16 v[32:47], v[200:203], v[184:187], v[32:47]
ds_read_b64_tr_b16 v[196:197], v233 offset:61440
ds_read_b64_tr_b16 v[198:199], v233 offset:63488
s_waitcnt lgkmcnt(4)
v_mfma_f32_32x32x16_bf16 v[48:63], v[204:207], v[184:187], v[48:63]
ds_read_b64_tr_b16 v[200:201], v234 offset:61440
ds_read_b64_tr_b16 v[202:203], v234 offset:63488
s_waitcnt lgkmcnt(4)
v_mfma_f32_32x32x16_bf16 v[0:15], v[192:195], v[188:191], v[0:15]
ds_read_b64_tr_b16 v[204:205], v235 offset:61440
ds_read_b64_tr_b16 v[206:207], v235 offset:63488
s_waitcnt lgkmcnt(4)
v_mfma_f32_32x32x16_bf16 v[16:31], v[196:199], v[188:191], v[16:31]
s_waitcnt lgkmcnt(2)
v_mfma_f32_32x32x16_bf16 v[32:47], v[200:203], v[188:191], v[32:47]
s_waitcnt lgkmcnt(0)
v_mfma_f32_32x32x16_bf16 v[48:63], v[204:207], v[188:191], v[48:63]
v_add_f32 v238, v238, v239
v_add_f32 v240, v240, v241
v_add_f32 v238, v238, v240
v_mov_b32 v243, v238
s_nop 1
v_permlane32_swap_b32 v238, v243
v_add_f32 v238, v238, v243
v_rcp_f32 v238, v238
s_lshl_b32 s28, s4, 3
s_add_u32 s28, s28, s6
s_lshl_b32 s28, s28, 5
s_add_u32 s28, s28, s7
s_mul_i32 s28, s28, 57344
s_add_u32 s24, s48, s28
s_addc_u32 s25, s49, 0
s_mov_b32 s26, 57344
s_mov_b32 s27, 0x20000
s_lshl_b32 s28, s5, 13
v_lshlrev_b32 v244, 4, v245
v_add_u32 v244, s28, v244
v_mul_f32 v0, v0, v238
v_mul_f32 v1, v1, v238
v_mul_f32 v2, v2, v238
v_mul_f32 v3, v3, v238
v_mul_f32 v4, v4, v238
v_mul_f32 v5, v5, v238
v_mul_f32 v6, v6, v238
v_mul_f32 v7, v7, v238
v_cvt_pk_bf16_f32 v144, v0, v1
v_cvt_pk_bf16_f32 v145, v2, v3
v_cvt_pk_bf16_f32 v146, v4, v5
v_cvt_pk_bf16_f32 v147, v6, v7
buffer_store_dwordx4 v[144:147], v244, s[24:27], 0 offen offset:0
v_mul_f32 v8, v8, v238
v_mul_f32 v9, v9, v238
v_mul_f32 v10, v10, v238
v_mul_f32 v11, v11, v238
v_mul_f32 v12, v12, v238
v_mul_f32 v13, v13, v238
v_mul_f32 v14, v14, v238
v_mul_f32 v15, v15, v238
v_cvt_pk_bf16_f32 v148, v8, v9
v_cvt_pk_bf16_f32 v149, v10, v11
v_cvt_pk_bf16_f32 v150, v12, v13
v_cvt_pk_bf16_f32 v151, v14, v15
buffer_store_dwordx4 v[148:151], v244, s[24:27], 0 offen offset:1024
v_mul_f32 v16, v16, v238
v_mul_f32 v17, v17, v238
v_mul_f32 v18, v18, v238
v_mul_f32 v19, v19, v238
v_mul_f32 v20, v20, v238
v_mul_f32 v21, v21, v238
v_mul_f32 v22, v22, v238
v_mul_f32 v23, v23, v238
v_cvt_pk_bf16_f32 v152, v16, v17
v_cvt_pk_bf16_f32 v153, v18, v19
v_cvt_pk_bf16_f32 v154, v20, v21
v_cvt_pk_bf16_f32 v155, v22, v23
buffer_store_dwordx4 v[152:155], v244, s[24:27], 0 offen offset:2048
v_mul_f32 v24, v24, v238
v_mul_f32 v25, v25, v238
v_mul_f32 v26, v26, v238
v_mul_f32 v27, v27, v238
v_mul_f32 v28, v28, v238
v_mul_f32 v29, v29, v238
v_mul_f32 v30, v30, v238
v_mul_f32 v31, v31, v238
v_cvt_pk_bf16_f32 v156, v24, v25
v_cvt_pk_bf16_f32 v157, v26, v27
v_cvt_pk_bf16_f32 v158, v28, v29
v_cvt_pk_bf16_f32 v159, v30, v31
buffer_store_dwordx4 v[156:159], v244, s[24:27], 0 offen offset:3072
v_mul_f32 v32, v32, v238
v_mul_f32 v33, v33, v238
v_mul_f32 v34, v34, v238
v_mul_f32 v35, v35, v238
v_mul_f32 v36, v36, v238
v_mul_f32 v37, v37, v238
v_mul_f32 v38, v38, v238
v_mul_f32 v39, v39, v238
v_cvt_pk_bf16_f32 v160, v32, v33
v_cvt_pk_bf16_f32 v161, v34, v35
v_cvt_pk_bf16_f32 v162, v36, v37
v_cvt_pk_bf16_f32 v163, v38, v39
buffer_store_dwordx4 v[160:163], v244, s[24:27], s58 offen offset:0
v_mul_f32 v40, v40, v238
v_mul_f32 v41, v41, v238
v_mul_f32 v42, v42, v238
v_mul_f32 v43, v43, v238
v_mul_f32 v44, v44, v238
v_mul_f32 v45, v45, v238
v_mul_f32 v46, v46, v238
v_mul_f32 v47, v47, v238
v_cvt_pk_bf16_f32 v164, v40, v41
v_cvt_pk_bf16_f32 v165, v42, v43
v_cvt_pk_bf16_f32 v166, v44, v45
v_cvt_pk_bf16_f32 v167, v46, v47
buffer_store_dwordx4 v[164:167], v244, s[24:27], s58 offen offset:1024
v_mul_f32 v48, v48, v238
v_mul_f32 v49, v49, v238
v_mul_f32 v50, v50, v238
v_mul_f32 v51, v51, v238
v_mul_f32 v52, v52, v238
v_mul_f32 v53, v53, v238
v_mul_f32 v54, v54, v238
v_mul_f32 v55, v55, v238
v_cvt_pk_bf16_f32 v168, v48, v49
v_cvt_pk_bf16_f32 v169, v50, v51
v_cvt_pk_bf16_f32 v170, v52, v53
v_cvt_pk_bf16_f32 v171, v54, v55
buffer_store_dwordx4 v[168:171], v244, s[24:27], s58 offen offset:2048
v_mul_f32 v56, v56, v238
v_mul_f32 v57, v57, v238
v_mul_f32 v58, v58, v238
v_mul_f32 v59, v59, v238
v_mul_f32 v60, v60, v238
v_mul_f32 v61, v61, v238
v_mul_f32 v62, v62, v238
v_mul_f32 v63, v63, v238
v_cvt_pk_bf16_f32 v172, v56, v57
v_cvt_pk_bf16_f32 v173, v58, v59
v_cvt_pk_bf16_f32 v174, v60, v61
v_cvt_pk_bf16_f32 v175, v62, v63
buffer_store_dwordx4 v[172:175], v244, s[24:27], s58 offen offset:3072
s_cmp_lg_u32 s4, 0
s_cbranch_scc1 K1_DONE
s_mov_b32 s4, 1
s_branch ROUND
K1_DONE:
s_waitcnt vmcnt(0)
K1_EXIT:
s_endpgm
RESC0:
s_nop 15
v_max_f32 v242, 0, v242
v_sub_f32 v243, 0, v242
v_exp_f32 v243, v243
v_sub_f32 v96, v96, v242
v_sub_f32 v97, v97, v242
v_sub_f32 v98, v98, v242
v_sub_f32 v99, v99, v242
v_sub_f32 v100, v100, v242
v_sub_f32 v101, v101, v242
v_sub_f32 v102, v102, v242
v_sub_f32 v103, v103, v242
v_sub_f32 v104, v104, v242
v_sub_f32 v105, v105, v242
v_sub_f32 v106, v106, v242
v_sub_f32 v107, v107, v242
v_sub_f32 v108, v108, v242
v_sub_f32 v109, v109, v242
v_sub_f32 v110, v110, v242
v_sub_f32 v111, v111, v242
v_sub_f32 v112, v112, v242
v_sub_f32 v113, v113, v242
v_sub_f32 v114, v114, v242
v_sub_f32 v115, v115, v242
v_sub_f32 v116, v116, v242
v_sub_f32 v117, v117, v242
v_sub_f32 v118, v118, v242
v_sub_f32 v119, v119, v242
v_sub_f32 v120, v120, v242
v_sub_f32 v121, v121, v242
v_sub_f32 v122, v122, v242
v_sub_f32 v123, v123, v242
v_sub_f32 v124, v124, v242
v_sub_f32 v125, v125, v242
v_sub_f32 v126, v126, v242
v_sub_f32 v127, v127, v242
v_sub_f32 v128, v128, v242
v_sub_f32 v129, v129, v242
v_sub_f32 v130, v130, v242
v_sub_f32 v131, v131, v242
v_sub_f32 v132, v132, v242
v_sub_f32 v133, v133, v242
v_sub_f32 v134, v134, v242
v_sub_f32 v135, v135, v242
v_sub_f32 v136, v136, v242
v_sub_f32 v137, v137, v242
v_sub_f32 v138, v138, v242
v_sub_f32 v139, v139, v242
v_sub_f32 v140, v140, v242
v_sub_f32 v141, v141, v242
v_sub_f32 v142, v142, v242
v_sub_f32 v143, v143, v242
v_mul_f32 v0, v0, v243
v_mul_f32 v1, v1, v243
v_mul_f32 v2, v2, v243
v_mul_f32 v3, v3, v243
v_mul_f32 v4, v4, v243
v_mul_f32 v5, v5, v243
v_mul_f32 v6, v6, v243
v_mul_f32 v7, v7, v243
v_mul_f32 v8, v8, v243
v_mul_f32 v9, v9, v243
v_mul_f32 v10, v10, v243
v_mul_f32 v11, v11, v243
v_mul_f32 v12, v12, v243
v_mul_f32 v13, v13, v243
v_mul_f32 v14, v14, v243
v_mul_f32 v15, v15, v243
v_mul_f32 v16, v16, v243
v_mul_f32 v17, v17, v243
v_mul_f32 v18, v18, v243
v_mul_f32 v19, v19, v243
v_mul_f32 v20, v20, v243
v_mul_f32 v21, v21, v243
v_mul_f32 v22, v22, v243
v_mul_f32 v23, v23, v243
v_mul_f32 v24, v24, v243
v_mul_f32 v25, v25, v243
v_mul_f32 v26, v26, v243
v_mul_f32 v27, v27, v243
v_mul_f32 v28, v28, v243
v_mul_f32 v29, v29, v243
v_mul_f32 v30, v30, v243
v_mul_f32 v31, v31, v243
v_mul_f32 v32, v32, v243
v_mul_f32 v33, v33, v243
v_mul_f32 v34, v34, v243
v_mul_f32 v35, v35, v243
v_mul_f32 v36, v36, v243
v_mul_f32 v37, v37, v243
v_mul_f32 v38, v38, v243
v_mul_f32 v39, v39, v243
v_mul_f32 v40, v40, v243
v_mul_f32 v41, v41, v243
v_mul_f32 v42, v42, v243
v_mul_f32 v43, v43, v243
v_mul_f32 v44, v44, v243
v_mul_f32 v45, v45, v243
v_mul_f32 v46, v46, v243
v_mul_f32 v47, v47, v243
v_mul_f32 v48, v48, v243
v_mul_f32 v49, v49, v243
v_mul_f32 v50, v50, v243
v_mul_f32 v51, v51, v243
v_mul_f32 v52, v52, v243
v_mul_f32 v53, v53, v243
v_mul_f32 v54, v54, v243
v_mul_f32 v55, v55, v243
v_mul_f32 v56, v56, v243
v_mul_f32 v57, v57, v243
v_mul_f32 v58, v58, v243
v_mul_f32 v59, v59, v243
v_mul_f32 v60, v60, v243
v_mul_f32 v61, v61, v243
v_mul_f32 v62, v62, v243
v_mul_f32 v63, v63, v243
v_mul_f32 v238, v238, v243
v_mul_f32 v239, v239, v243
v_mul_f32 v240, v240, v243
v_mul_f32 v241, v241, v243
s_nop 1
s_branch BACK0
RESC1:
s_nop 15
v_max_f32 v242, 0, v242
v_sub_f32 v243, 0, v242
v_exp_f32 v243, v243
v_sub_f32 v64, v64, v242
v_sub_f32 v65, v65, v242
v_sub_f32 v66, v66, v242
v_sub_f32 v67, v67, v242
v_sub_f32 v68, v68, v242
v_sub_f32 v69, v69, v242
v_sub_f32 v70, v70, v242
v_sub_f32 v71, v71, v242
v_sub_f32 v72, v72, v242
v_sub_f32 v73, v73, v242
v_sub_f32 v74, v74, v242
v_sub_f32 v75, v75, v242
v_sub_f32 v76, v76, v242
v_sub_f32 v77, v77, v242
v_sub_f32 v78, v78, v242
v_sub_f32 v79, v79, v242
v_sub_f32 v80, v80, v242
v_sub_f32 v81, v81, v242
v_sub_f32 v82, v82, v242
v_sub_f32 v83, v83, v242
v_sub_f32 v84, v84, v242
v_sub_f32 v85, v85, v242
v_sub_f32 v86, v86, v242
v_sub_f32 v87, v87, v242
v_sub_f32 v88, v88, v242
v_sub_f32 v89, v89, v242
v_sub_f32 v90, v90, v242
v_sub_f32 v91, v91, v242
v_sub_f32 v92, v92, v242
v_sub_f32 v93, v93, v242
v_sub_f32 v94, v94, v242
v_sub_f32 v95, v95, v242
v_sub_f32 v128, v128, v242
v_sub_f32 v129, v129, v242
v_sub_f32 v130, v130, v242
v_sub_f32 v131, v131, v242
v_sub_f32 v132, v132, v242
v_sub_f32 v133, v133, v242
v_sub_f32 v134, v134, v242
v_sub_f32 v135, v135, v242
v_sub_f32 v136, v136, v242
v_sub_f32 v137, v137, v242
v_sub_f32 v138, v138, v242
v_sub_f32 v139, v139, v242
v_sub_f32 v140, v140, v242
v_sub_f32 v141, v141, v242
v_sub_f32 v142, v142, v242
v_sub_f32 v143, v143, v242
v_mul_f32 v0, v0, v243
v_mul_f32 v1, v1, v243
v_mul_f32 v2, v2, v243
v_mul_f32 v3, v3, v243
v_mul_f32 v4, v4, v243
v_mul_f32 v5, v5, v243
v_mul_f32 v6, v6, v243
v_mul_f32 v7, v7, v243
v_mul_f32 v8, v8, v243
v_mul_f32 v9, v9, v243
v_mul_f32 v10, v10, v243
v_mul_f32 v11, v11, v243
v_mul_f32 v12, v12, v243
v_mul_f32 v13, v13, v243
v_mul_f32 v14, v14, v243
v_mul_f32 v15, v15, v243
v_mul_f32 v16, v16, v243
v_mul_f32 v17, v17, v243
v_mul_f32 v18, v18, v243
v_mul_f32 v19, v19, v243
v_mul_f32 v20, v20, v243
v_mul_f32 v21, v21, v243
v_mul_f32 v22, v22, v243
v_mul_f32 v23, v23, v243
v_mul_f32 v24, v24, v243
v_mul_f32 v25, v25, v243
v_mul_f32 v26, v26, v243
v_mul_f32 v27, v27, v243
v_mul_f32 v28, v28, v243
v_mul_f32 v29, v29, v243
v_mul_f32 v30, v30, v243
v_mul_f32 v31, v31, v243
v_mul_f32 v32, v32, v243
v_mul_f32 v33, v33, v243
v_mul_f32 v34, v34, v243
v_mul_f32 v35, v35, v243
v_mul_f32 v36, v36, v243
v_mul_f32 v37, v37, v243
v_mul_f32 v38, v38, v243
v_mul_f32 v39, v39, v243
v_mul_f32 v40, v40, v243
v_mul_f32 v41, v41, v243
v_mul_f32 v42, v42, v243
v_mul_f32 v43, v43, v243
v_mul_f32 v44, v44, v243
v_mul_f32 v45, v45, v243
v_mul_f32 v46, v46, v243
v_mul_f32 v47, v47, v243
v_mul_f32 v48, v48, v243
v_mul_f32 v49, v49, v243
v_mul_f32 v50, v50, v243
v_mul_f32 v51, v51, v243
v_mul_f32 v52, v52, v243
v_mul_f32 v53, v53, v243
v_mul_f32 v54, v54, v243
v_mul_f32 v55, v55, v243
v_mul_f32 v56, v56, v243
v_mul_f32 v57, v57, v243
v_mul_f32 v58, v58, v243
v_mul_f32 v59, v59, v243
v_mul_f32 v60, v60, v243
v_mul_f32 v61, v61, v243
v_mul_f32 v62, v62, v243
v_mul_f32 v63, v63, v243
v_mul_f32 v238, v238, v243
v_mul_f32 v239, v239, v243
v_mul_f32 v240, v240, v243
v_mul_f32 v241, v241, v243
s_nop 1
s_branch BACK1
RESC2:
s_nop 15
v_max_f32 v242, 0, v242
v_sub_f32 v243, 0, v242
v_exp_f32 v243, v243
v_sub_f32 v96, v96, v242
v_sub_f32 v97, v97, v242
v_sub_f32 v98, v98, v242
v_sub_f32 v99, v99, v242
v_sub_f32 v100, v100, v242
v_sub_f32 v101, v101, v242
v_sub_f32 v102, v102, v242
v_sub_f32 v103, v103, v242
v_sub_f32 v104, v104, v242
v_sub_f32 v105, v105, v242
v_sub_f32 v106, v106, v242
v_sub_f32 v107, v107, v242
v_sub_f32 v108, v108, v242
v_sub_f32 v109, v109, v242
v_sub_f32 v110, v110, v242
v_sub_f32 v111, v111, v242
v_sub_f32 v112, v112, v242
v_sub_f32 v113, v113, v242
v_sub_f32 v114, v114, v242
v_sub_f32 v115, v115, v242
v_sub_f32 v116, v116, v242
v_sub_f32 v117, v117, v242
v_sub_f32 v118, v118, v242
v_sub_f32 v119, v119, v242
v_sub_f32 v120, v120, v242
v_sub_f32 v121, v121, v242
v_sub_f32 v122, v122, v242
v_sub_f32 v123, v123, v242
v_sub_f32 v124, v124, v242
v_sub_f32 v125, v125, v242
v_sub_f32 v126, v126, v242
v_sub_f32 v127, v127, v242
v_sub_f32 v128, v128, v242
v_sub_f32 v129, v129, v242
v_sub_f32 v130, v130, v242
v_sub_f32 v131, v131, v242
v_sub_f32 v132, v132, v242
v_sub_f32 v133, v133, v242
v_sub_f32 v134, v134, v242
v_sub_f32 v135, v135, v242
v_sub_f32 v136, v136, v242
v_sub_f32 v137, v137, v242
v_sub_f32 v138, v138, v242
v_sub_f32 v139, v139, v242
v_sub_f32 v140, v140, v242
v_sub_f32 v141, v141, v242
v_sub_f32 v142, v142, v242
v_sub_f32 v143, v143, v242
v_mul_f32 v0, v0, v243
v_mul_f32 v1, v1, v243
v_mul_f32 v2, v2, v243
v_mul_f32 v3, v3, v243
v_mul_f32 v4, v4, v243
v_mul_f32 v5, v5, v243
v_mul_f32 v6, v6, v243
v_mul_f32 v7, v7, v243
v_mul_f32 v8, v8, v243
v_mul_f32 v9, v9, v243
v_mul_f32 v10, v10, v243
v_mul_f32 v11, v11, v243
v_mul_f32 v12, v12, v243
v_mul_f32 v13, v13, v243
v_mul_f32 v14, v14, v243
v_mul_f32 v15, v15, v243
v_mul_f32 v16, v16, v243
v_mul_f32 v17, v17, v243
v_mul_f32 v18, v18, v243
v_mul_f32 v19, v19, v243
v_mul_f32 v20, v20, v243
v_mul_f32 v21, v21, v243
v_mul_f32 v22, v22, v243
v_mul_f32 v23, v23, v243
v_mul_f32 v24, v24, v243
v_mul_f32 v25, v25, v243
v_mul_f32 v26, v26, v243
v_mul_f32 v27, v27, v243
v_mul_f32 v28, v28, v243
v_mul_f32 v29, v29, v243
v_mul_f32 v30, v30, v243
v_mul_f32 v31, v31, v243
v_mul_f32 v32, v32, v243
v_mul_f32 v33, v33, v243
v_mul_f32 v34, v34, v243
v_mul_f32 v35, v35, v243
v_mul_f32 v36, v36, v243
v_mul_f32 v37, v37, v243
v_mul_f32 v38, v38, v243
v_mul_f32 v39, v39, v243
v_mul_f32 v40, v40, v243
v_mul_f32 v41, v41, v243
v_mul_f32 v42, v42, v243
v_mul_f32 v43, v43, v243
v_mul_f32 v44, v44, v243
v_mul_f32 v45, v45, v243
v_mul_f32 v46, v46, v243
v_mul_f32 v47, v47, v243
v_mul_f32 v48, v48, v243
v_mul_f32 v49, v49, v243
v_mul_f32 v50, v50, v243
v_mul_f32 v51, v51, v243
v_mul_f32 v52, v52, v243
v_mul_f32 v53, v53, v243
v_mul_f32 v54, v54, v243
v_mul_f32 v55, v55, v243
v_mul_f32 v56, v56, v243
v_mul_f32 v57, v57, v243
v_mul_f32 v58, v58, v243
v_mul_f32 v59, v59, v243
v_mul_f32 v60, v60, v243
v_mul_f32 v61, v61, v243
v_mul_f32 v62, v62, v243
v_mul_f32 v63, v63, v243
v_mul_f32 v238, v238, v243
v_mul_f32 v239, v239, v243
v_mul_f32 v240, v240, v243
v_mul_f32 v241, v241, v243
s_nop 1
s_branch BACK2
RESC3:
s_nop 15
v_max_f32 v242, 0, v242
v_sub_f32 v243, 0, v242
v_exp_f32 v243, v243
v_sub_f32 v64, v64, v242
v_sub_f32 v65, v65, v242
v_sub_f32 v66, v66, v242
v_sub_f32 v67, v67, v242
v_sub_f32 v68, v68, v242
v_sub_f32 v69, v69, v242
v_sub_f32 v70, v70, v242
v_sub_f32 v71, v71, v242
v_sub_f32 v72, v72, v242
v_sub_f32 v73, v73, v242
v_sub_f32 v74, v74, v242
v_sub_f32 v75, v75, v242
v_sub_f32 v76, v76, v242
v_sub_f32 v77, v77, v242
v_sub_f32 v78, v78, v242
v_sub_f32 v79, v79, v242
v_sub_f32 v80, v80, v242
v_sub_f32 v81, v81, v242
v_sub_f32 v82, v82, v242
v_sub_f32 v83, v83, v242
v_sub_f32 v84, v84, v242
v_sub_f32 v85, v85, v242
v_sub_f32 v86, v86, v242
v_sub_f32 v87, v87, v242
v_sub_f32 v88, v88, v242
v_sub_f32 v89, v89, v242
v_sub_f32 v90, v90, v242
v_sub_f32 v91, v91, v242
v_sub_f32 v92, v92, v242
v_sub_f32 v93, v93, v242
v_sub_f32 v94, v94, v242
v_sub_f32 v95, v95, v242
v_sub_f32 v128, v128, v242
v_sub_f32 v129, v129, v242
v_sub_f32 v130, v130, v242
v_sub_f32 v131, v131, v242
v_sub_f32 v132, v132, v242
v_sub_f32 v133, v133, v242
v_sub_f32 v134, v134, v242
v_sub_f32 v135, v135, v242
v_sub_f32 v136, v136, v242
v_sub_f32 v137, v137, v242
v_sub_f32 v138, v138, v242
v_sub_f32 v139, v139, v242
v_sub_f32 v140, v140, v242
v_sub_f32 v141, v141, v242
v_sub_f32 v142, v142, v242
v_sub_f32 v143, v143, v242
v_mul_f32 v0, v0, v243
v_mul_f32 v1, v1, v243
v_mul_f32 v2, v2, v243
v_mul_f32 v3, v3, v243
v_mul_f32 v4, v4, v243
v_mul_f32 v5, v5, v243
v_mul_f32 v6, v6, v243
v_mul_f32 v7, v7, v243
v_mul_f32 v8, v8, v243
v_mul_f32 v9, v9, v243
v_mul_f32 v10, v10, v243
v_mul_f32 v11, v11, v243
v_mul_f32 v12, v12, v243
v_mul_f32 v13, v13, v243
v_mul_f32 v14, v14, v243
v_mul_f32 v15, v15, v243
v_mul_f32 v16, v16, v243
v_mul_f32 v17, v17, v243
v_mul_f32 v18, v18, v243
v_mul_f32 v19, v19, v243
v_mul_f32 v20, v20, v243
v_mul_f32 v21, v21, v243
v_mul_f32 v22, v22, v243
v_mul_f32 v23, v23, v243
v_mul_f32 v24, v24, v243
v_mul_f32 v25, v25, v243
v_mul_f32 v26, v26, v243
v_mul_f32 v27, v27, v243
v_mul_f32 v28, v28, v243
v_mul_f32 v29, v29, v243
v_mul_f32 v30, v30, v243
v_mul_f32 v31, v31, v243
v_mul_f32 v32, v32, v243
v_mul_f32 v33, v33, v243
v_mul_f32 v34, v34, v243
v_mul_f32 v35, v35, v243
v_mul_f32 v36, v36, v243
v_mul_f32 v37, v37, v243
v_mul_f32 v38, v38, v243
v_mul_f32 v39, v39, v243
v_mul_f32 v40, v40, v243
v_mul_f32 v41, v41, v243
v_mul_f32 v42, v42, v243
v_mul_f32 v43, v43, v243
v_mul_f32 v44, v44, v243
v_mul_f32 v45, v45, v243
v_mul_f32 v46, v46, v243
v_mul_f32 v47, v47, v243
v_mul_f32 v48, v48, v243
v_mul_f32 v49, v49, v243
v_mul_f32 v50, v50, v243
v_mul_f32 v51, v51, v243
v_mul_f32 v52, v52, v243
v_mul_f32 v53, v53, v243
v_mul_f32 v54, v54, v243
v_mul_f32 v55, v55, v243
v_mul_f32 v56, v56, v243
v_mul_f32 v57, v57, v243
v_mul_f32 v58, v58, v243
v_mul_f32 v59, v59, v243
v_mul_f32 v60, v60, v243
v_mul_f32 v61, v61, v243
v_mul_f32 v62, v62, v243
v_mul_f32 v63, v63, v243
v_mul_f32 v238, v238, v243
v_mul_f32 v239, v239, v243
v_mul_f32 v240, v240, v243
v_mul_f32 v241, v241, v243
s_nop 1
s_branch BACK3
RESC12:
s_nop 15
v_max_f32 v242, 0, v242
v_sub_f32 v243, 0, v242
v_exp_f32 v243, v243
v_sub_f32 v96, v96, v242
v_sub_f32 v97, v97, v242
v_sub_f32 v98, v98, v242
v_sub_f32 v99, v99, v242
v_sub_f32 v100, v100, v242
v_sub_f32 v101, v101, v242
v_sub_f32 v102, v102, v242
v_sub_f32 v103, v103, v242
v_sub_f32 v104, v104, v242
v_sub_f32 v105, v105, v242
v_sub_f32 v106, v106, v242
v_sub_f32 v107, v107, v242
v_sub_f32 v108, v108, v242
v_sub_f32 v109, v109, v242
v_sub_f32 v110, v110, v242
v_sub_f32 v111, v111, v242
v_sub_f32 v112, v112, v242
v_sub_f32 v113, v113, v242
v_sub_f32 v114, v114, v242
v_sub_f32 v115, v115, v242
v_sub_f32 v116, v116, v242
v_sub_f32 v117, v117, v242
v_sub_f32 v118, v118, v242
v_sub_f32 v119, v119, v242
v_sub_f32 v120, v120, v242
v_sub_f32 v121, v121, v242
v_sub_f32 v122, v122, v242
v_sub_f32 v123, v123, v242
v_sub_f32 v124, v124, v242
v_sub_f32 v125, v125, v242
v_sub_f32 v126, v126, v242
v_sub_f32 v127, v127, v242
v_sub_f32 v128, v128, v242
v_sub_f32 v129, v129, v242
v_sub_f32 v130, v130, v242
v_sub_f32 v131, v131, v242
v_sub_f32 v132, v132, v242
v_sub_f32 v133, v133, v242
v_sub_f32 v134, v134, v242
v_sub_f32 v135, v135, v242
v_sub_f32 v136, v136, v242
v_sub_f32 v137, v137, v242
v_sub_f32 v138, v138, v242
v_sub_f32 v139, v139, v242
v_sub_f32 v140, v140, v242
v_sub_f32 v141, v141, v242
v_sub_f32 v142, v142, v242
v_sub_f32 v143, v143, v242
v_mul_f32 v0, v0, v243
v_mul_f32 v1, v1, v243
v_mul_f32 v2, v2, v243
v_mul_f32 v3, v3, v243
v_mul_f32 v4, v4, v243
v_mul_f32 v5, v5, v243
v_mul_f32 v6, v6, v243
v_mul_f32 v7, v7, v243
v_mul_f32 v8, v8, v243
v_mul_f32 v9, v9, v243
v_mul_f32 v10, v10, v243
v_mul_f32 v11, v11, v243
v_mul_f32 v12, v12, v243
v_mul_f32 v13, v13, v243
v_mul_f32 v14, v14, v243
v_mul_f32 v15, v15, v243
v_mul_f32 v16, v16, v243
v_mul_f32 v17, v17, v243
v_mul_f32 v18, v18, v243
v_mul_f32 v19, v19, v243
v_mul_f32 v20, v20, v243
v_mul_f32 v21, v21, v243
v_mul_f32 v22, v22, v243
v_mul_f32 v23, v23, v243
v_mul_f32 v24, v24, v243
v_mul_f32 v25, v25, v243
v_mul_f32 v26, v26, v243
v_mul_f32 v27, v27, v243
v_mul_f32 v28, v28, v243
v_mul_f32 v29, v29, v243
v_mul_f32 v30, v30, v243
v_mul_f32 v31, v31, v243
v_mul_f32 v32, v32, v243
v_mul_f32 v33, v33, v243
v_mul_f32 v34, v34, v243
v_mul_f32 v35, v35, v243
v_mul_f32 v36, v36, v243
v_mul_f32 v37, v37, v243
v_mul_f32 v38, v38, v243
v_mul_f32 v39, v39, v243
v_mul_f32 v40, v40, v243
v_mul_f32 v41, v41, v243
v_mul_f32 v42, v42, v243
v_mul_f32 v43, v43, v243
v_mul_f32 v44, v44, v243
v_mul_f32 v45, v45, v243
v_mul_f32 v46, v46, v243
v_mul_f32 v47, v47, v243
v_mul_f32 v48, v48, v243
v_mul_f32 v49, v49, v243
v_mul_f32 v50, v50, v243
v_mul_f32 v51, v51, v243
v_mul_f32 v52, v52, v243
v_mul_f32 v53, v53, v243
v_mul_f32 v54, v54, v243
v_mul_f32 v55, v55, v243
v_mul_f32 v56, v56, v243
v_mul_f32 v57, v57, v243
v_mul_f32 v58, v58, v243
v_mul_f32 v59, v59, v243
v_mul_f32 v60, v60, v243
v_mul_f32 v61, v61, v243
v_mul_f32 v62, v62, v243
v_mul_f32 v63, v63, v243
v_mul_f32 v238, v238, v243
v_mul_f32 v239, v239, v243
v_mul_f32 v240, v240, v243
v_mul_f32 v241, v241, v243
s_nop 1
s_branch BACK12
RESC13:
s_nop 15
v_max_f32 v242, 0, v242
v_sub_f32 v243, 0, v242
v_exp_f32 v243, v243
v_sub_f32 v64, v64, v242
v_sub_f32 v65, v65, v242
v_sub_f32 v66, v66, v242
v_sub_f32 v67, v67, v242
v_sub_f32 v68, v68, v242
v_sub_f32 v69, v69, v242
v_sub_f32 v70, v70, v242
v_sub_f32 v71, v71, v242
v_sub_f32 v72, v72, v242
v_sub_f32 v73, v73, v242
v_sub_f32 v74, v74, v242
v_sub_f32 v75, v75, v242
v_sub_f32 v76, v76, v242
v_sub_f32 v77, v77, v242
v_sub_f32 v78, v78, v242
v_sub_f32 v79, v79, v242
v_sub_f32 v80, v80, v242
v_sub_f32 v81, v81, v242
v_sub_f32 v82, v82, v242
v_sub_f32 v83, v83, v242
v_sub_f32 v84, v84, v242
v_sub_f32 v85, v85, v242
v_sub_f32 v86, v86, v242
v_sub_f32 v87, v87, v242
v_sub_f32 v88, v88, v242
v_sub_f32 v89, v89, v242
v_sub_f32 v90, v90, v242
v_sub_f32 v91, v91, v242
v_sub_f32 v92, v92, v242
v_sub_f32 v93, v93, v242
v_sub_f32 v94, v94, v242
v_sub_f32 v95, v95, v242
v_sub_f32 v128, v128, v242
v_sub_f32 v129, v129, v242
v_sub_f32 v130, v130, v242
v_sub_f32 v131, v131, v242
v_sub_f32 v132, v132, v242
v_sub_f32 v133, v133, v242
v_sub_f32 v134, v134, v242
v_sub_f32 v135, v135, v242
v_sub_f32 v136, v136, v242
v_sub_f32 v137, v137, v242
v_sub_f32 v138, v138, v242
v_sub_f32 v139, v139, v242
v_sub_f32 v140, v140, v242
v_sub_f32 v141, v141, v242
v_sub_f32 v142, v142, v242
v_sub_f32 v143, v143, v242
v_mul_f32 v0, v0, v243
v_mul_f32 v1, v1, v243
v_mul_f32 v2, v2, v243
v_mul_f32 v3, v3, v243
v_mul_f32 v4, v4, v243
v_mul_f32 v5, v5, v243
v_mul_f32 v6, v6, v243
v_mul_f32 v7, v7, v243
v_mul_f32 v8, v8, v243
v_mul_f32 v9, v9, v243
v_mul_f32 v10, v10, v243
v_mul_f32 v11, v11, v243
v_mul_f32 v12, v12, v243
v_mul_f32 v13, v13, v243
v_mul_f32 v14, v14, v243
v_mul_f32 v15, v15, v243
v_mul_f32 v16, v16, v243
v_mul_f32 v17, v17, v243
v_mul_f32 v18, v18, v243
v_mul_f32 v19, v19, v243
v_mul_f32 v20, v20, v243
v_mul_f32 v21, v21, v243
v_mul_f32 v22, v22, v243
v_mul_f32 v23, v23, v243
v_mul_f32 v24, v24, v243
v_mul_f32 v25, v25, v243
v_mul_f32 v26, v26, v243
v_mul_f32 v27, v27, v243
v_mul_f32 v28, v28, v243
v_mul_f32 v29, v29, v243
v_mul_f32 v30, v30, v243
v_mul_f32 v31, v31, v243
v_mul_f32 v32, v32, v243
v_mul_f32 v33, v33, v243
v_mul_f32 v34, v34, v243
v_mul_f32 v35, v35, v243
v_mul_f32 v36, v36, v243
v_mul_f32 v37, v37, v243
v_mul_f32 v38, v38, v243
v_mul_f32 v39, v39, v243
v_mul_f32 v40, v40, v243
v_mul_f32 v41, v41, v243
v_mul_f32 v42, v42, v243
v_mul_f32 v43, v43, v243
v_mul_f32 v44, v44, v243
v_mul_f32 v45, v45, v243
v_mul_f32 v46, v46, v243
v_mul_f32 v47, v47, v243
v_mul_f32 v48, v48, v243
v_mul_f32 v49, v49, v243
v_mul_f32 v50, v50, v243
v_mul_f32 v51, v51, v243
v_mul_f32 v52, v52, v243
v_mul_f32 v53, v53, v243
v_mul_f32 v54, v54, v243
v_mul_f32 v55, v55, v243
v_mul_f32 v56, v56, v243
v_mul_f32 v57, v57, v243
v_mul_f32 v58, v58, v243
v_mul_f32 v59, v59, v243
v_mul_f32 v60, v60, v243
v_mul_f32 v61, v61, v243
v_mul_f32 v62, v62, v243
v_mul_f32 v63, v63, v243
v_mul_f32 v238, v238, v243
v_mul_f32 v239, v239, v243
v_mul_f32 v240, v240, v243
v_mul_f32 v241, v241, v243
s_nop 1
s_branch BACK13
RESC14:
s_nop 15
v_max_f32 v242, 0, v242
v_sub_f32 v243, 0, v242
v_exp_f32 v243, v243
v_sub_f32 v96, v96, v242
v_sub_f32 v97, v97, v242
v_sub_f32 v98, v98, v242
v_sub_f32 v99, v99, v242
v_sub_f32 v100, v100, v242
v_sub_f32 v101, v101, v242
v_sub_f32 v102, v102, v242
v_sub_f32 v103, v103, v242
v_sub_f32 v104, v104, v242
v_sub_f32 v105, v105, v242
v_sub_f32 v106, v106, v242
v_sub_f32 v107, v107, v242
v_sub_f32 v108, v108, v242
v_sub_f32 v109, v109, v242
v_sub_f32 v110, v110, v242
v_sub_f32 v111, v111, v242
v_sub_f32 v112, v112, v242
v_sub_f32 v113, v113, v242
v_sub_f32 v114, v114, v242
v_sub_f32 v115, v115, v242
v_sub_f32 v116, v116, v242
v_sub_f32 v117, v117, v242
v_sub_f32 v118, v118, v242
v_sub_f32 v119, v119, v242
v_sub_f32 v120, v120, v242
v_sub_f32 v121, v121, v242
v_sub_f32 v122, v122, v242
v_sub_f32 v123, v123, v242
v_sub_f32 v124, v124, v242
v_sub_f32 v125, v125, v242
v_sub_f32 v126, v126, v242
v_sub_f32 v127, v127, v242
v_sub_f32 v128, v128, v242
v_sub_f32 v129, v129, v242
v_sub_f32 v130, v130, v242
v_sub_f32 v131, v131, v242
v_sub_f32 v132, v132, v242
v_sub_f32 v133, v133, v242
v_sub_f32 v134, v134, v242
v_sub_f32 v135, v135, v242
v_sub_f32 v136, v136, v242
v_sub_f32 v137, v137, v242
v_sub_f32 v138, v138, v242
v_sub_f32 v139, v139, v242
v_sub_f32 v140, v140, v242
v_sub_f32 v141, v141, v242
v_sub_f32 v142, v142, v242
v_sub_f32 v143, v143, v242
v_mul_f32 v0, v0, v243
v_mul_f32 v1, v1, v243
v_mul_f32 v2, v2, v243
v_mul_f32 v3, v3, v243
v_mul_f32 v4, v4, v243
v_mul_f32 v5, v5, v243
v_mul_f32 v6, v6, v243
v_mul_f32 v7, v7, v243
v_mul_f32 v8, v8, v243
v_mul_f32 v9, v9, v243
v_mul_f32 v10, v10, v243
v_mul_f32 v11, v11, v243
v_mul_f32 v12, v12, v243
v_mul_f32 v13, v13, v243
v_mul_f32 v14, v14, v243
v_mul_f32 v15, v15, v243
v_mul_f32 v16, v16, v243
v_mul_f32 v17, v17, v243
v_mul_f32 v18, v18, v243
v_mul_f32 v19, v19, v243
v_mul_f32 v20, v20, v243
v_mul_f32 v21, v21, v243
v_mul_f32 v22, v22, v243
v_mul_f32 v23, v23, v243
v_mul_f32 v24, v24, v243
v_mul_f32 v25, v25, v243
v_mul_f32 v26, v26, v243
v_mul_f32 v27, v27, v243
v_mul_f32 v28, v28, v243
v_mul_f32 v29, v29, v243
v_mul_f32 v30, v30, v243
v_mul_f32 v31, v31, v243
v_mul_f32 v32, v32, v243
v_mul_f32 v33, v33, v243
v_mul_f32 v34, v34, v243
v_mul_f32 v35, v35, v243
v_mul_f32 v36, v36, v243
v_mul_f32 v37, v37, v243
v_mul_f32 v38, v38, v243
v_mul_f32 v39, v39, v243
v_mul_f32 v40, v40, v243
v_mul_f32 v41, v41, v243
v_mul_f32 v42, v42, v243
v_mul_f32 v43, v43, v243
v_mul_f32 v44, v44, v243
v_mul_f32 v45, v45, v243
v_mul_f32 v46, v46, v243
v_mul_f32 v47, v47, v243
v_mul_f32 v48, v48, v243
v_mul_f32 v49, v49, v243
v_mul_f32 v50, v50, v243
v_mul_f32 v51, v51, v243
v_mul_f32 v52, v52, v243
v_mul_f32 v53, v53, v243
v_mul_f32 v54, v54, v243
v_mul_f32 v55, v55, v243
v_mul_f32 v56, v56, v243
v_mul_f32 v57, v57, v243
v_mul_f32 v58, v58, v243
v_mul_f32 v59, v59, v243
v_mul_f32 v60, v60, v243
v_mul_f32 v61, v61, v243
v_mul_f32 v62, v62, v243
v_mul_f32 v63, v63, v243
v_mul_f32 v238, v238, v243
v_mul_f32 v239, v239, v243
v_mul_f32 v240, v240, v243
v_mul_f32 v241, v241, v243
s_nop 1
s_branch BACK14
LOADER:
v_lshrrev_b32 v1, 4, v245
v_and_b32 v2, 15, v245
v_add_u32 v3, 0, v1
v_xor_b32 v3, v3, v2
v_lshlrev_b32 v3, 4, v3
v_lshl_add_u32 v10, v1, 8, v3
v_add_u32 v3, 4, v1
v_xor_b32 v3, v3, v2
v_lshlrev_b32 v3, 4, v3
v_lshl_add_u32 v11, v1, 8, v3
v_add_u32 v3, 8, v1
v_xor_b32 v3, v3, v2
v_lshlrev_b32 v3, 4, v3
v_lshl_add_u32 v12, v1, 8, v3
v_add_u32 v3, 12, v1
v_xor_b32 v3, v3, v2
v_lshlrev_b32 v3, 4, v3
v_lshl_add_u32 v13, v1, 8, v3
v_lshlrev_b32 v3, 2, v1
v_xor_b32 v3, v3, v2
v_lshlrev_b32 v3, 4, v3
v_lshl_add_u32 v14, v1, 8, v3
v_lshl_add_u32 v15, v1, 13, v3
s_lshl_b32 s28, s6, 5
s_add_u32 s28, s28, s7
s_lshl_b32 s28, s28, 18
s_add_u32 s8, s34, s28
s_addc_u32 s9, s35, 0
s_mov_b32 s10, 262144
s_mov_b32 s11, 0x20000
s_add_u32 s12, s36, s28
s_addc_u32 s13, s37, 0
s_mov_b32 s14, 262144
s_mov_b32 s15, 0x20000
s_lshl_b32 s28, s7, 8
s_sub_u32 s29, 0x400000, s28
s_add_u32 s16, s38, s28
s_addc_u32 s17, s39, 0
s_mov_b32 s18, s29
s_mov_b32 s19, 0x20000
s_mov_b32 m0, 81920
s_mov_b32 s52, 0
buffer_load_dwordx4 v15, s[16:19], s52 offen lds
s_mov_b32 m0, 82944
s_mov_b32 s52, 32768
buffer_load_dwordx4 v15, s[16:19], s52 offen lds
s_mov_b32 m0, 83968
s_mov_b32 s52, 65536
buffer_load_dwordx4 v15, s[16:19], s52 offen lds
s_mov_b32 m0, 84992
s_mov_b32 s52, 98304
buffer_load_dwordx4 v15, s[16:19], s52 offen lds
s_mov_b32 m0, 86016
s_mov_b32 s52, 131072
buffer_load_dwordx4 v15, s[16:19], s52 offen lds
s_mov_b32 m0, 87040
s_mov_b32 s52, 163840
buffer_load_dwordx4 v15, s[16:19], s52 offen lds
s_mov_b32 m0, 88064
s_mov_b32 s52, 196608
buffer_load_dwordx4 v15, s[16:19], s52 offen lds
s_mov_b32 m0, 89088
s_mov_b32 s52, 229376
buffer_load_dwordx4 v15, s[16:19], s52 offen lds
s_mov_b32 m0, 90112
s_mov_b32 s52, 262144
buffer_load_dwordx4 v15, s[16:19], s52 offen lds
s_mov_b32 m0, 91136
s_mov_b32 s52, 294912
buffer_load_dwordx4 v15, s[16:19], s52 offen lds
s_mov_b32 m0, 92160
s_mov_b32 s52, 327680
buffer_load_dwordx4 v15, s[16:19], s52 offen lds
s_mov_b32 m0, 93184
s_mov_b32 s52, 360448
buffer_load_dwordx4 v15, s[16:19], s52 offen lds
s_mov_b32 m0, 94208
s_mov_b32 s52, 393216
buffer_load_dwordx4 v15, s[16:19], s52 offen lds
s_mov_b32 m0, 95232
s_mov_b32 s52, 425984
buffer_load_dwordx4 v15, s[16:19], s52 offen lds
s_mov_b32 m0, 96256
s_mov_b32 s52, 458752
buffer_load_dwordx4 v15, s[16:19], s52 offen lds
s_mov_b32 m0, 97280
s_mov_b32 s52, 491520
buffer_load_dwordx4 v15, s[16:19], s52 offen lds
s_mov_b32 m0, 98304
s_mov_b32 s52, 524288
buffer_load_dwordx4 v15, s[16:19], s52 offen lds
s_mov_b32 m0, 99328
s_mov_b32 s52, 557056
buffer_load_dwordx4 v15, s[16:19], s52 offen lds
s_mov_b32 m0, 100352
s_mov_b32 s52, 589824
buffer_load_dwordx4 v15, s[16:19], s52 offen lds
s_mov_b32 m0, 101376
s_mov_b32 s52, 622592
buffer_load_dwordx4 v15, s[16:19], s52 offen lds
s_mov_b32 m0, 102400
s_mov_b32 s52, 655360
buffer_load_dwordx4 v15, s[16:19], s52 offen lds
s_mov_b32 m0, 103424
s_mov_b32 s52, 688128
buffer_load_dwordx4 v15, s[16:19], s52 offen lds
s_mov_b32 m0, 104448
s_mov_b32 s52, 720896
buffer_load_dwordx4 v15, s[16:19], s52 offen lds
s_mov_b32 m0, 105472
s_mov_b32 s52, 753664
buffer_load_dwordx4 v15, s[16:19], s52 offen lds
s_mov_b32 m0, 106496
s_mov_b32 s52, 786432
buffer_load_dwordx4 v15, s[16:19], s52 offen lds
s_mov_b32 m0, 107520
s_mov_b32 s52, 819200
buffer_load_dwordx4 v15, s[16:19], s52 offen lds
s_mov_b32 m0, 108544
s_mov_b32 s52, 851968
buffer_load_dwordx4 v15, s[16:19], s52 offen lds
s_mov_b32 m0, 109568
s_mov_b32 s52, 884736
buffer_load_dwordx4 v15, s[16:19], s52 offen lds
s_mov_b32 m0, 110592
s_mov_b32 s52, 917504
buffer_load_dwordx4 v15, s[16:19], s52 offen lds
s_mov_b32 m0, 111616
s_mov_b32 s52, 950272
buffer_load_dwordx4 v15, s[16:19], s52 offen lds
s_mov_b32 m0, 112640
s_mov_b32 s52, 983040
buffer_load_dwordx4 v15, s[16:19], s52 offen lds
s_mov_b32 m0, 113664
s_mov_b32 s52, 1015808
buffer_load_dwordx4 v15, s[16:19], s52 offen lds
s_mov_b32 m0, 0
s_mov_b32 s52, 0
buffer_load_dwordx4 v10, s[8:11], s52 offen offset:0 nt lds
buffer_load_dwordx4 v11, s[8:11], s52 offen offset:1024 nt lds
buffer_load_dwordx4 v12, s[8:11], s52 offen offset:2048 nt lds
buffer_load_dwordx4 v13, s[8:11], s52 offen offset:3072 nt lds
s_mov_b32 m0, 4096
s_mov_b32 s52, 4096
buffer_load_dwordx4 v10, s[8:11], s52 offen offset:0 nt lds
buffer_load_dwordx4 v11, s[8:11], s52 offen offset:1024 nt lds
buffer_load_dwordx4 v12, s[8:11], s52 offen offset:2048 nt lds
buffer_load_dwordx4 v13, s[8:11], s52 offen offset:3072 nt lds
s_mov_b32 m0, 8192
s_mov_b32 s52, 8192
buffer_load_dwordx4 v10, s[8:11], s52 offen offset:0 nt lds
buffer_load_dwordx4 v11, s[8:11], s52 offen offset:1024 nt lds
buffer_load_dwordx4 v12, s[8:11], s52 offen offset:2048 nt lds
buffer_load_dwordx4 v13, s[8:11], s52 offen offset:3072 nt lds
s_mov_b32 m0, 12288
s_mov_b32 s52, 12288
buffer_load_dwordx4 v10, s[8:11], s52 offen offset:0 nt lds
buffer_load_dwordx4 v11, s[8:11], s52 offen offset:1024 nt lds
buffer_load_dwordx4 v12, s[8:11], s52 offen offset:2048 nt lds
buffer_load_dwordx4 v13, s[8:11], s52 offen offset:3072 nt lds
s_mov_b32 m0, 16384
s_mov_b32 s52, 16384
buffer_load_dwordx4 v10, s[8:11], s52 offen offset:0 nt lds
buffer_load_dwordx4 v11, s[8:11], s52 offen offset:1024 nt lds
buffer_load_dwordx4 v12, s[8:11], s52 offen offset:2048 nt lds
buffer_load_dwordx4 v13, s[8:11], s52 offen offset:3072 nt lds
s_mov_b32 m0, 20480
s_mov_b32 s52, 20480
buffer_load_dwordx4 v10, s[8:11], s52 offen offset:0 nt lds
buffer_load_dwordx4 v11, s[8:11], s52 offen offset:1024 nt lds
buffer_load_dwordx4 v12, s[8:11], s52 offen offset:2048 nt lds
buffer_load_dwordx4 v13, s[8:11], s52 offen offset:3072 nt lds
s_mov_b32 m0, 24576
s_mov_b32 s52, 24576
buffer_load_dwordx4 v10, s[8:11], s52 offen offset:0 nt lds
buffer_load_dwordx4 v11, s[8:11], s52 offen offset:1024 nt lds
buffer_load_dwordx4 v12, s[8:11], s52 offen offset:2048 nt lds
buffer_load_dwordx4 v13, s[8:11], s52 offen offset:3072 nt lds
s_mov_b32 m0, 28672
s_mov_b32 s52, 28672
buffer_load_dwordx4 v10, s[8:11], s52 offen offset:0 nt lds
buffer_load_dwordx4 v11, s[8:11], s52 offen offset:1024 nt lds
buffer_load_dwordx4 v12, s[8:11], s52 offen offset:2048 nt lds
buffer_load_dwordx4 v13, s[8:11], s52 offen offset:3072 nt lds
LD_ROUND:
s_waitcnt vmcnt(48)
s_barrier
s_mov_b32 m0, 114688
s_mov_b32 s52, 1048576
buffer_load_dwordx4 v15, s[16:19], s52 offen lds
s_mov_b32 m0, 115712
s_mov_b32 s52, 1081344
buffer_load_dwordx4 v15, s[16:19], s52 offen lds
s_mov_b32 m0, 116736
s_mov_b32 s52, 1114112
buffer_load_dwordx4 v15, s[16:19], s52 offen lds
s_mov_b32 m0, 117760
s_mov_b32 s52, 1146880
buffer_load_dwordx4 v15, s[16:19], s52 offen lds
s_mov_b32 m0, 118784
s_mov_b32 s52, 1179648
buffer_load_dwordx4 v15, s[16:19], s52 offen lds
s_mov_b32 m0, 119808
s_mov_b32 s52, 1212416
buffer_load_dwordx4 v15, s[16:19], s52 offen lds
s_mov_b32 m0, 120832
s_mov_b32 s52, 1245184
buffer_load_dwordx4 v15, s[16:19], s52 offen lds
s_mov_b32 m0, 121856
s_mov_b32 s52, 1277952
buffer_load_dwordx4 v15, s[16:19], s52 offen lds
s_mov_b32 m0, 122880
s_mov_b32 s52, 1310720
buffer_load_dwordx4 v15, s[16:19], s52 offen lds
s_mov_b32 m0, 123904
s_mov_b32 s52, 1343488
buffer_load_dwordx4 v15, s[16:19], s52 offen lds
s_mov_b32 m0, 124928
s_mov_b32 s52, 1376256
buffer_load_dwordx4 v15, s[16:19], s52 offen lds
s_mov_b32 m0, 125952
s_mov_b32 s52, 1409024
buffer_load_dwordx4 v15, s[16:19], s52 offen lds
s_mov_b32 m0, 126976
s_mov_b32 s52, 1441792
buffer_load_dwordx4 v15, s[16:19], s52 offen lds
s_mov_b32 m0, 128000
s_mov_b32 s52, 1474560
buffer_load_dwordx4 v15, s[16:19], s52 offen lds
s_mov_b32 m0, 129024
s_mov_b32 s52, 1507328
buffer_load_dwordx4 v15, s[16:19], s52 offen lds
s_mov_b32 m0, 130048
s_mov_b32 s52, 1540096
buffer_load_dwordx4 v15, s[16:19], s52 offen lds
s_mov_b32 m0, 65536
s_mov_b32 s52, 0
buffer_load_dwordx4 v14, s[12:15], s52 offen offset:0 nt lds
buffer_load_dwordx4 v14, s[12:15], s52 offen offset:1024 nt lds
buffer_load_dwordx4 v14, s[12:15], s52 offen offset:2048 nt lds
buffer_load_dwordx4 v14, s[12:15], s52 offen offset:3072 nt lds
s_mov_b32 m0, 69632
s_mov_b32 s52, 4096
buffer_load_dwordx4 v14, s[12:15], s52 offen offset:0 nt lds
buffer_load_dwordx4 v14, s[12:15], s52 offen offset:1024 nt lds
buffer_load_dwordx4 v14, s[12:15], s52 offen offset:2048 nt lds
buffer_load_dwordx4 v14, s[12:15], s52 offen offset:3072 nt lds
s_mov_b32 m0, 73728
s_mov_b32 s52, 8192
buffer_load_dwordx4 v14, s[12:15], s52 offen offset:0 nt lds
buffer_load_dwordx4 v14, s[12:15], s52 offen offset:1024 nt lds
buffer_load_dwordx4 v14, s[12:15], s52 offen offset:2048 nt lds
buffer_load_dwordx4 v14, s[12:15], s52 offen offset:3072 nt lds
s_mov_b32 m0, 77824
s_mov_b32 s52, 12288
buffer_load_dwordx4 v14, s[12:15], s52 offen offset:0 nt lds
buffer_load_dwordx4 v14, s[12:15], s52 offen offset:1024 nt lds
buffer_load_dwordx4 v14, s[12:15], s52 offen offset:2048 nt lds
buffer_load_dwordx4 v14, s[12:15], s52 offen offset:3072 nt lds
s_waitcnt vmcnt(63)
s_barrier
s_mov_b32 m0, 81920
s_mov_b32 s52, 1572864
buffer_load_dwordx4 v15, s[16:19], s52 offen lds
s_mov_b32 m0, 82944
s_mov_b32 s52, 1605632
buffer_load_dwordx4 v15, s[16:19], s52 offen lds
s_mov_b32 m0, 83968
s_mov_b32 s52, 1638400
buffer_load_dwordx4 v15, s[16:19], s52 offen lds
s_mov_b32 m0, 84992
s_mov_b32 s52, 1671168
buffer_load_dwordx4 v15, s[16:19], s52 offen lds
s_mov_b32 m0, 86016
s_mov_b32 s52, 1703936
buffer_load_dwordx4 v15, s[16:19], s52 offen lds
s_mov_b32 m0, 87040
s_mov_b32 s52, 1736704
buffer_load_dwordx4 v15, s[16:19], s52 offen lds
s_mov_b32 m0, 88064
s_mov_b32 s52, 1769472
buffer_load_dwordx4 v15, s[16:19], s52 offen lds
s_mov_b32 m0, 89088
s_mov_b32 s52, 1802240
buffer_load_dwordx4 v15, s[16:19], s52 offen lds
s_mov_b32 m0, 90112
s_mov_b32 s52, 1835008
buffer_load_dwordx4 v15, s[16:19], s52 offen lds
s_mov_b32 m0, 91136
s_mov_b32 s52, 1867776
buffer_load_dwordx4 v15, s[16:19], s52 offen lds
s_mov_b32 m0, 92160
s_mov_b32 s52, 1900544
buffer_load_dwordx4 v15, s[16:19], s52 offen lds
s_mov_b32 m0, 93184
s_mov_b32 s52, 1933312
buffer_load_dwordx4 v15, s[16:19], s52 offen lds
s_mov_b32 m0, 94208
s_mov_b32 s52, 1966080
buffer_load_dwordx4 v15, s[16:19], s52 offen lds
s_mov_b32 m0, 95232
s_mov_b32 s52, 1998848
buffer_load_dwordx4 v15, s[16:19], s52 offen lds
s_mov_b32 m0, 96256
s_mov_b32 s52, 2031616
buffer_load_dwordx4 v15, s[16:19], s52 offen lds
s_mov_b32 m0, 97280
s_mov_b32 s52, 2064384
buffer_load_dwordx4 v15, s[16:19], s52 offen lds
s_waitcnt vmcnt(32)
s_barrier
s_mov_b32 m0, 98304
s_mov_b32 s52, 2097152
buffer_load_dwordx4 v15, s[16:19], s52 offen lds
s_mov_b32 m0, 99328
s_mov_b32 s52, 2129920
buffer_load_dwordx4 v15, s[16:19], s52 offen lds
s_mov_b32 m0, 100352
s_mov_b32 s52, 2162688
buffer_load_dwordx4 v15, s[16:19], s52 offen lds
s_mov_b32 m0, 101376
s_mov_b32 s52, 2195456
buffer_load_dwordx4 v15, s[16:19], s52 offen lds
s_mov_b32 m0, 102400
s_mov_b32 s52, 2228224
buffer_load_dwordx4 v15, s[16:19], s52 offen lds
s_mov_b32 m0, 103424
s_mov_b32 s52, 2260992
buffer_load_dwordx4 v15, s[16:19], s52 offen lds
s_mov_b32 m0, 104448
s_mov_b32 s52, 2293760
buffer_load_dwordx4 v15, s[16:19], s52 offen lds
s_mov_b32 m0, 105472
s_mov_b32 s52, 2326528
buffer_load_dwordx4 v15, s[16:19], s52 offen lds
s_mov_b32 m0, 106496
s_mov_b32 s52, 2359296
buffer_load_dwordx4 v15, s[16:19], s52 offen lds
s_mov_b32 m0, 107520
s_mov_b32 s52, 2392064
buffer_load_dwordx4 v15, s[16:19], s52 offen lds
s_mov_b32 m0, 108544
s_mov_b32 s52, 2424832
buffer_load_dwordx4 v15, s[16:19], s52 offen lds
s_mov_b32 m0, 109568
s_mov_b32 s52, 2457600
buffer_load_dwordx4 v15, s[16:19], s52 offen lds
s_mov_b32 m0, 110592
s_mov_b32 s52, 2490368
buffer_load_dwordx4 v15, s[16:19], s52 offen lds
s_mov_b32 m0, 111616
s_mov_b32 s52, 2523136
buffer_load_dwordx4 v15, s[16:19], s52 offen lds
s_mov_b32 m0, 112640
s_mov_b32 s52, 2555904
buffer_load_dwordx4 v15, s[16:19], s52 offen lds
s_mov_b32 m0, 113664
s_mov_b32 s52, 2588672
buffer_load_dwordx4 v15, s[16:19], s52 offen lds
s_waitcnt vmcnt(16)
s_barrier
s_mov_b32 m0, 114688
s_mov_b32 s52, 2621440
buffer_load_dwordx4 v15, s[16:19], s52 offen lds
s_mov_b32 m0, 115712
s_mov_b32 s52, 2654208
buffer_load_dwordx4 v15, s[16:19], s52 offen lds
s_mov_b32 m0, 116736
s_mov_b32 s52, 2686976
buffer_load_dwordx4 v15, s[16:19], s52 offen lds
s_mov_b32 m0, 117760
s_mov_b32 s52, 2719744
buffer_load_dwordx4 v15, s[16:19], s52 offen lds
s_mov_b32 m0, 118784
s_mov_b32 s52, 2752512
buffer_load_dwordx4 v15, s[16:19], s52 offen lds
s_mov_b32 m0, 119808
s_mov_b32 s52, 2785280
buffer_load_dwordx4 v15, s[16:19], s52 offen lds
s_mov_b32 m0, 120832
s_mov_b32 s52, 2818048
buffer_load_dwordx4 v15, s[16:19], s52 offen lds
s_mov_b32 m0, 121856
s_mov_b32 s52, 2850816
buffer_load_dwordx4 v15, s[16:19], s52 offen lds
s_mov_b32 m0, 122880
s_mov_b32 s52, 2883584
buffer_load_dwordx4 v15, s[16:19], s52 offen lds
s_mov_b32 m0, 123904
s_mov_b32 s52, 2916352
buffer_load_dwordx4 v15, s[16:19], s52 offen lds
s_mov_b32 m0, 124928
s_mov_b32 s52, 2949120
buffer_load_dwordx4 v15, s[16:19], s52 offen lds
s_mov_b32 m0, 125952
s_mov_b32 s52, 2981888
buffer_load_dwordx4 v15, s[16:19], s52 offen lds
s_mov_b32 m0, 126976
s_mov_b32 s52, 3014656
buffer_load_dwordx4 v15, s[16:19], s52 offen lds
s_mov_b32 m0, 128000
s_mov_b32 s52, 3047424
buffer_load_dwordx4 v15, s[16:19], s52 offen lds
s_mov_b32 m0, 129024
s_mov_b32 s52, 3080192
buffer_load_dwordx4 v15, s[16:19], s52 offen lds
s_mov_b32 m0, 130048
s_mov_b32 s52, 3112960
buffer_load_dwordx4 v15, s[16:19], s52 offen lds
s_waitcnt vmcnt(16)
s_barrier
s_mov_b32 m0, 81920
s_mov_b32 s52, 3145728
buffer_load_dwordx4 v15, s[16:19], s52 offen lds
s_mov_b32 m0, 82944
s_mov_b32 s52, 3178496
buffer_load_dwordx4 v15, s[16:19], s52 offen lds
s_mov_b32 m0, 83968
s_mov_b32 s52, 3211264
buffer_load_dwordx4 v15, s[16:19], s52 offen lds
s_mov_b32 m0, 84992
s_mov_b32 s52, 3244032
buffer_load_dwordx4 v15, s[16:19], s52 offen lds
s_mov_b32 m0, 86016
s_mov_b32 s52, 3276800
buffer_load_dwordx4 v15, s[16:19], s52 offen lds
s_mov_b32 m0, 87040
s_mov_b32 s52, 3309568
buffer_load_dwordx4 v15, s[16:19], s52 offen lds
s_mov_b32 m0, 88064
s_mov_b32 s52, 3342336
buffer_load_dwordx4 v15, s[16:19], s52 offen lds
s_mov_b32 m0, 89088
s_mov_b32 s52, 3375104
buffer_load_dwordx4 v15, s[16:19], s52 offen lds
s_mov_b32 m0, 90112
s_mov_b32 s52, 3407872
buffer_load_dwordx4 v15, s[16:19], s52 offen lds
s_mov_b32 m0, 91136
s_mov_b32 s52, 3440640
buffer_load_dwordx4 v15, s[16:19], s52 offen lds
s_mov_b32 m0, 92160
s_mov_b32 s52, 3473408
buffer_load_dwordx4 v15, s[16:19], s52 offen lds
s_mov_b32 m0, 93184
s_mov_b32 s52, 3506176
buffer_load_dwordx4 v15, s[16:19], s52 offen lds
s_mov_b32 m0, 94208
s_mov_b32 s52, 3538944
buffer_load_dwordx4 v15, s[16:19], s52 offen lds
s_mov_b32 m0, 95232
s_mov_b32 s52, 3571712
buffer_load_dwordx4 v15, s[16:19], s52 offen lds
s_mov_b32 m0, 96256
s_mov_b32 s52, 3604480
buffer_load_dwordx4 v15, s[16:19], s52 offen lds
s_mov_b32 m0, 97280
s_mov_b32 s52, 3637248
buffer_load_dwordx4 v15, s[16:19], s52 offen lds
s_waitcnt vmcnt(16)
s_barrier
s_mov_b32 m0, 98304
s_mov_b32 s52, 3670016
buffer_load_dwordx4 v15, s[16:19], s52 offen lds
s_mov_b32 m0, 99328
s_mov_b32 s52, 3702784
buffer_load_dwordx4 v15, s[16:19], s52 offen lds
s_mov_b32 m0, 100352
s_mov_b32 s52, 3735552
buffer_load_dwordx4 v15, s[16:19], s52 offen lds
s_mov_b32 m0, 101376
s_mov_b32 s52, 3768320
buffer_load_dwordx4 v15, s[16:19], s52 offen lds
s_mov_b32 m0, 102400
s_mov_b32 s52, 3801088
buffer_load_dwordx4 v15, s[16:19], s52 offen lds
s_mov_b32 m0, 103424
s_mov_b32 s52, 3833856
buffer_load_dwordx4 v15, s[16:19], s52 offen lds
s_mov_b32 m0, 104448
s_mov_b32 s52, 3866624
buffer_load_dwordx4 v15, s[16:19], s52 offen lds
s_mov_b32 m0, 105472
s_mov_b32 s52, 3899392
buffer_load_dwordx4 v15, s[16:19], s52 offen lds
s_mov_b32 m0, 106496
s_mov_b32 s52, 3932160
buffer_load_dwordx4 v15, s[16:19], s52 offen lds
s_mov_b32 m0, 107520
s_mov_b32 s52, 3964928
buffer_load_dwordx4 v15, s[16:19], s52 offen lds
s_mov_b32 m0, 108544
s_mov_b32 s52, 3997696
buffer_load_dwordx4 v15, s[16:19], s52 offen lds
s_mov_b32 m0, 109568
s_mov_b32 s52, 4030464
buffer_load_dwordx4 v15, s[16:19], s52 offen lds
s_mov_b32 m0, 110592
s_mov_b32 s52, 4063232
buffer_load_dwordx4 v15, s[16:19], s52 offen lds
s_mov_b32 m0, 111616
s_mov_b32 s52, 4096000
buffer_load_dwordx4 v15, s[16:19], s52 offen lds
s_mov_b32 m0, 112640
s_mov_b32 s52, 4128768
buffer_load_dwordx4 v15, s[16:19], s52 offen lds
s_mov_b32 m0, 113664
s_mov_b32 s52, 4161536
buffer_load_dwordx4 v15, s[16:19], s52 offen lds
s_waitcnt vmcnt(16)
s_barrier
s_waitcnt vmcnt(0)
s_barrier
s_mov_b32 m0, 32768
s_mov_b32 s52, 32768
buffer_load_dwordx4 v10, s[8:11], s52 offen offset:0 nt lds
buffer_load_dwordx4 v11, s[8:11], s52 offen offset:1024 nt lds
buffer_load_dwordx4 v12, s[8:11], s52 offen offset:2048 nt lds
buffer_load_dwordx4 v13, s[8:11], s52 offen offset:3072 nt lds
s_mov_b32 m0, 36864
s_mov_b32 s52, 36864
buffer_load_dwordx4 v10, s[8:11], s52 offen offset:0 nt lds
buffer_load_dwordx4 v11, s[8:11], s52 offen offset:1024 nt lds
buffer_load_dwordx4 v12, s[8:11], s52 offen offset:2048 nt lds
buffer_load_dwordx4 v13, s[8:11], s52 offen offset:3072 nt lds
s_mov_b32 m0, 40960
s_mov_b32 s52, 40960
buffer_load_dwordx4 v10, s[8:11], s52 offen offset:0 nt lds
buffer_load_dwordx4 v11, s[8:11], s52 offen offset:1024 nt lds
buffer_load_dwordx4 v12, s[8:11], s52 offen offset:2048 nt lds
buffer_load_dwordx4 v13, s[8:11], s52 offen offset:3072 nt lds
s_mov_b32 m0, 45056
s_mov_b32 s52, 45056
buffer_load_dwordx4 v10, s[8:11], s52 offen offset:0 nt lds
buffer_load_dwordx4 v11, s[8:11], s52 offen offset:1024 nt lds
buffer_load_dwordx4 v12, s[8:11], s52 offen offset:2048 nt lds
buffer_load_dwordx4 v13, s[8:11], s52 offen offset:3072 nt lds
s_mov_b32 m0, 81920
s_mov_b32 s52, 16384
buffer_load_dwordx4 v14, s[12:15], s52 offen offset:0 nt lds
buffer_load_dwordx4 v14, s[12:15], s52 offen offset:1024 nt lds
buffer_load_dwordx4 v14, s[12:15], s52 offen offset:2048 nt lds
buffer_load_dwordx4 v14, s[12:15], s52 offen offset:3072 nt lds
s_mov_b32 m0, 86016
s_mov_b32 s52, 20480
buffer_load_dwordx4 v14, s[12:15], s52 offen offset:0 nt lds
buffer_load_dwordx4 v14, s[12:15], s52 offen offset:1024 nt lds
buffer_load_dwordx4 v14, s[12:15], s52 offen offset:2048 nt lds
buffer_load_dwordx4 v14, s[12:15], s52 offen offset:3072 nt lds
s_mov_b32 m0, 90112
s_mov_b32 s52, 24576
buffer_load_dwordx4 v14, s[12:15], s52 offen offset:0 nt lds
buffer_load_dwordx4 v14, s[12:15], s52 offen offset:1024 nt lds
buffer_load_dwordx4 v14, s[12:15], s52 offen offset:2048 nt lds
buffer_load_dwordx4 v14, s[12:15], s52 offen offset:3072 nt lds
s_mov_b32 m0, 94208
s_mov_b32 s52, 28672
buffer_load_dwordx4 v14, s[12:15], s52 offen offset:0 nt lds
buffer_load_dwordx4 v14, s[12:15], s52 offen offset:1024 nt lds
buffer_load_dwordx4 v14, s[12:15], s52 offen offset:2048 nt lds
buffer_load_dwordx4 v14, s[12:15], s52 offen offset:3072 nt lds
s_waitcnt vmcnt(32)
s_barrier
s_mov_b32 s56, 0
LD_LOOP:
s_add_u32 s51, s56, 3
s_and_b32 s50, s51, 3
s_lshl_b32 s50, s50, 14
s_lshl_b32 s51, s51, 14
s_add_u32 s54, s56, 2
s_and_b32 s53, s54, 3
s_lshl_b32 s53, s53, 14
s_lshl_b32 s54, s54, 14
s_add_u32 m0, s50, 0
s_add_u32 s52, s51, 0
buffer_load_dwordx4 v10, s[8:11], s52 offen offset:0 nt lds
buffer_load_dwordx4 v11, s[8:11], s52 offen offset:1024 nt lds
buffer_load_dwordx4 v12, s[8:11], s52 offen offset:2048 nt lds
buffer_load_dwordx4 v13, s[8:11], s52 offen offset:3072 nt lds
s_add_u32 m0, s50, 4096
s_add_u32 s52, s51, 4096
buffer_load_dwordx4 v10, s[8:11], s52 offen offset:0 nt lds
buffer_load_dwordx4 v11, s[8:11], s52 offen offset:1024 nt lds
buffer_load_dwordx4 v12, s[8:11], s52 offen offset:2048 nt lds
buffer_load_dwordx4 v13, s[8:11], s52 offen offset:3072 nt lds
s_add_u32 m0, s50, 8192
s_add_u32 s52, s51, 8192
buffer_load_dwordx4 v10, s[8:11], s52 offen offset:0 nt lds
buffer_load_dwordx4 v11, s[8:11], s52 offen offset:1024 nt lds
buffer_load_dwordx4 v12, s[8:11], s52 offen offset:2048 nt lds
buffer_load_dwordx4 v13, s[8:11], s52 offen offset:3072 nt lds
s_add_u32 m0, s50, 12288
s_add_u32 s52, s51, 12288
buffer_load_dwordx4 v10, s[8:11], s52 offen offset:0 nt lds
buffer_load_dwordx4 v11, s[8:11], s52 offen offset:1024 nt lds
buffer_load_dwordx4 v12, s[8:11], s52 offen offset:2048 nt lds
buffer_load_dwordx4 v13, s[8:11], s52 offen offset:3072 nt lds
s_add_u32 m0, s53, 65536
s_add_u32 s52, s54, 0
buffer_load_dwordx4 v14, s[12:15], s52 offen offset:0 nt lds
buffer_load_dwordx4 v14, s[12:15], s52 offen offset:1024 nt lds
buffer_load_dwordx4 v14, s[12:15], s52 offen offset:2048 nt lds
buffer_load_dwordx4 v14, s[12:15], s52 offen offset:3072 nt lds
s_add_u32 m0, s53, 69632
s_add_u32 s52, s54, 4096
buffer_load_dwordx4 v14, s[12:15], s52 offen offset:0 nt lds
buffer_load_dwordx4 v14, s[12:15], s52 offen offset:1024 nt lds
buffer_load_dwordx4 v14, s[12:15], s52 offen offset:2048 nt lds
buffer_load_dwordx4 v14, s[12:15], s52 offen offset:3072 nt lds
s_add_u32 m0, s53, 73728
s_add_u32 s52, s54, 8192
buffer_load_dwordx4 v14, s[12:15], s52 offen offset:0 nt lds
buffer_load_dwordx4 v14, s[12:15], s52 offen offset:1024 nt lds
buffer_load_dwordx4 v14, s[12:15], s52 offen offset:2048 nt lds
buffer_load_dwordx4 v14, s[12:15], s52 offen offset:3072 nt lds
s_add_u32 m0, s53, 77824
s_add_u32 s52, s54, 12288
buffer_load_dwordx4 v14, s[12:15], s52 offen offset:0 nt lds
buffer_load_dwordx4 v14, s[12:15], s52 offen offset:1024 nt lds
buffer_load_dwordx4 v14, s[12:15], s52 offen offset:2048 nt lds
buffer_load_dwordx4 v14, s[12:15], s52 offen offset:3072 nt lds
s_waitcnt vmcnt(32)
s_barrier
s_add_u32 s56, s56, 1
s_cmp_lt_u32 s56, 13
s_cbranch_scc1 LD_LOOP
s_mov_b32 m0, 114688
s_mov_b32 s52, 245760
buffer_load_dwordx4 v14, s[12:15], s52 offen offset:0 nt lds
buffer_load_dwordx4 v14, s[12:15], s52 offen offset:1024 nt lds
buffer_load_dwordx4 v14, s[12:15], s52 offen offset:2048 nt lds
buffer_load_dwordx4 v14, s[12:15], s52 offen offset:3072 nt lds
s_mov_b32 m0, 118784
s_mov_b32 s52, 249856
buffer_load_dwordx4 v14, s[12:15], s52 offen offset:0 nt lds
buffer_load_dwordx4 v14, s[12:15], s52 offen offset:1024 nt lds
buffer_load_dwordx4 v14, s[12:15], s52 offen offset:2048 nt lds
buffer_load_dwordx4 v14, s[12:15], s52 offen offset:3072 nt lds
s_mov_b32 m0, 122880
s_mov_b32 s52, 253952
buffer_load_dwordx4 v14, s[12:15], s52 offen offset:0 nt lds
buffer_load_dwordx4 v14, s[12:15], s52 offen offset:1024 nt lds
buffer_load_dwordx4 v14, s[12:15], s52 offen offset:2048 nt lds
buffer_load_dwordx4 v14, s[12:15], s52 offen offset:3072 nt lds
s_mov_b32 m0, 126976
s_mov_b32 s52, 258048
buffer_load_dwordx4 v14, s[12:15], s52 offen offset:0 nt lds
buffer_load_dwordx4 v14, s[12:15], s52 offen offset:1024 nt lds
buffer_load_dwordx4 v14, s[12:15], s52 offen offset:2048 nt lds
buffer_load_dwordx4 v14, s[12:15], s52 offen offset:3072 nt lds
s_waitcnt vmcnt(16)
s_barrier
s_waitcnt vmcnt(0)
s_barrier
s_cmp_lg_u32 s4, 0
s_cbranch_scc1 LD_END
s_mov_b32 s4, 1
s_mov_b32 s32, s40
s_mov_b32 s33, s41
s_mov_b32 s34, s42
s_mov_b32 s35, s43
s_mov_b32 s36, s44
s_mov_b32 s37, s45
s_mov_b32 s38, s46
s_mov_b32 s39, s47
s_lshl_b32 s28, s6, 5
s_add_u32 s28, s28, s7
s_lshl_b32 s28, s28, 18
s_add_u32 s8, s34, s28
s_addc_u32 s9, s35, 0
s_mov_b32 s10, 262144
s_mov_b32 s11, 0x20000
s_add_u32 s12, s36, s28
s_addc_u32 s13, s37, 0
s_mov_b32 s14, 262144
s_mov_b32 s15, 0x20000
s_lshl_b32 s28, s7, 8
s_sub_u32 s29, 0x400000, s28
s_add_u32 s16, s38, s28
s_addc_u32 s17, s39, 0
s_mov_b32 s18, s29
s_mov_b32 s19, 0x20000
s_mov_b32 m0, 81920
s_mov_b32 s52, 0
buffer_load_dwordx4 v15, s[16:19], s52 offen lds
s_mov_b32 m0, 82944
s_mov_b32 s52, 32768
buffer_load_dwordx4 v15, s[16:19], s52 offen lds
s_mov_b32 m0, 83968
s_mov_b32 s52, 65536
buffer_load_dwordx4 v15, s[16:19], s52 offen lds
s_mov_b32 m0, 84992
s_mov_b32 s52, 98304
buffer_load_dwordx4 v15, s[16:19], s52 offen lds
s_mov_b32 m0, 86016
s_mov_b32 s52, 131072
buffer_load_dwordx4 v15, s[16:19], s52 offen lds
s_mov_b32 m0, 87040
s_mov_b32 s52, 163840
buffer_load_dwordx4 v15, s[16:19], s52 offen lds
s_mov_b32 m0, 88064
s_mov_b32 s52, 196608
buffer_load_dwordx4 v15, s[16:19], s52 offen lds
s_mov_b32 m0, 89088
s_mov_b32 s52, 229376
buffer_load_dwordx4 v15, s[16:19], s52 offen lds
s_mov_b32 m0, 90112
s_mov_b32 s52, 262144
buffer_load_dwordx4 v15, s[16:19], s52 offen lds
s_mov_b32 m0, 91136
s_mov_b32 s52, 294912
buffer_load_dwordx4 v15, s[16:19], s52 offen lds
s_mov_b32 m0, 92160
s_mov_b32 s52, 327680
buffer_load_dwordx4 v15, s[16:19], s52 offen lds
s_mov_b32 m0, 93184
s_mov_b32 s52, 360448
buffer_load_dwordx4 v15, s[16:19], s52 offen lds
s_mov_b32 m0, 94208
s_mov_b32 s52, 393216
buffer_load_dwordx4 v15, s[16:19], s52 offen lds
s_mov_b32 m0, 95232
s_mov_b32 s52, 425984
buffer_load_dwordx4 v15, s[16:19], s52 offen lds
s_mov_b32 m0, 96256
s_mov_b32 s52, 458752
buffer_load_dwordx4 v15, s[16:19], s52 offen lds
s_mov_b32 m0, 97280
s_mov_b32 s52, 491520
buffer_load_dwordx4 v15, s[16:19], s52 offen lds
s_mov_b32 m0, 98304
s_mov_b32 s52, 524288
buffer_load_dwordx4 v15, s[16:19], s52 offen lds
s_mov_b32 m0, 99328
s_mov_b32 s52, 557056
buffer_load_dwordx4 v15, s[16:19], s52 offen lds
s_mov_b32 m0, 100352
s_mov_b32 s52, 589824
buffer_load_dwordx4 v15, s[16:19], s52 offen lds
s_mov_b32 m0, 101376
s_mov_b32 s52, 622592
buffer_load_dwordx4 v15, s[16:19], s52 offen lds
s_mov_b32 m0, 102400
s_mov_b32 s52, 655360
buffer_load_dwordx4 v15, s[16:19], s52 offen lds
s_mov_b32 m0, 103424
s_mov_b32 s52, 688128
buffer_load_dwordx4 v15, s[16:19], s52 offen lds
s_mov_b32 m0, 104448
s_mov_b32 s52, 720896
buffer_load_dwordx4 v15, s[16:19], s52 offen lds
s_mov_b32 m0, 105472
s_mov_b32 s52, 753664
buffer_load_dwordx4 v15, s[16:19], s52 offen lds
s_mov_b32 m0, 106496
s_mov_b32 s52, 786432
buffer_load_dwordx4 v15, s[16:19], s52 offen lds
s_mov_b32 m0, 107520
s_mov_b32 s52, 819200
buffer_load_dwordx4 v15, s[16:19], s52 offen lds
s_mov_b32 m0, 108544
s_mov_b32 s52, 851968
buffer_load_dwordx4 v15, s[16:19], s52 offen lds
s_mov_b32 m0, 109568
s_mov_b32 s52, 884736
buffer_load_dwordx4 v15, s[16:19], s52 offen lds
s_mov_b32 m0, 110592
s_mov_b32 s52, 917504
buffer_load_dwordx4 v15, s[16:19], s52 offen lds
s_mov_b32 m0, 111616
s_mov_b32 s52, 950272
buffer_load_dwordx4 v15, s[16:19], s52 offen lds
s_mov_b32 m0, 112640
s_mov_b32 s52, 983040
buffer_load_dwordx4 v15, s[16:19], s52 offen lds
s_mov_b32 m0, 113664
s_mov_b32 s52, 1015808
buffer_load_dwordx4 v15, s[16:19], s52 offen lds
s_mov_b32 m0, 0
s_mov_b32 s52, 0
buffer_load_dwordx4 v10, s[8:11], s52 offen offset:0 nt lds
buffer_load_dwordx4 v11, s[8:11], s52 offen offset:1024 nt lds
buffer_load_dwordx4 v12, s[8:11], s52 offen offset:2048 nt lds
buffer_load_dwordx4 v13, s[8:11], s52 offen offset:3072 nt lds
s_mov_b32 m0, 4096
s_mov_b32 s52, 4096
buffer_load_dwordx4 v10, s[8:11], s52 offen offset:0 nt lds
buffer_load_dwordx4 v11, s[8:11], s52 offen offset:1024 nt lds
buffer_load_dwordx4 v12, s[8:11], s52 offen offset:2048 nt lds
buffer_load_dwordx4 v13, s[8:11], s52 offen offset:3072 nt lds
s_mov_b32 m0, 8192
s_mov_b32 s52, 8192
buffer_load_dwordx4 v10, s[8:11], s52 offen offset:0 nt lds
buffer_load_dwordx4 v11, s[8:11], s52 offen offset:1024 nt lds
buffer_load_dwordx4 v12, s[8:11], s52 offen offset:2048 nt lds
buffer_load_dwordx4 v13, s[8:11], s52 offen offset:3072 nt lds
s_mov_b32 m0, 12288
s_mov_b32 s52, 12288
buffer_load_dwordx4 v10, s[8:11], s52 offen offset:0 nt lds
buffer_load_dwordx4 v11, s[8:11], s52 offen offset:1024 nt lds
buffer_load_dwordx4 v12, s[8:11], s52 offen offset:2048 nt lds
buffer_load_dwordx4 v13, s[8:11], s52 offen offset:3072 nt lds
s_mov_b32 m0, 16384
s_mov_b32 s52, 16384
buffer_load_dwordx4 v10, s[8:11], s52 offen offset:0 nt lds
buffer_load_dwordx4 v11, s[8:11], s52 offen offset:1024 nt lds
buffer_load_dwordx4 v12, s[8:11], s52 offen offset:2048 nt lds
buffer_load_dwordx4 v13, s[8:11], s52 offen offset:3072 nt lds
s_mov_b32 m0, 20480
s_mov_b32 s52, 20480
buffer_load_dwordx4 v10, s[8:11], s52 offen offset:0 nt lds
buffer_load_dwordx4 v11, s[8:11], s52 offen offset:1024 nt lds
buffer_load_dwordx4 v12, s[8:11], s52 offen offset:2048 nt lds
buffer_load_dwordx4 v13, s[8:11], s52 offen offset:3072 nt lds
s_mov_b32 m0, 24576
s_mov_b32 s52, 24576
buffer_load_dwordx4 v10, s[8:11], s52 offen offset:0 nt lds
buffer_load_dwordx4 v11, s[8:11], s52 offen offset:1024 nt lds
buffer_load_dwordx4 v12, s[8:11], s52 offen offset:2048 nt lds
buffer_load_dwordx4 v13, s[8:11], s52 offen offset:3072 nt lds
s_mov_b32 m0, 28672
s_mov_b32 s52, 28672
buffer_load_dwordx4 v10, s[8:11], s52 offen offset:0 nt lds
buffer_load_dwordx4 v11, s[8:11], s52 offen offset:1024 nt lds
buffer_load_dwordx4 v12, s[8:11], s52 offen offset:2048 nt lds
buffer_load_dwordx4 v13, s[8:11], s52 offen offset:3072 nt lds
s_branch LD_ROUND
LD_END:
s_endpgm
.globl oproj_kernel
.p2align 8
.type oproj_kernel,@function
oproj_kernel:
s_cmp_ge_u32 s2, 224
s_cbranch_scc1 K2_EXIT
s_load_dwordx2 s[32:33], s[0:1], 32
s_load_dwordx2 s[34:35], s[0:1], 72
s_load_dwordx2 s[36:37], s[0:1], 80
s_load_dwordx2 s[48:49], s[0:1], 96
v_and_b32 v165, 63, v0
v_lshrrev_b32 v1, 6, v0
s_nop 0
v_readfirstlane_b32 s5, v1
s_and_b32 s28, s2, 7
s_lshr_b32 s29, s2, 3
s_mul_i32 s28, s28, 28
s_add_u32 s28, s28, s29
s_and_b32 s7, s28, 7
s_lshr_b32 s28, s28, 3
s_cmp_ge_u32 s28, 14
s_cselect_b32 s4, 1, 0
s_mul_i32 s29, s4, 14
s_sub_u32 s6, s28, s29
s_lshl_b32 s6, s6, 2
s_add_u32 s6, s6, s5
s_mul_i32 s28, s6, 37
s_lshr_b32 s28, s28, 8
s_mul_i32 s29, s28, 7
s_sub_u32 s29, s6, s29
s_lshl_b32 s30, s4, 3
s_add_u32 s30, s30, s28
s_mul_i32 s30, s30, 1835008
s_lshl_b32 s29, s29, 13
s_add_u32 s30, s30, s29
s_waitcnt lgkmcnt(0)
s_add_u32 s8, s48, s30
s_addc_u32 s9, s49, 0
s_mov_b32 s10, 1835008
s_mov_b32 s11, 0x20000
s_cmp_eq_u32 s4, 0
s_cselect_b32 s32, s32, s34
s_cselect_b32 s33, s33, s35
s_lshl_b32 s28, s7, 7
s_sub_u32 s29, 0x400000, s28
s_add_u32 s12, s32, s28
s_addc_u32 s13, s33, 0
s_mov_b32 s14, s29
s_mov_b32 s15, 0x20000
s_lshl_b32 s28, s6, 16
s_lshl_b32 s29, s4, 10
s_add_u32 s28, s28, s29
s_lshl_b32 s29, s7, 7
s_add_u32 s28, s28, s29
s_add_u32 s16, s36, s28
s_addc_u32 s17, s37, 0
s_mov_b32 s18, 65536
s_mov_b32 s19, 0x20000
s_lshl_b32 s29, s4, 10
s_lshl_b32 s31, s7, 7
s_add_u32 s29, s29, s31
s_sub_u32 s18, 65536, s29
v_lshlrev_b32 v167, 4, v165
v_lshrrev_b32 v1, 3, v165
v_bfe_u32 v2, v165, 4, 1
v_lshlrev_b32 v2, 2, v2
v_and_b32 v3, 7, v165
v_xor_b32 v2, v2, v3
v_lshlrev_b32 v2, 4, v2
v_lshl_add_u32 v166, v1, 10, v2
v_bfe_u32 v3, v165, 2, 2
v_and_b32 v4, 3, v165
v_bfe_u32 v5, v165, 4, 1
v_lshrrev_b32 v2, 5, v165
v_lshl_add_u32 v6, v2, 2, v3
v_lshlrev_b32 v6, 7, v6
v_and_b32 v7, 1, v4
v_lshl_add_u32 v6, v7, 5, v6
v_lshl_add_u32 v6, v5, 4, v6
v_lshrrev_b32 v7, 1, v4
v_lshl_add_u32 v6, v7, 3, v6
v_lshrrev_b32 v3, 1, v3
v_xor_b32 v7, 0, v3
v_lshl_add_u32 v160, v7, 6, v6
v_add_u32 v162, 65536, v160
v_xor_b32 v7, 1, v3
v_lshl_add_u32 v161, v7, 6, v6
v_add_u32 v163, 65536, v161
v_and_b32 v1, 31, v165
v_lshrrev_b32 v2, 5, v165
v_lshlrev_b32 v1, 11, v1
v_lshl_add_u32 v164, v2, 5, v1
s_lshl_b32 s30, s5, 12
s_lshl_b32 s31, s5, 15
s_mov_b32 s58, 4096
s_mov_b32 s50, 0
s_mov_b32 s51, s31
s_add_u32 m0, s30, 0
s_add_u32 s52, s51, 0
buffer_load_dwordx4 v166, s[12:15], s52 offen lds
s_add_u32 m0, s30, 1024
s_add_u32 s52, s51, 8192
buffer_load_dwordx4 v166, s[12:15], s52 offen lds
s_add_u32 m0, s30, 2048
s_add_u32 s52, s51, 16384
buffer_load_dwordx4 v166, s[12:15], s52 offen lds
s_add_u32 m0, s30, 3072
s_add_u32 s52, s51, 24576
buffer_load_dwordx4 v166, s[12:15], s52 offen lds
s_add_u32 s53, s50, 4096
buffer_load_dwordx4 v[64:67], v167, s[8:11], s50 offen offset:0
buffer_load_dwordx4 v[68:71], v167, s[8:11], s50 offen offset:1024
buffer_load_dwordx4 v[72:75], v167, s[8:11], s50 offen offset:2048
buffer_load_dwordx4 v[76:79], v167, s[8:11], s50 offen offset:3072
buffer_load_dwordx4 v[80:83], v167, s[8:11], s53 offen offset:0
buffer_load_dwordx4 v[84:87], v167, s[8:11], s53 offen offset:1024
buffer_load_dwordx4 v[88:91], v167, s[8:11], s53 offen offset:2048
buffer_load_dwordx4 v[92:95], v167, s[8:11], s53 offen offset:3072
s_add_u32 s50, s50, 57344
s_add_u32 s51, s51, 131072
s_add_u32 m0, s30, 16384
s_add_u32 s52, s51, 0
buffer_load_dwordx4 v166, s[12:15], s52 offen lds
s_add_u32 m0, s30, 17408
s_add_u32 s52, s51, 8192
buffer_load_dwordx4 v166, s[12:15], s52 offen lds
s_add_u32 m0, s30, 18432
s_add_u32 s52, s51, 16384
buffer_load_dwordx4 v166, s[12:15], s52 offen lds
s_add_u32 m0, s30, 19456
s_add_u32 s52, s51, 24576
buffer_load_dwordx4 v166, s[12:15], s52 offen lds
s_add_u32 s53, s50, 4096
buffer_load_dwordx4 v[96:99], v167, s[8:11], s50 offen offset:0
buffer_load_dwordx4 v[100:103], v167, s[8:11], s50 offen offset:1024
buffer_load_dwordx4 v[104:107], v167, s[8:11], s50 offen offset:2048
buffer_load_dwordx4 v[108:111], v167, s[8:11], s50 offen offset:3072
buffer_load_dwordx4 v[112:115], v167, s[8:11], s53 offen offset:0
buffer_load_dwordx4 v[116:119], v167, s[8:11], s53 offen offset:1024
buffer_load_dwordx4 v[120:123], v167, s[8:11], s53 offen offset:2048
buffer_load_dwordx4 v[124:127], v167, s[8:11], s53 offen offset:3072
s_add_u32 s50, s50, 57344
s_add_u32 s51, s51, 131072
v_mov_b32 v0, 0
v_mov_b32 v1, 0
v_mov_b32 v2, 0
v_mov_b32 v3, 0
v_mov_b32 v4, 0
v_mov_b32 v5, 0
v_mov_b32 v6, 0
v_mov_b32 v7, 0
v_mov_b32 v8, 0
v_mov_b32 v9, 0
v_mov_b32 v10, 0
v_mov_b32 v11, 0
v_mov_b32 v12, 0
v_mov_b32 v13, 0
v_mov_b32 v14, 0
v_mov_b32 v15, 0
v_mov_b32 v16, 0
v_mov_b32 v17, 0
v_mov_b32 v18, 0
v_mov_b32 v19, 0
v_mov_b32 v20, 0
v_mov_b32 v21, 0
v_mov_b32 v22, 0
v_mov_b32 v23, 0
v_mov_b32 v24, 0
v_mov_b32 v25, 0
v_mov_b32 v26, 0
v_mov_b32 v27, 0
v_mov_b32 v28, 0
v_mov_b32 v29, 0
v_mov_b32 v30, 0
v_mov_b32 v31, 0
s_waitcnt vmcnt(12)
s_barrier
ds_read_b64_tr_b16 v[32:33], v160 offset:0
ds_read_b64_tr_b16 v[34:35], v160 offset:1024
ds_read_b64_tr_b16 v[36:37], v161 offset:0
ds_read_b64_tr_b16 v[38:39], v161 offset:1024
ds_read_b64_tr_b16 v[40:41], v160 offset:2048
ds_read_b64_tr_b16 v[42:43], v160 offset:3072
ds_read_b64_tr_b16 v[44:45], v161 offset:2048
ds_read_b64_tr_b16 v[46:47], v161 offset:3072
ds_read_b64_tr_b16 v[48:49], v160 offset:4096
ds_read_b64_tr_b16 v[50:51], v160 offset:5120
ds_read_b64_tr_b16 v[52:53], v161 offset:4096
ds_read_b64_tr_b16 v[54:55], v161 offset:5120
s_waitcnt lgkmcnt(10)
v_mfma_f32_32x32x16_bf16 v[0:15], v[32:35], v[64:67], v[0:15]
s_add_u32 m0, s30, 32768
s_add_u32 s52, s51, 0
buffer_load_dwordx4 v166, s[12:15], s52 offen lds
ds_read_b64_tr_b16 v[56:57], v160 offset:6144
ds_read_b64_tr_b16 v[58:59], v160 offset:7168
s_waitcnt lgkmcnt(10)
v_mfma_f32_32x32x16_bf16 v[16:31], v[36:39], v[64:67], v[16:31]
s_add_u32 m0, s30, 33792
s_add_u32 s52, s51, 8192
buffer_load_dwordx4 v166, s[12:15], s52 offen lds
ds_read_b64_tr_b16 v[60:61], v161 offset:6144
ds_read_b64_tr_b16 v[62:63], v161 offset:7168
s_waitcnt lgkmcnt(10)
v_mfma_f32_32x32x16_bf16 v[0:15], v[40:43], v[68:71], v[0:15]
s_add_u32 m0, s30, 34816
s_add_u32 s52, s51, 16384
buffer_load_dwordx4 v166, s[12:15], s52 offen lds
ds_read_b64_tr_b16 v[32:33], v160 offset:8192
ds_read_b64_tr_b16 v[34:35], v160 offset:9216
s_waitcnt lgkmcnt(10)
v_mfma_f32_32x32x16_bf16 v[16:31], v[44:47], v[68:71], v[16:31]
s_add_u32 m0, s30, 35840
s_add_u32 s52, s51, 24576
buffer_load_dwordx4 v166, s[12:15], s52 offen lds
ds_read_b64_tr_b16 v[36:37], v161 offset:8192
ds_read_b64_tr_b16 v[38:39], v161 offset:9216
s_waitcnt lgkmcnt(10)
v_mfma_f32_32x32x16_bf16 v[0:15], v[48:51], v[72:75], v[0:15]
s_add_u32 s53, s50, 4096
buffer_load_dwordx4 v[128:131], v167, s[8:11], s50 offen offset:0
buffer_load_dwordx4 v[132:135], v167, s[8:11], s50 offen offset:1024
ds_read_b64_tr_b16 v[40:41], v160 offset:10240
ds_read_b64_tr_b16 v[42:43], v160 offset:11264
s_waitcnt lgkmcnt(10)
v_mfma_f32_32x32x16_bf16 v[16:31], v[52:55], v[72:75], v[16:31]
buffer_load_dwordx4 v[136:139], v167, s[8:11], s50 offen offset:2048
buffer_load_dwordx4 v[140:143], v167, s[8:11], s50 offen offset:3072
buffer_load_dwordx4 v[144:147], v167, s[8:11], s53 offen offset:0
ds_read_b64_tr_b16 v[44:45], v161 offset:10240
ds_read_b64_tr_b16 v[46:47], v161 offset:11264
s_waitcnt lgkmcnt(10)
v_mfma_f32_32x32x16_bf16 v[0:15], v[56:59], v[76:79], v[0:15]
buffer_load_dwordx4 v[148:151], v167, s[8:11], s53 offen offset:1024
buffer_load_dwordx4 v[152:155], v167, s[8:11], s53 offen offset:2048
buffer_load_dwordx4 v[156:159], v167, s[8:11], s53 offen offset:3072
ds_read_b64_tr_b16 v[48:49], v160 offset:12288
ds_read_b64_tr_b16 v[50:51], v160 offset:13312
s_waitcnt lgkmcnt(10)
v_mfma_f32_32x32x16_bf16 v[16:31], v[60:63], v[76:79], v[16:31]
s_add_u32 s50, s50, 57344
s_add_u32 s51, s51, 131072
ds_read_b64_tr_b16 v[52:53], v161 offset:12288
ds_read_b64_tr_b16 v[54:55], v161 offset:13312
s_waitcnt lgkmcnt(10)
v_mfma_f32_32x32x16_bf16 v[0:15], v[32:35], v[80:83], v[0:15]
ds_read_b64_tr_b16 v[56:57], v160 offset:14336
ds_read_b64_tr_b16 v[58:59], v160 offset:15360
s_waitcnt lgkmcnt(10)
v_mfma_f32_32x32x16_bf16 v[16:31], v[36:39], v[80:83], v[16:31]
ds_read_b64_tr_b16 v[60:61], v161 offset:14336
ds_read_b64_tr_b16 v[62:63], v161 offset:15360
s_waitcnt lgkmcnt(10)
v_mfma_f32_32x32x16_bf16 v[0:15], v[40:43], v[84:87], v[0:15]
s_waitcnt vmcnt(12)
s_barrier
ds_read_b64_tr_b16 v[32:33], v160 offset:16384
ds_read_b64_tr_b16 v[34:35], v160 offset:17408
s_waitcnt lgkmcnt(10)
v_mfma_f32_32x32x16_bf16 v[16:31], v[44:47], v[84:87], v[16:31]
ds_read_b64_tr_b16 v[36:37], v161 offset:16384
ds_read_b64_tr_b16 v[38:39], v161 offset:17408
s_waitcnt lgkmcnt(10)
v_mfma_f32_32x32x16_bf16 v[0:15], v[48:51], v[88:91], v[0:15]
ds_read_b64_tr_b16 v[40:41], v160 offset:18432
ds_read_b64_tr_b16 v[42:43], v160 offset:19456
s_waitcnt lgkmcnt(10)
v_mfma_f32_32x32x16_bf16 v[16:31], v[52:55], v[88:91], v[16:31]
ds_read_b64_tr_b16 v[44:45], v161 offset:18432
ds_read_b64_tr_b16 v[46:47], v161 offset:19456
s_waitcnt lgkmcnt(10)
v_mfma_f32_32x32x16_bf16 v[0:15], v[56:59], v[92:95], v[0:15]
ds_read_b64_tr_b16 v[48:49], v160 offset:20480
ds_read_b64_tr_b16 v[50:51], v160 offset:21504
s_waitcnt lgkmcnt(10)
v_mfma_f32_32x32x16_bf16 v[16:31], v[60:63], v[92:95], v[16:31]
ds_read_b64_tr_b16 v[52:53], v161 offset:20480
ds_read_b64_tr_b16 v[54:55], v161 offset:21504
s_waitcnt lgkmcnt(10)
v_mfma_f32_32x32x16_bf16 v[0:15], v[32:35], v[96:99], v[0:15]
s_add_u32 m0, s30, 49152
s_add_u32 s52, s51, 0
buffer_load_dwordx4 v166, s[12:15], s52 offen lds
ds_read_b64_tr_b16 v[56:57], v160 offset:22528
ds_read_b64_tr_b16 v[58:59], v160 offset:23552
s_waitcnt lgkmcnt(10)
v_mfma_f32_32x32x16_bf16 v[16:31], v[36:39], v[96:99], v[16:31]
s_add_u32 m0, s30, 50176
s_add_u32 s52, s51, 8192
buffer_load_dwordx4 v166, s[12:15], s52 offen lds
ds_read_b64_tr_b16 v[60:61], v161 offset:22528
ds_read_b64_tr_b16 v[62:63], v161 offset:23552
s_waitcnt lgkmcnt(10)
v_mfma_f32_32x32x16_bf16 v[0:15], v[40:43], v[100:103], v[0:15]
s_add_u32 m0, s30, 51200
s_add_u32 s52, s51, 16384
buffer_load_dwordx4 v166, s[12:15], s52 offen lds
ds_read_b64_tr_b16 v[32:33], v160 offset:24576
ds_read_b64_tr_b16 v[34:35], v160 offset:25600
s_waitcnt lgkmcnt(10)
v_mfma_f32_32x32x16_bf16 v[16:31], v[44:47], v[100:103], v[16:31]
s_add_u32 m0, s30, 52224
s_add_u32 s52, s51, 24576
buffer_load_dwordx4 v166, s[12:15], s52 offen lds
ds_read_b64_tr_b16 v[36:37], v161 offset:24576
ds_read_b64_tr_b16 v[38:39], v161 offset:25600
s_waitcnt lgkmcnt(10)
v_mfma_f32_32x32x16_bf16 v[0:15], v[48:51], v[104:107], v[0:15]
s_add_u32 s53, s50, 4096
buffer_load_dwordx4 v[64:67], v167, s[8:11], s50 offen offset:0
buffer_load_dwordx4 v[68:71], v167, s[8:11], s50 offen offset:1024
ds_read_b64_tr_b16 v[40:41], v160 offset:26624
ds_read_b64_tr_b16 v[42:43], v160 offset:27648
s_waitcnt lgkmcnt(10)
v_mfma_f32_32x32x16_bf16 v[16:31], v[52:55], v[104:107], v[16:31]
buffer_load_dwordx4 v[72:75], v167, s[8:11], s50 offen offset:2048
buffer_load_dwordx4 v[76:79], v167, s[8:11], s50 offen offset:3072
buffer_load_dwordx4 v[80:83], v167, s[8:11], s53 offen offset:0
ds_read_b64_tr_b16 v[44:45], v161 offset:26624
ds_read_b64_tr_b16 v[46:47], v161 offset:27648
s_waitcnt lgkmcnt(10)
v_mfma_f32_32x32x16_bf16 v[0:15], v[56:59], v[108:111], v[0:15]
buffer_load_dwordx4 v[84:87], v167, s[8:11], s53 offen offset:1024
buffer_load_dwordx4 v[88:91], v167, s[8:11], s53 offen offset:2048
buffer_load_dwordx4 v[92:95], v167, s[8:11], s53 offen offset:3072
ds_read_b64_tr_b16 v[48:49], v160 offset:28672
ds_read_b64_tr_b16 v[50:51], v160 offset:29696
s_waitcnt lgkmcnt(10)
v_mfma_f32_32x32x16_bf16 v[16:31], v[60:63], v[108:111], v[16:31]
s_add_u32 s50, s50, 57344
s_add_u32 s51, s51, 131072
ds_read_b64_tr_b16 v[52:53], v161 offset:28672
ds_read_b64_tr_b16 v[54:55], v161 offset:29696
s_waitcnt lgkmcnt(10)
v_mfma_f32_32x32x16_bf16 v[0:15], v[32:35], v[112:115], v[0:15]
ds_read_b64_tr_b16 v[56:57], v160 offset:30720
ds_read_b64_tr_b16 v[58:59], v160 offset:31744
s_waitcnt lgkmcnt(10)
v_mfma_f32_32x32x16_bf16 v[16:31], v[36:39], v[112:115], v[16:31]
ds_read_b64_tr_b16 v[60:61], v161 offset:30720
ds_read_b64_tr_b16 v[62:63], v161 offset:31744
s_waitcnt lgkmcnt(10)
v_mfma_f32_32x32x16_bf16 v[0:15], v[40:43], v[116:119], v[0:15]
s_waitcnt vmcnt(12)
s_barrier
ds_read_b64_tr_b16 v[32:33], v160 offset:32768
ds_read_b64_tr_b16 v[34:35], v160 offset:33792
s_waitcnt lgkmcnt(10)
v_mfma_f32_32x32x16_bf16 v[16:31], v[44:47], v[116:119], v[16:31]
ds_read_b64_tr_b16 v[36:37], v161 offset:32768
ds_read_b64_tr_b16 v[38:39], v161 offset:33792
s_waitcnt lgkmcnt(10)
v_mfma_f32_32x32x16_bf16 v[0:15], v[48:51], v[120:123], v[0:15]
ds_read_b64_tr_b16 v[40:41], v160 offset:34816
ds_read_b64_tr_b16 v[42:43], v160 offset:35840
s_waitcnt lgkmcnt(10)
v_mfma_f32_32x32x16_bf16 v[16:31], v[52:55], v[120:123], v[16:31]
ds_read_b64_tr_b16 v[44:45], v161 offset:34816
ds_read_b64_tr_b16 v[46:47], v161 offset:35840
s_waitcnt lgkmcnt(10)
v_mfma_f32_32x32x16_bf16 v[0:15], v[56:59], v[124:127], v[0:15]
ds_read_b64_tr_b16 v[48:49], v160 offset:36864
ds_read_b64_tr_b16 v[50:51], v160 offset:37888
s_waitcnt lgkmcnt(10)
v_mfma_f32_32x32x16_bf16 v[16:31], v[60:63], v[124:127], v[16:31]
ds_read_b64_tr_b16 v[52:53], v161 offset:36864
ds_read_b64_tr_b16 v[54:55], v161 offset:37888
s_waitcnt lgkmcnt(10)
v_mfma_f32_32x32x16_bf16 v[0:15], v[32:35], v[128:131], v[0:15]
s_add_u32 m0, s30, 65536
s_add_u32 s52, s51, 0
buffer_load_dwordx4 v166, s[12:15], s52 offen lds
ds_read_b64_tr_b16 v[56:57], v160 offset:38912
ds_read_b64_tr_b16 v[58:59], v160 offset:39936
s_waitcnt lgkmcnt(10)
v_mfma_f32_32x32x16_bf16 v[16:31], v[36:39], v[128:131], v[16:31]
s_add_u32 m0, s30, 66560
s_add_u32 s52, s51, 8192
buffer_load_dwordx4 v166, s[12:15], s52 offen lds
ds_read_b64_tr_b16 v[60:61], v161 offset:38912
ds_read_b64_tr_b16 v[62:63], v161 offset:39936
s_waitcnt lgkmcnt(10)
v_mfma_f32_32x32x16_bf16 v[0:15], v[40:43], v[132:135], v[0:15]
s_add_u32 m0, s30, 67584
s_add_u32 s52, s51, 16384
buffer_load_dwordx4 v166, s[12:15], s52 offen lds
ds_read_b64_tr_b16 v[32:33], v160 offset:40960
ds_read_b64_tr_b16 v[34:35], v160 offset:41984
s_waitcnt lgkmcnt(10)
v_mfma_f32_32x32x16_bf16 v[16:31], v[44:47], v[132:135], v[16:31]
s_add_u32 m0, s30, 68608
s_add_u32 s52, s51, 24576
buffer_load_dwordx4 v166, s[12:15], s52 offen lds
ds_read_b64_tr_b16 v[36:37], v161 offset:40960
ds_read_b64_tr_b16 v[38:39], v161 offset:41984
s_waitcnt lgkmcnt(10)
v_mfma_f32_32x32x16_bf16 v[0:15], v[48:51], v[136:139], v[0:15]
s_add_u32 s53, s50, 4096
buffer_load_dwordx4 v[96:99], v167, s[8:11], s50 offen offset:0
buffer_load_dwordx4 v[100:103], v167, s[8:11], s50 offen offset:1024
ds_read_b64_tr_b16 v[40:41], v160 offset:43008
ds_read_b64_tr_b16 v[42:43], v160 offset:44032
s_waitcnt lgkmcnt(10)
v_mfma_f32_32x32x16_bf16 v[16:31], v[52:55], v[136:139], v[16:31]
buffer_load_dwordx4 v[104:107], v167, s[8:11], s50 offen offset:2048
buffer_load_dwordx4 v[108:111], v167, s[8:11], s50 offen offset:3072
buffer_load_dwordx4 v[112:115], v167, s[8:11], s53 offen offset:0
ds_read_b64_tr_b16 v[44:45], v161 offset:43008
ds_read_b64_tr_b16 v[46:47], v161 offset:44032
s_waitcnt lgkmcnt(10)
v_mfma_f32_32x32x16_bf16 v[0:15], v[56:59], v[140:143], v[0:15]
buffer_load_dwordx4 v[116:119], v167, s[8:11], s53 offen offset:1024
buffer_load_dwordx4 v[120:123], v167, s[8:11], s53 offen offset:2048
buffer_load_dwordx4 v[124:127], v167, s[8:11], s53 offen offset:3072
ds_read_b64_tr_b16 v[48:49], v160 offset:45056
ds_read_b64_tr_b16 v[50:51], v160 offset:46080
s_waitcnt lgkmcnt(10)
v_mfma_f32_32x32x16_bf16 v[16:31], v[60:63], v[140:143], v[16:31]
s_add_u32 s50, s50, 57344
s_add_u32 s51, s51, 131072
ds_read_b64_tr_b16 v[52:53], v161 offset:45056
ds_read_b64_tr_b16 v[54:55], v161 offset:46080
s_waitcnt lgkmcnt(10)
v_mfma_f32_32x32x16_bf16 v[0:15], v[32:35], v[144:147], v[0:15]
ds_read_b64_tr_b16 v[56:57], v160 offset:47104
ds_read_b64_tr_b16 v[58:59], v160 offset:48128
s_waitcnt lgkmcnt(10)
v_mfma_f32_32x32x16_bf16 v[16:31], v[36:39], v[144:147], v[16:31]
ds_read_b64_tr_b16 v[60:61], v161 offset:47104
ds_read_b64_tr_b16 v[62:63], v161 offset:48128
s_waitcnt lgkmcnt(10)
v_mfma_f32_32x32x16_bf16 v[0:15], v[40:43], v[148:151], v[0:15]
s_waitcnt vmcnt(12)
s_barrier
ds_read_b64_tr_b16 v[32:33], v160 offset:49152
ds_read_b64_tr_b16 v[34:35], v160 offset:50176
s_waitcnt lgkmcnt(10)
v_mfma_f32_32x32x16_bf16 v[16:31], v[44:47], v[148:151], v[16:31]
ds_read_b64_tr_b16 v[36:37], v161 offset:49152
ds_read_b64_tr_b16 v[38:39], v161 offset:50176
s_waitcnt lgkmcnt(10)
v_mfma_f32_32x32x16_bf16 v[0:15], v[48:51], v[152:155], v[0:15]
ds_read_b64_tr_b16 v[40:41], v160 offset:51200
ds_read_b64_tr_b16 v[42:43], v160 offset:52224
s_waitcnt lgkmcnt(10)
v_mfma_f32_32x32x16_bf16 v[16:31], v[52:55], v[152:155], v[16:31]
ds_read_b64_tr_b16 v[44:45], v161 offset:51200
ds_read_b64_tr_b16 v[46:47], v161 offset:52224
s_waitcnt lgkmcnt(10)
v_mfma_f32_32x32x16_bf16 v[0:15], v[56:59], v[156:159], v[0:15]
ds_read_b64_tr_b16 v[48:49], v160 offset:53248
ds_read_b64_tr_b16 v[50:51], v160 offset:54272
s_waitcnt lgkmcnt(10)
v_mfma_f32_32x32x16_bf16 v[16:31], v[60:63], v[156:159], v[16:31]
ds_read_b64_tr_b16 v[52:53], v161 offset:53248
ds_read_b64_tr_b16 v[54:55], v161 offset:54272
s_waitcnt lgkmcnt(10)
v_mfma_f32_32x32x16_bf16 v[0:15], v[32:35], v[64:67], v[0:15]
s_add_u32 m0, s30, 81920
s_add_u32 s52, s51, 0
buffer_load_dwordx4 v166, s[12:15], s52 offen lds
ds_read_b64_tr_b16 v[56:57], v160 offset:55296
ds_read_b64_tr_b16 v[58:59], v160 offset:56320
s_waitcnt lgkmcnt(10)
v_mfma_f32_32x32x16_bf16 v[16:31], v[36:39], v[64:67], v[16:31]
s_add_u32 m0, s30, 82944
s_add_u32 s52, s51, 8192
buffer_load_dwordx4 v166, s[12:15], s52 offen lds
ds_read_b64_tr_b16 v[60:61], v161 offset:55296
ds_read_b64_tr_b16 v[62:63], v161 offset:56320
s_waitcnt lgkmcnt(10)
v_mfma_f32_32x32x16_bf16 v[0:15], v[40:43], v[68:71], v[0:15]
s_add_u32 m0, s30, 83968
s_add_u32 s52, s51, 16384
buffer_load_dwordx4 v166, s[12:15], s52 offen lds
ds_read_b64_tr_b16 v[32:33], v160 offset:57344
ds_read_b64_tr_b16 v[34:35], v160 offset:58368
s_waitcnt lgkmcnt(10)
v_mfma_f32_32x32x16_bf16 v[16:31], v[44:47], v[68:71], v[16:31]
s_add_u32 m0, s30, 84992
s_add_u32 s52, s51, 24576
buffer_load_dwordx4 v166, s[12:15], s52 offen lds
ds_read_b64_tr_b16 v[36:37], v161 offset:57344
ds_read_b64_tr_b16 v[38:39], v161 offset:58368
s_waitcnt lgkmcnt(10)
v_mfma_f32_32x32x16_bf16 v[0:15], v[48:51], v[72:75], v[0:15]
s_add_u32 s53, s50, 4096
buffer_load_dwordx4 v[128:131], v167, s[8:11], s50 offen offset:0
buffer_load_dwordx4 v[132:135], v167, s[8:11], s50 offen offset:1024
ds_read_b64_tr_b16 v[40:41], v160 offset:59392
ds_read_b64_tr_b16 v[42:43], v160 offset:60416
s_waitcnt lgkmcnt(10)
v_mfma_f32_32x32x16_bf16 v[16:31], v[52:55], v[72:75], v[16:31]
buffer_load_dwordx4 v[136:139], v167, s[8:11], s50 offen offset:2048
buffer_load_dwordx4 v[140:143], v167, s[8:11], s50 offen offset:3072
buffer_load_dwordx4 v[144:147], v167, s[8:11], s53 offen offset:0
ds_read_b64_tr_b16 v[44:45], v161 offset:59392
ds_read_b64_tr_b16 v[46:47], v161 offset:60416
s_waitcnt lgkmcnt(10)
v_mfma_f32_32x32x16_bf16 v[0:15], v[56:59], v[76:79], v[0:15]
buffer_load_dwordx4 v[148:151], v167, s[8:11], s53 offen offset:1024
buffer_load_dwordx4 v[152:155], v167, s[8:11], s53 offen offset:2048
buffer_load_dwordx4 v[156:159], v167, s[8:11], s53 offen offset:3072
ds_read_b64_tr_b16 v[48:49], v160 offset:61440
ds_read_b64_tr_b16 v[50:51], v160 offset:62464
s_waitcnt lgkmcnt(10)
v_mfma_f32_32x32x16_bf16 v[16:31], v[60:63], v[76:79], v[16:31]
s_add_u32 s50, s50, 57344
s_add_u32 s51, s51, 131072
ds_read_b64_tr_b16 v[52:53], v161 offset:61440
ds_read_b64_tr_b16 v[54:55], v161 offset:62464
s_waitcnt lgkmcnt(10)
v_mfma_f32_32x32x16_bf16 v[0:15], v[32:35], v[80:83], v[0:15]
ds_read_b64_tr_b16 v[56:57], v160 offset:63488
ds_read_b64_tr_b16 v[58:59], v160 offset:64512
s_waitcnt lgkmcnt(10)
v_mfma_f32_32x32x16_bf16 v[16:31], v[36:39], v[80:83], v[16:31]
ds_read_b64_tr_b16 v[60:61], v161 offset:63488
ds_read_b64_tr_b16 v[62:63], v161 offset:64512
s_waitcnt lgkmcnt(10)
v_mfma_f32_32x32x16_bf16 v[0:15], v[40:43], v[84:87], v[0:15]
s_waitcnt vmcnt(12)
s_barrier
ds_read_b64_tr_b16 v[32:33], v162 offset:0
ds_read_b64_tr_b16 v[34:35], v162 offset:1024
s_waitcnt lgkmcnt(10)
v_mfma_f32_32x32x16_bf16 v[16:31], v[44:47], v[84:87], v[16:31]
ds_read_b64_tr_b16 v[36:37], v163 offset:0
ds_read_b64_tr_b16 v[38:39], v163 offset:1024
s_waitcnt lgkmcnt(10)
v_mfma_f32_32x32x16_bf16 v[0:15], v[48:51], v[88:91], v[0:15]
ds_read_b64_tr_b16 v[40:41], v162 offset:2048
ds_read_b64_tr_b16 v[42:43], v162 offset:3072
s_waitcnt lgkmcnt(10)
v_mfma_f32_32x32x16_bf16 v[16:31], v[52:55], v[88:91], v[16:31]
ds_read_b64_tr_b16 v[44:45], v163 offset:2048
ds_read_b64_tr_b16 v[46:47], v163 offset:3072
s_waitcnt lgkmcnt(10)
v_mfma_f32_32x32x16_bf16 v[0:15], v[56:59], v[92:95], v[0:15]
ds_read_b64_tr_b16 v[48:49], v162 offset:4096
ds_read_b64_tr_b16 v[50:51], v162 offset:5120
s_waitcnt lgkmcnt(10)
v_mfma_f32_32x32x16_bf16 v[16:31], v[60:63], v[92:95], v[16:31]
ds_read_b64_tr_b16 v[52:53], v163 offset:4096
ds_read_b64_tr_b16 v[54:55], v163 offset:5120
s_waitcnt lgkmcnt(10)
v_mfma_f32_32x32x16_bf16 v[0:15], v[32:35], v[96:99], v[0:15]
s_add_u32 m0, s30, 98304
s_add_u32 s52, s51, 0
buffer_load_dwordx4 v166, s[12:15], s52 offen lds
ds_read_b64_tr_b16 v[56:57], v162 offset:6144
ds_read_b64_tr_b16 v[58:59], v162 offset:7168
s_waitcnt lgkmcnt(10)
v_mfma_f32_32x32x16_bf16 v[16:31], v[36:39], v[96:99], v[16:31]
s_add_u32 m0, s30, 99328
s_add_u32 s52, s51, 8192
buffer_load_dwordx4 v166, s[12:15], s52 offen lds
ds_read_b64_tr_b16 v[60:61], v163 offset:6144
ds_read_b64_tr_b16 v[62:63], v163 offset:7168
s_waitcnt lgkmcnt(10)
v_mfma_f32_32x32x16_bf16 v[0:15], v[40:43], v[100:103], v[0:15]
s_add_u32 m0, s30, 100352
s_add_u32 s52, s51, 16384
buffer_load_dwordx4 v166, s[12:15], s52 offen lds
ds_read_b64_tr_b16 v[32:33], v162 offset:8192
ds_read_b64_tr_b16 v[34:35], v162 offset:9216
s_waitcnt lgkmcnt(10)
v_mfma_f32_32x32x16_bf16 v[16:31], v[44:47], v[100:103], v[16:31]
s_add_u32 m0, s30, 101376
s_add_u32 s52, s51, 24576
buffer_load_dwordx4 v166, s[12:15], s52 offen lds
ds_read_b64_tr_b16 v[36:37], v163 offset:8192
ds_read_b64_tr_b16 v[38:39], v163 offset:9216
s_waitcnt lgkmcnt(10)
v_mfma_f32_32x32x16_bf16 v[0:15], v[48:51], v[104:107], v[0:15]
s_add_u32 s53, s50, 4096
buffer_load_dwordx4 v[64:67], v167, s[8:11], s50 offen offset:0
buffer_load_dwordx4 v[68:71], v167, s[8:11], s50 offen offset:1024
ds_read_b64_tr_b16 v[40:41], v162 offset:10240
ds_read_b64_tr_b16 v[42:43], v162 offset:11264
s_waitcnt lgkmcnt(10)
v_mfma_f32_32x32x16_bf16 v[16:31], v[52:55], v[104:107], v[16:31]
buffer_load_dwordx4 v[72:75], v167, s[8:11], s50 offen offset:2048
buffer_load_dwordx4 v[76:79], v167, s[8:11], s50 offen offset:3072
buffer_load_dwordx4 v[80:83], v167, s[8:11], s53 offen offset:0
ds_read_b64_tr_b16 v[44:45], v163 offset:10240
ds_read_b64_tr_b16 v[46:47], v163 offset:11264
s_waitcnt lgkmcnt(10)
v_mfma_f32_32x32x16_bf16 v[0:15], v[56:59], v[108:111], v[0:15]
buffer_load_dwordx4 v[84:87], v167, s[8:11], s53 offen offset:1024
buffer_load_dwordx4 v[88:91], v167, s[8:11], s53 offen offset:2048
buffer_load_dwordx4 v[92:95], v167, s[8:11], s53 offen offset:3072
ds_read_b64_tr_b16 v[48:49], v162 offset:12288
ds_read_b64_tr_b16 v[50:51], v162 offset:13312
s_waitcnt lgkmcnt(10)
v_mfma_f32_32x32x16_bf16 v[16:31], v[60:63], v[108:111], v[16:31]
s_add_u32 s50, s50, 57344
s_add_u32 s51, s51, 131072
ds_read_b64_tr_b16 v[52:53], v163 offset:12288
ds_read_b64_tr_b16 v[54:55], v163 offset:13312
s_waitcnt lgkmcnt(10)
v_mfma_f32_32x32x16_bf16 v[0:15], v[32:35], v[112:115], v[0:15]
ds_read_b64_tr_b16 v[56:57], v162 offset:14336
ds_read_b64_tr_b16 v[58:59], v162 offset:15360
s_waitcnt lgkmcnt(10)
v_mfma_f32_32x32x16_bf16 v[16:31], v[36:39], v[112:115], v[16:31]
ds_read_b64_tr_b16 v[60:61], v163 offset:14336
ds_read_b64_tr_b16 v[62:63], v163 offset:15360
s_waitcnt lgkmcnt(10)
v_mfma_f32_32x32x16_bf16 v[0:15], v[40:43], v[116:119], v[0:15]
s_waitcnt vmcnt(12)
s_barrier
ds_read_b64_tr_b16 v[32:33], v162 offset:16384
ds_read_b64_tr_b16 v[34:35], v162 offset:17408
s_waitcnt lgkmcnt(10)
v_mfma_f32_32x32x16_bf16 v[16:31], v[44:47], v[116:119], v[16:31]
ds_read_b64_tr_b16 v[36:37], v163 offset:16384
ds_read_b64_tr_b16 v[38:39], v163 offset:17408
s_waitcnt lgkmcnt(10)
v_mfma_f32_32x32x16_bf16 v[0:15], v[48:51], v[120:123], v[0:15]
ds_read_b64_tr_b16 v[40:41], v162 offset:18432
ds_read_b64_tr_b16 v[42:43], v162 offset:19456
s_waitcnt lgkmcnt(10)
v_mfma_f32_32x32x16_bf16 v[16:31], v[52:55], v[120:123], v[16:31]
ds_read_b64_tr_b16 v[44:45], v163 offset:18432
ds_read_b64_tr_b16 v[46:47], v163 offset:19456
s_waitcnt lgkmcnt(10)
v_mfma_f32_32x32x16_bf16 v[0:15], v[56:59], v[124:127], v[0:15]
ds_read_b64_tr_b16 v[48:49], v162 offset:20480
ds_read_b64_tr_b16 v[50:51], v162 offset:21504
s_waitcnt lgkmcnt(10)
v_mfma_f32_32x32x16_bf16 v[16:31], v[60:63], v[124:127], v[16:31]
ds_read_b64_tr_b16 v[52:53], v163 offset:20480
ds_read_b64_tr_b16 v[54:55], v163 offset:21504
s_waitcnt lgkmcnt(10)
v_mfma_f32_32x32x16_bf16 v[0:15], v[32:35], v[128:131], v[0:15]
s_add_u32 m0, s30, 114688
s_add_u32 s52, s51, 0
buffer_load_dwordx4 v166, s[12:15], s52 offen lds
ds_read_b64_tr_b16 v[56:57], v162 offset:22528
ds_read_b64_tr_b16 v[58:59], v162 offset:23552
s_waitcnt lgkmcnt(10)
v_mfma_f32_32x32x16_bf16 v[16:31], v[36:39], v[128:131], v[16:31]
s_add_u32 m0, s30, 115712
s_add_u32 s52, s51, 8192
buffer_load_dwordx4 v166, s[12:15], s52 offen lds
ds_read_b64_tr_b16 v[60:61], v163 offset:22528
ds_read_b64_tr_b16 v[62:63], v163 offset:23552
s_waitcnt lgkmcnt(10)
v_mfma_f32_32x32x16_bf16 v[0:15], v[40:43], v[132:135], v[0:15]
s_add_u32 m0, s30, 116736
s_add_u32 s52, s51, 16384
buffer_load_dwordx4 v166, s[12:15], s52 offen lds
ds_read_b64_tr_b16 v[32:33], v162 offset:24576
ds_read_b64_tr_b16 v[34:35], v162 offset:25600
s_waitcnt lgkmcnt(10)
v_mfma_f32_32x32x16_bf16 v[16:31], v[44:47], v[132:135], v[16:31]
s_add_u32 m0, s30, 117760
s_add_u32 s52, s51, 24576
buffer_load_dwordx4 v166, s[12:15], s52 offen lds
ds_read_b64_tr_b16 v[36:37], v163 offset:24576
ds_read_b64_tr_b16 v[38:39], v163 offset:25600
s_waitcnt lgkmcnt(10)
v_mfma_f32_32x32x16_bf16 v[0:15], v[48:51], v[136:139], v[0:15]
s_add_u32 s53, s50, 4096
buffer_load_dwordx4 v[96:99], v167, s[8:11], s50 offen offset:0
buffer_load_dwordx4 v[100:103], v167, s[8:11], s50 offen offset:1024
ds_read_b64_tr_b16 v[40:41], v162 offset:26624
ds_read_b64_tr_b16 v[42:43], v162 offset:27648
s_waitcnt lgkmcnt(10)
v_mfma_f32_32x32x16_bf16 v[16:31], v[52:55], v[136:139], v[16:31]
buffer_load_dwordx4 v[104:107], v167, s[8:11], s50 offen offset:2048
buffer_load_dwordx4 v[108:111], v167, s[8:11], s50 offen offset:3072
buffer_load_dwordx4 v[112:115], v167, s[8:11], s53 offen offset:0
ds_read_b64_tr_b16 v[44:45], v163 offset:26624
ds_read_b64_tr_b16 v[46:47], v163 offset:27648
s_waitcnt lgkmcnt(10)
v_mfma_f32_32x32x16_bf16 v[0:15], v[56:59], v[140:143], v[0:15]
buffer_load_dwordx4 v[116:119], v167, s[8:11], s53 offen offset:1024
buffer_load_dwordx4 v[120:123], v167, s[8:11], s53 offen offset:2048
buffer_load_dwordx4 v[124:127], v167, s[8:11], s53 offen offset:3072
ds_read_b64_tr_b16 v[48:49], v162 offset:28672
ds_read_b64_tr_b16 v[50:51], v162 offset:29696
s_waitcnt lgkmcnt(10)
v_mfma_f32_32x32x16_bf16 v[16:31], v[60:63], v[140:143], v[16:31]
s_add_u32 s50, s50, 57344
s_add_u32 s51, s51, 131072
ds_read_b64_tr_b16 v[52:53], v163 offset:28672
ds_read_b64_tr_b16 v[54:55], v163 offset:29696
s_waitcnt lgkmcnt(10)
v_mfma_f32_32x32x16_bf16 v[0:15], v[32:35], v[144:147], v[0:15]
ds_read_b64_tr_b16 v[56:57], v162 offset:30720
ds_read_b64_tr_b16 v[58:59], v162 offset:31744
s_waitcnt lgkmcnt(10)
v_mfma_f32_32x32x16_bf16 v[16:31], v[36:39], v[144:147], v[16:31]
ds_read_b64_tr_b16 v[60:61], v163 offset:30720
ds_read_b64_tr_b16 v[62:63], v163 offset:31744
s_waitcnt lgkmcnt(10)
v_mfma_f32_32x32x16_bf16 v[0:15], v[40:43], v[148:151], v[0:15]
s_waitcnt vmcnt(12)
s_barrier
ds_read_b64_tr_b16 v[32:33], v162 offset:32768
ds_read_b64_tr_b16 v[34:35], v162 offset:33792
s_waitcnt lgkmcnt(10)
v_mfma_f32_32x32x16_bf16 v[16:31], v[44:47], v[148:151], v[16:31]
ds_read_b64_tr_b16 v[36:37], v163 offset:32768
ds_read_b64_tr_b16 v[38:39], v163 offset:33792
s_waitcnt lgkmcnt(10)
v_mfma_f32_32x32x16_bf16 v[0:15], v[48:51], v[152:155], v[0:15]
ds_read_b64_tr_b16 v[40:41], v162 offset:34816
ds_read_b64_tr_b16 v[42:43], v162 offset:35840
s_waitcnt lgkmcnt(10)
v_mfma_f32_32x32x16_bf16 v[16:31], v[52:55], v[152:155], v[16:31]
ds_read_b64_tr_b16 v[44:45], v163 offset:34816
ds_read_b64_tr_b16 v[46:47], v163 offset:35840
s_waitcnt lgkmcnt(10)
v_mfma_f32_32x32x16_bf16 v[0:15], v[56:59], v[156:159], v[0:15]
ds_read_b64_tr_b16 v[48:49], v162 offset:36864
ds_read_b64_tr_b16 v[50:51], v162 offset:37888
s_waitcnt lgkmcnt(10)
v_mfma_f32_32x32x16_bf16 v[16:31], v[60:63], v[156:159], v[16:31]
ds_read_b64_tr_b16 v[52:53], v163 offset:36864
ds_read_b64_tr_b16 v[54:55], v163 offset:37888
s_waitcnt lgkmcnt(10)
v_mfma_f32_32x32x16_bf16 v[0:15], v[32:35], v[64:67], v[0:15]
s_add_u32 m0, s30, 0
s_add_u32 s52, s51, 0
buffer_load_dwordx4 v166, s[12:15], s52 offen lds
ds_read_b64_tr_b16 v[56:57], v162 offset:38912
ds_read_b64_tr_b16 v[58:59], v162 offset:39936
s_waitcnt lgkmcnt(10)
v_mfma_f32_32x32x16_bf16 v[16:31], v[36:39], v[64:67], v[16:31]
s_add_u32 m0, s30, 1024
s_add_u32 s52, s51, 8192
buffer_load_dwordx4 v166, s[12:15], s52 offen lds
ds_read_b64_tr_b16 v[60:61], v163 offset:38912
ds_read_b64_tr_b16 v[62:63], v163 offset:39936
s_waitcnt lgkmcnt(10)
v_mfma_f32_32x32x16_bf16 v[0:15], v[40:43], v[68:71], v[0:15]
s_add_u32 m0, s30, 2048
s_add_u32 s52, s51, 16384
buffer_load_dwordx4 v166, s[12:15], s52 offen lds
ds_read_b64_tr_b16 v[32:33], v162 offset:40960
ds_read_b64_tr_b16 v[34:35], v162 offset:41984
s_waitcnt lgkmcnt(10)
v_mfma_f32_32x32x16_bf16 v[16:31], v[44:47], v[68:71], v[16:31]
s_add_u32 m0, s30, 3072
s_add_u32 s52, s51, 24576
buffer_load_dwordx4 v166, s[12:15], s52 offen lds
ds_read_b64_tr_b16 v[36:37], v163 offset:40960
ds_read_b64_tr_b16 v[38:39], v163 offset:41984
s_waitcnt lgkmcnt(10)
v_mfma_f32_32x32x16_bf16 v[0:15], v[48:51], v[72:75], v[0:15]
s_add_u32 s53, s50, 4096
buffer_load_dwordx4 v[128:131], v167, s[8:11], s50 offen offset:0
buffer_load_dwordx4 v[132:135], v167, s[8:11], s50 offen offset:1024
ds_read_b64_tr_b16 v[40:41], v162 offset:43008
ds_read_b64_tr_b16 v[42:43], v162 offset:44032
s_waitcnt lgkmcnt(10)
v_mfma_f32_32x32x16_bf16 v[16:31], v[52:55], v[72:75], v[16:31]
buffer_load_dwordx4 v[136:139], v167, s[8:11], s50 offen offset:2048
buffer_load_dwordx4 v[140:143], v167, s[8:11], s50 offen offset:3072
buffer_load_dwordx4 v[144:147], v167, s[8:11], s53 offen offset:0
ds_read_b64_tr_b16 v[44:45], v163 offset:43008
ds_read_b64_tr_b16 v[46:47], v163 offset:44032
s_waitcnt lgkmcnt(10)
v_mfma_f32_32x32x16_bf16 v[0:15], v[56:59], v[76:79], v[0:15]
buffer_load_dwordx4 v[148:151], v167, s[8:11], s53 offen offset:1024
buffer_load_dwordx4 v[152:155], v167, s[8:11], s53 offen offset:2048
buffer_load_dwordx4 v[156:159], v167, s[8:11], s53 offen offset:3072
ds_read_b64_tr_b16 v[48:49], v162 offset:45056
ds_read_b64_tr_b16 v[50:51], v162 offset:46080
s_waitcnt lgkmcnt(10)
v_mfma_f32_32x32x16_bf16 v[16:31], v[60:63], v[76:79], v[16:31]
s_add_u32 s50, s50, 57344
s_add_u32 s51, s51, 131072
ds_read_b64_tr_b16 v[52:53], v163 offset:45056
ds_read_b64_tr_b16 v[54:55], v163 offset:46080
s_waitcnt lgkmcnt(10)
v_mfma_f32_32x32x16_bf16 v[0:15], v[32:35], v[80:83], v[0:15]
ds_read_b64_tr_b16 v[56:57], v162 offset:47104
ds_read_b64_tr_b16 v[58:59], v162 offset:48128
s_waitcnt lgkmcnt(10)
v_mfma_f32_32x32x16_bf16 v[16:31], v[36:39], v[80:83], v[16:31]
ds_read_b64_tr_b16 v[60:61], v163 offset:47104
ds_read_b64_tr_b16 v[62:63], v163 offset:48128
s_waitcnt lgkmcnt(10)
v_mfma_f32_32x32x16_bf16 v[0:15], v[40:43], v[84:87], v[0:15]
s_waitcnt vmcnt(12)
s_barrier
ds_read_b64_tr_b16 v[32:33], v162 offset:49152
ds_read_b64_tr_b16 v[34:35], v162 offset:50176
s_waitcnt lgkmcnt(10)
v_mfma_f32_32x32x16_bf16 v[16:31], v[44:47], v[84:87], v[16:31]
ds_read_b64_tr_b16 v[36:37], v163 offset:49152
ds_read_b64_tr_b16 v[38:39], v163 offset:50176
s_waitcnt lgkmcnt(10)
v_mfma_f32_32x32x16_bf16 v[0:15], v[48:51], v[88:91], v[0:15]
ds_read_b64_tr_b16 v[40:41], v162 offset:51200
ds_read_b64_tr_b16 v[42:43], v162 offset:52224
s_waitcnt lgkmcnt(10)
v_mfma_f32_32x32x16_bf16 v[16:31], v[52:55], v[88:91], v[16:31]
ds_read_b64_tr_b16 v[44:45], v163 offset:51200
ds_read_b64_tr_b16 v[46:47], v163 offset:52224
s_waitcnt lgkmcnt(10)
v_mfma_f32_32x32x16_bf16 v[0:15], v[56:59], v[92:95], v[0:15]
ds_read_b64_tr_b16 v[48:49], v162 offset:53248
ds_read_b64_tr_b16 v[50:51], v162 offset:54272
s_waitcnt lgkmcnt(10)
v_mfma_f32_32x32x16_bf16 v[16:31], v[60:63], v[92:95], v[16:31]
ds_read_b64_tr_b16 v[52:53], v163 offset:53248
ds_read_b64_tr_b16 v[54:55], v163 offset:54272
s_waitcnt lgkmcnt(10)
v_mfma_f32_32x32x16_bf16 v[0:15], v[32:35], v[96:99], v[0:15]
s_add_u32 m0, s30, 16384
s_add_u32 s52, s51, 0
buffer_load_dwordx4 v166, s[12:15], s52 offen lds
ds_read_b64_tr_b16 v[56:57], v162 offset:55296
ds_read_b64_tr_b16 v[58:59], v162 offset:56320
s_waitcnt lgkmcnt(10)
v_mfma_f32_32x32x16_bf16 v[16:31], v[36:39], v[96:99], v[16:31]
s_add_u32 m0, s30, 17408
s_add_u32 s52, s51, 8192
buffer_load_dwordx4 v166, s[12:15], s52 offen lds
ds_read_b64_tr_b16 v[60:61], v163 offset:55296
ds_read_b64_tr_b16 v[62:63], v163 offset:56320
s_waitcnt lgkmcnt(10)
v_mfma_f32_32x32x16_bf16 v[0:15], v[40:43], v[100:103], v[0:15]
s_add_u32 m0, s30, 18432
s_add_u32 s52, s51, 16384
buffer_load_dwordx4 v166, s[12:15], s52 offen lds
ds_read_b64_tr_b16 v[32:33], v162 offset:57344
ds_read_b64_tr_b16 v[34:35], v162 offset:58368
s_waitcnt lgkmcnt(10)
v_mfma_f32_32x32x16_bf16 v[16:31], v[44:47], v[100:103], v[16:31]
s_add_u32 m0, s30, 19456
s_add_u32 s52, s51, 24576
buffer_load_dwordx4 v166, s[12:15], s52 offen lds
ds_read_b64_tr_b16 v[36:37], v163 offset:57344
ds_read_b64_tr_b16 v[38:39], v163 offset:58368
s_waitcnt lgkmcnt(10)
v_mfma_f32_32x32x16_bf16 v[0:15], v[48:51], v[104:107], v[0:15]
s_add_u32 s53, s50, 4096
buffer_load_dwordx4 v[64:67], v167, s[8:11], s50 offen offset:0
buffer_load_dwordx4 v[68:71], v167, s[8:11], s50 offen offset:1024
ds_read_b64_tr_b16 v[40:41], v162 offset:59392
ds_read_b64_tr_b16 v[42:43], v162 offset:60416
s_waitcnt lgkmcnt(10)
v_mfma_f32_32x32x16_bf16 v[16:31], v[52:55], v[104:107], v[16:31]
buffer_load_dwordx4 v[72:75], v167, s[8:11], s50 offen offset:2048
buffer_load_dwordx4 v[76:79], v167, s[8:11], s50 offen offset:3072
buffer_load_dwordx4 v[80:83], v167, s[8:11], s53 offen offset:0
ds_read_b64_tr_b16 v[44:45], v163 offset:59392
ds_read_b64_tr_b16 v[46:47], v163 offset:60416
s_waitcnt lgkmcnt(10)
v_mfma_f32_32x32x16_bf16 v[0:15], v[56:59], v[108:111], v[0:15]
buffer_load_dwordx4 v[84:87], v167, s[8:11], s53 offen offset:1024
buffer_load_dwordx4 v[88:91], v167, s[8:11], s53 offen offset:2048
buffer_load_dwordx4 v[92:95], v167, s[8:11], s53 offen offset:3072
ds_read_b64_tr_b16 v[48:49], v162 offset:61440
ds_read_b64_tr_b16 v[50:51], v162 offset:62464
s_waitcnt lgkmcnt(10)
v_mfma_f32_32x32x16_bf16 v[16:31], v[60:63], v[108:111], v[16:31]
s_add_u32 s50, s50, 57344
s_add_u32 s51, s51, 131072
ds_read_b64_tr_b16 v[52:53], v163 offset:61440
ds_read_b64_tr_b16 v[54:55], v163 offset:62464
s_waitcnt lgkmcnt(10)
v_mfma_f32_32x32x16_bf16 v[0:15], v[32:35], v[112:115], v[0:15]
ds_read_b64_tr_b16 v[56:57], v162 offset:63488
ds_read_b64_tr_b16 v[58:59], v162 offset:64512
s_waitcnt lgkmcnt(10)
v_mfma_f32_32x32x16_bf16 v[16:31], v[36:39], v[112:115], v[16:31]
ds_read_b64_tr_b16 v[60:61], v163 offset:63488
ds_read_b64_tr_b16 v[62:63], v163 offset:64512
s_waitcnt lgkmcnt(10)
v_mfma_f32_32x32x16_bf16 v[0:15], v[40:43], v[116:119], v[0:15]
s_waitcnt vmcnt(12)
s_barrier
ds_read_b64_tr_b16 v[32:33], v160 offset:0
ds_read_b64_tr_b16 v[34:35], v160 offset:1024
s_waitcnt lgkmcnt(10)
v_mfma_f32_32x32x16_bf16 v[16:31], v[44:47], v[116:119], v[16:31]
ds_read_b64_tr_b16 v[36:37], v161 offset:0
ds_read_b64_tr_b16 v[38:39], v161 offset:1024
s_waitcnt lgkmcnt(10)
v_mfma_f32_32x32x16_bf16 v[0:15], v[48:51], v[120:123], v[0:15]
ds_read_b64_tr_b16 v[40:41], v160 offset:2048
ds_read_b64_tr_b16 v[42:43], v160 offset:3072
s_waitcnt lgkmcnt(10)
v_mfma_f32_32x32x16_bf16 v[16:31], v[52:55], v[120:123], v[16:31]
ds_read_b64_tr_b16 v[44:45], v161 offset:2048
ds_read_b64_tr_b16 v[46:47], v161 offset:3072
s_waitcnt lgkmcnt(10)
v_mfma_f32_32x32x16_bf16 v[0:15], v[56:59], v[124:127], v[0:15]
ds_read_b64_tr_b16 v[48:49], v160 offset:4096
ds_read_b64_tr_b16 v[50:51], v160 offset:5120
s_waitcnt lgkmcnt(10)
v_mfma_f32_32x32x16_bf16 v[16:31], v[60:63], v[124:127], v[16:31]
ds_read_b64_tr_b16 v[52:53], v161 offset:4096
ds_read_b64_tr_b16 v[54:55], v161 offset:5120
s_waitcnt lgkmcnt(10)
v_mfma_f32_32x32x16_bf16 v[0:15], v[32:35], v[128:131], v[0:15]
s_add_u32 m0, s30, 32768
s_add_u32 s52, s51, 0
buffer_load_dwordx4 v166, s[12:15], s52 offen lds
ds_read_b64_tr_b16 v[56:57], v160 offset:6144
ds_read_b64_tr_b16 v[58:59], v160 offset:7168
s_waitcnt lgkmcnt(10)
v_mfma_f32_32x32x16_bf16 v[16:31], v[36:39], v[128:131], v[16:31]
s_add_u32 m0, s30, 33792
s_add_u32 s52, s51, 8192
buffer_load_dwordx4 v166, s[12:15], s52 offen lds
ds_read_b64_tr_b16 v[60:61], v161 offset:6144
ds_read_b64_tr_b16 v[62:63], v161 offset:7168
s_waitcnt lgkmcnt(10)
v_mfma_f32_32x32x16_bf16 v[0:15], v[40:43], v[132:135], v[0:15]
s_add_u32 m0, s30, 34816
s_add_u32 s52, s51, 16384
buffer_load_dwordx4 v166, s[12:15], s52 offen lds
ds_read_b64_tr_b16 v[32:33], v160 offset:8192
ds_read_b64_tr_b16 v[34:35], v160 offset:9216
s_waitcnt lgkmcnt(10)
v_mfma_f32_32x32x16_bf16 v[16:31], v[44:47], v[132:135], v[16:31]
s_add_u32 m0, s30, 35840
s_add_u32 s52, s51, 24576
buffer_load_dwordx4 v166, s[12:15], s52 offen lds
ds_read_b64_tr_b16 v[36:37], v161 offset:8192
ds_read_b64_tr_b16 v[38:39], v161 offset:9216
s_waitcnt lgkmcnt(10)
v_mfma_f32_32x32x16_bf16 v[0:15], v[48:51], v[136:139], v[0:15]
s_add_u32 s53, s50, 4096
buffer_load_dwordx4 v[96:99], v167, s[8:11], s50 offen offset:0
buffer_load_dwordx4 v[100:103], v167, s[8:11], s50 offen offset:1024
ds_read_b64_tr_b16 v[40:41], v160 offset:10240
ds_read_b64_tr_b16 v[42:43], v160 offset:11264
s_waitcnt lgkmcnt(10)
v_mfma_f32_32x32x16_bf16 v[16:31], v[52:55], v[136:139], v[16:31]
buffer_load_dwordx4 v[104:107], v167, s[8:11], s50 offen offset:2048
buffer_load_dwordx4 v[108:111], v167, s[8:11], s50 offen offset:3072
buffer_load_dwordx4 v[112:115], v167, s[8:11], s53 offen offset:0
ds_read_b64_tr_b16 v[44:45], v161 offset:10240
ds_read_b64_tr_b16 v[46:47], v161 offset:11264
s_waitcnt lgkmcnt(10)
v_mfma_f32_32x32x16_bf16 v[0:15], v[56:59], v[140:143], v[0:15]
buffer_load_dwordx4 v[116:119], v167, s[8:11], s53 offen offset:1024
buffer_load_dwordx4 v[120:123], v167, s[8:11], s53 offen offset:2048
buffer_load_dwordx4 v[124:127], v167, s[8:11], s53 offen offset:3072
ds_read_b64_tr_b16 v[48:49], v160 offset:12288
ds_read_b64_tr_b16 v[50:51], v160 offset:13312
s_waitcnt lgkmcnt(10)
v_mfma_f32_32x32x16_bf16 v[16:31], v[60:63], v[140:143], v[16:31]
s_add_u32 s50, s50, 57344
s_add_u32 s51, s51, 131072
ds_read_b64_tr_b16 v[52:53], v161 offset:12288
ds_read_b64_tr_b16 v[54:55], v161 offset:13312
s_waitcnt lgkmcnt(10)
v_mfma_f32_32x32x16_bf16 v[0:15], v[32:35], v[144:147], v[0:15]
ds_read_b64_tr_b16 v[56:57], v160 offset:14336
ds_read_b64_tr_b16 v[58:59], v160 offset:15360
s_waitcnt lgkmcnt(10)
v_mfma_f32_32x32x16_bf16 v[16:31], v[36:39], v[144:147], v[16:31]
ds_read_b64_tr_b16 v[60:61], v161 offset:14336
ds_read_b64_tr_b16 v[62:63], v161 offset:15360
s_waitcnt lgkmcnt(10)
v_mfma_f32_32x32x16_bf16 v[0:15], v[40:43], v[148:151], v[0:15]
s_waitcnt vmcnt(12)
s_barrier
ds_read_b64_tr_b16 v[32:33], v160 offset:16384
ds_read_b64_tr_b16 v[34:35], v160 offset:17408
s_waitcnt lgkmcnt(10)
v_mfma_f32_32x32x16_bf16 v[16:31], v[44:47], v[148:151], v[16:31]
ds_read_b64_tr_b16 v[36:37], v161 offset:16384
ds_read_b64_tr_b16 v[38:39], v161 offset:17408
s_waitcnt lgkmcnt(10)
v_mfma_f32_32x32x16_bf16 v[0:15], v[48:51], v[152:155], v[0:15]
ds_read_b64_tr_b16 v[40:41], v160 offset:18432
ds_read_b64_tr_b16 v[42:43], v160 offset:19456
s_waitcnt lgkmcnt(10)
v_mfma_f32_32x32x16_bf16 v[16:31], v[52:55], v[152:155], v[16:31]
ds_read_b64_tr_b16 v[44:45], v161 offset:18432
ds_read_b64_tr_b16 v[46:47], v161 offset:19456
s_waitcnt lgkmcnt(10)
v_mfma_f32_32x32x16_bf16 v[0:15], v[56:59], v[156:159], v[0:15]
ds_read_b64_tr_b16 v[48:49], v160 offset:20480
ds_read_b64_tr_b16 v[50:51], v160 offset:21504
s_waitcnt lgkmcnt(10)
v_mfma_f32_32x32x16_bf16 v[16:31], v[60:63], v[156:159], v[16:31]
ds_read_b64_tr_b16 v[52:53], v161 offset:20480
ds_read_b64_tr_b16 v[54:55], v161 offset:21504
s_waitcnt lgkmcnt(10)
v_mfma_f32_32x32x16_bf16 v[0:15], v[32:35], v[64:67], v[0:15]
s_add_u32 m0, s30, 49152
s_add_u32 s52, s51, 0
buffer_load_dwordx4 v166, s[12:15], s52 offen lds
ds_read_b64_tr_b16 v[56:57], v160 offset:22528
ds_read_b64_tr_b16 v[58:59], v160 offset:23552
s_waitcnt lgkmcnt(10)
v_mfma_f32_32x32x16_bf16 v[16:31], v[36:39], v[64:67], v[16:31]
s_add_u32 m0, s30, 50176
s_add_u32 s52, s51, 8192
buffer_load_dwordx4 v166, s[12:15], s52 offen lds
ds_read_b64_tr_b16 v[60:61], v161 offset:22528
ds_read_b64_tr_b16 v[62:63], v161 offset:23552
s_waitcnt lgkmcnt(10)
v_mfma_f32_32x32x16_bf16 v[0:15], v[40:43], v[68:71], v[0:15]
s_add_u32 m0, s30, 51200
s_add_u32 s52, s51, 16384
buffer_load_dwordx4 v166, s[12:15], s52 offen lds
ds_read_b64_tr_b16 v[32:33], v160 offset:24576
ds_read_b64_tr_b16 v[34:35], v160 offset:25600
s_waitcnt lgkmcnt(10)
v_mfma_f32_32x32x16_bf16 v[16:31], v[44:47], v[68:71], v[16:31]
s_add_u32 m0, s30, 52224
s_add_u32 s52, s51, 24576
buffer_load_dwordx4 v166, s[12:15], s52 offen lds
ds_read_b64_tr_b16 v[36:37], v161 offset:24576
ds_read_b64_tr_b16 v[38:39], v161 offset:25600
s_waitcnt lgkmcnt(10)
v_mfma_f32_32x32x16_bf16 v[0:15], v[48:51], v[72:75], v[0:15]
s_add_u32 s53, s50, 4096
buffer_load_dwordx4 v[128:131], v167, s[8:11], s50 offen offset:0
buffer_load_dwordx4 v[132:135], v167, s[8:11], s50 offen offset:1024
ds_read_b64_tr_b16 v[40:41], v160 offset:26624
ds_read_b64_tr_b16 v[42:43], v160 offset:27648
s_waitcnt lgkmcnt(10)
v_mfma_f32_32x32x16_bf16 v[16:31], v[52:55], v[72:75], v[16:31]
buffer_load_dwordx4 v[136:139], v167, s[8:11], s50 offen offset:2048
buffer_load_dwordx4 v[140:143], v167, s[8:11], s50 offen offset:3072
buffer_load_dwordx4 v[144:147], v167, s[8:11], s53 offen offset:0
ds_read_b64_tr_b16 v[44:45], v161 offset:26624
ds_read_b64_tr_b16 v[46:47], v161 offset:27648
s_waitcnt lgkmcnt(10)
v_mfma_f32_32x32x16_bf16 v[0:15], v[56:59], v[76:79], v[0:15]
buffer_load_dwordx4 v[148:151], v167, s[8:11], s53 offen offset:1024
buffer_load_dwordx4 v[152:155], v167, s[8:11], s53 offen offset:2048
buffer_load_dwordx4 v[156:159], v167, s[8:11], s53 offen offset:3072
ds_read_b64_tr_b16 v[48:49], v160 offset:28672
ds_read_b64_tr_b16 v[50:51], v160 offset:29696
s_waitcnt lgkmcnt(10)
v_mfma_f32_32x32x16_bf16 v[16:31], v[60:63], v[76:79], v[16:31]
s_add_u32 s50, s50, 57344
s_add_u32 s51, s51, 131072
ds_read_b64_tr_b16 v[52:53], v161 offset:28672
ds_read_b64_tr_b16 v[54:55], v161 offset:29696
s_waitcnt lgkmcnt(10)
v_mfma_f32_32x32x16_bf16 v[0:15], v[32:35], v[80:83], v[0:15]
ds_read_b64_tr_b16 v[56:57], v160 offset:30720
ds_read_b64_tr_b16 v[58:59], v160 offset:31744
s_waitcnt lgkmcnt(10)
v_mfma_f32_32x32x16_bf16 v[16:31], v[36:39], v[80:83], v[16:31]
ds_read_b64_tr_b16 v[60:61], v161 offset:30720
ds_read_b64_tr_b16 v[62:63], v161 offset:31744
s_waitcnt lgkmcnt(10)
v_mfma_f32_32x32x16_bf16 v[0:15], v[40:43], v[84:87], v[0:15]
s_waitcnt vmcnt(12)
s_barrier
ds_read_b64_tr_b16 v[32:33], v160 offset:32768
ds_read_b64_tr_b16 v[34:35], v160 offset:33792
s_waitcnt lgkmcnt(10)
v_mfma_f32_32x32x16_bf16 v[16:31], v[44:47], v[84:87], v[16:31]
ds_read_b64_tr_b16 v[36:37], v161 offset:32768
ds_read_b64_tr_b16 v[38:39], v161 offset:33792
s_waitcnt lgkmcnt(10)
v_mfma_f32_32x32x16_bf16 v[0:15], v[48:51], v[88:91], v[0:15]
ds_read_b64_tr_b16 v[40:41], v160 offset:34816
ds_read_b64_tr_b16 v[42:43], v160 offset:35840
s_waitcnt lgkmcnt(10)
v_mfma_f32_32x32x16_bf16 v[16:31], v[52:55], v[88:91], v[16:31]
ds_read_b64_tr_b16 v[44:45], v161 offset:34816
ds_read_b64_tr_b16 v[46:47], v161 offset:35840
s_waitcnt lgkmcnt(10)
v_mfma_f32_32x32x16_bf16 v[0:15], v[56:59], v[92:95], v[0:15]
ds_read_b64_tr_b16 v[48:49], v160 offset:36864
ds_read_b64_tr_b16 v[50:51], v160 offset:37888
s_waitcnt lgkmcnt(10)
v_mfma_f32_32x32x16_bf16 v[16:31], v[60:63], v[92:95], v[16:31]
ds_read_b64_tr_b16 v[52:53], v161 offset:36864
ds_read_b64_tr_b16 v[54:55], v161 offset:37888
s_waitcnt lgkmcnt(10)
v_mfma_f32_32x32x16_bf16 v[0:15], v[32:35], v[96:99], v[0:15]
s_add_u32 m0, s30, 65536
s_add_u32 s52, s51, 0
buffer_load_dwordx4 v166, s[12:15], s52 offen lds
ds_read_b64_tr_b16 v[56:57], v160 offset:38912
ds_read_b64_tr_b16 v[58:59], v160 offset:39936
s_waitcnt lgkmcnt(10)
v_mfma_f32_32x32x16_bf16 v[16:31], v[36:39], v[96:99], v[16:31]
s_add_u32 m0, s30, 66560
s_add_u32 s52, s51, 8192
buffer_load_dwordx4 v166, s[12:15], s52 offen lds
ds_read_b64_tr_b16 v[60:61], v161 offset:38912
ds_read_b64_tr_b16 v[62:63], v161 offset:39936
s_waitcnt lgkmcnt(10)
v_mfma_f32_32x32x16_bf16 v[0:15], v[40:43], v[100:103], v[0:15]
s_add_u32 m0, s30, 67584
s_add_u32 s52, s51, 16384
buffer_load_dwordx4 v166, s[12:15], s52 offen lds
ds_read_b64_tr_b16 v[32:33], v160 offset:40960
ds_read_b64_tr_b16 v[34:35], v160 offset:41984
s_waitcnt lgkmcnt(10)
v_mfma_f32_32x32x16_bf16 v[16:31], v[44:47], v[100:103], v[16:31]
s_add_u32 m0, s30, 68608
s_add_u32 s52, s51, 24576
buffer_load_dwordx4 v166, s[12:15], s52 offen lds
ds_read_b64_tr_b16 v[36:37], v161 offset:40960
ds_read_b64_tr_b16 v[38:39], v161 offset:41984
s_waitcnt lgkmcnt(10)
v_mfma_f32_32x32x16_bf16 v[0:15], v[48:51], v[104:107], v[0:15]
s_add_u32 s53, s50, 4096
buffer_load_dwordx4 v[64:67], v167, s[8:11], s50 offen offset:0
buffer_load_dwordx4 v[68:71], v167, s[8:11], s50 offen offset:1024
ds_read_b64_tr_b16 v[40:41], v160 offset:43008
ds_read_b64_tr_b16 v[42:43], v160 offset:44032
s_waitcnt lgkmcnt(10)
v_mfma_f32_32x32x16_bf16 v[16:31], v[52:55], v[104:107], v[16:31]
buffer_load_dwordx4 v[72:75], v167, s[8:11], s50 offen offset:2048
buffer_load_dwordx4 v[76:79], v167, s[8:11], s50 offen offset:3072
buffer_load_dwordx4 v[80:83], v167, s[8:11], s53 offen offset:0
ds_read_b64_tr_b16 v[44:45], v161 offset:43008
ds_read_b64_tr_b16 v[46:47], v161 offset:44032
s_waitcnt lgkmcnt(10)
v_mfma_f32_32x32x16_bf16 v[0:15], v[56:59], v[108:111], v[0:15]
buffer_load_dwordx4 v[84:87], v167, s[8:11], s53 offen offset:1024
buffer_load_dwordx4 v[88:91], v167, s[8:11], s53 offen offset:2048
buffer_load_dwordx4 v[92:95], v167, s[8:11], s53 offen offset:3072
ds_read_b64_tr_b16 v[48:49], v160 offset:45056
ds_read_b64_tr_b16 v[50:51], v160 offset:46080
s_waitcnt lgkmcnt(10)
v_mfma_f32_32x32x16_bf16 v[16:31], v[60:63], v[108:111], v[16:31]
s_add_u32 s50, s50, 57344
s_add_u32 s51, s51, 131072
ds_read_b64_tr_b16 v[52:53], v161 offset:45056
ds_read_b64_tr_b16 v[54:55], v161 offset:46080
s_waitcnt lgkmcnt(10)
v_mfma_f32_32x32x16_bf16 v[0:15], v[32:35], v[112:115], v[0:15]
ds_read_b64_tr_b16 v[56:57], v160 offset:47104
ds_read_b64_tr_b16 v[58:59], v160 offset:48128
s_waitcnt lgkmcnt(10)
v_mfma_f32_32x32x16_bf16 v[16:31], v[36:39], v[112:115], v[16:31]
ds_read_b64_tr_b16 v[60:61], v161 offset:47104
ds_read_b64_tr_b16 v[62:63], v161 offset:48128
s_waitcnt lgkmcnt(10)
v_mfma_f32_32x32x16_bf16 v[0:15], v[40:43], v[116:119], v[0:15]
s_waitcnt vmcnt(12)
s_barrier
ds_read_b64_tr_b16 v[32:33], v160 offset:49152
ds_read_b64_tr_b16 v[34:35], v160 offset:50176
s_waitcnt lgkmcnt(10)
v_mfma_f32_32x32x16_bf16 v[16:31], v[44:47], v[116:119], v[16:31]
ds_read_b64_tr_b16 v[36:37], v161 offset:49152
ds_read_b64_tr_b16 v[38:39], v161 offset:50176
s_waitcnt lgkmcnt(10)
v_mfma_f32_32x32x16_bf16 v[0:15], v[48:51], v[120:123], v[0:15]
ds_read_b64_tr_b16 v[40:41], v160 offset:51200
ds_read_b64_tr_b16 v[42:43], v160 offset:52224
s_waitcnt lgkmcnt(10)
v_mfma_f32_32x32x16_bf16 v[16:31], v[52:55], v[120:123], v[16:31]
ds_read_b64_tr_b16 v[44:45], v161 offset:51200
ds_read_b64_tr_b16 v[46:47], v161 offset:52224
s_waitcnt lgkmcnt(10)
v_mfma_f32_32x32x16_bf16 v[0:15], v[56:59], v[124:127], v[0:15]
ds_read_b64_tr_b16 v[48:49], v160 offset:53248
ds_read_b64_tr_b16 v[50:51], v160 offset:54272
s_waitcnt lgkmcnt(10)
v_mfma_f32_32x32x16_bf16 v[16:31], v[60:63], v[124:127], v[16:31]
ds_read_b64_tr_b16 v[52:53], v161 offset:53248
ds_read_b64_tr_b16 v[54:55], v161 offset:54272
s_waitcnt lgkmcnt(10)
v_mfma_f32_32x32x16_bf16 v[0:15], v[32:35], v[128:131], v[0:15]
s_add_u32 m0, s30, 81920
s_add_u32 s52, s51, 0
buffer_load_dwordx4 v166, s[12:15], s52 offen lds
ds_read_b64_tr_b16 v[56:57], v160 offset:55296
ds_read_b64_tr_b16 v[58:59], v160 offset:56320
s_waitcnt lgkmcnt(10)
v_mfma_f32_32x32x16_bf16 v[16:31], v[36:39], v[128:131], v[16:31]
s_add_u32 m0, s30, 82944
s_add_u32 s52, s51, 8192
buffer_load_dwordx4 v166, s[12:15], s52 offen lds
ds_read_b64_tr_b16 v[60:61], v161 offset:55296
ds_read_b64_tr_b16 v[62:63], v161 offset:56320
s_waitcnt lgkmcnt(10)
v_mfma_f32_32x32x16_bf16 v[0:15], v[40:43], v[132:135], v[0:15]
s_add_u32 m0, s30, 83968
s_add_u32 s52, s51, 16384
buffer_load_dwordx4 v166, s[12:15], s52 offen lds
ds_read_b64_tr_b16 v[32:33], v160 offset:57344
ds_read_b64_tr_b16 v[34:35], v160 offset:58368
s_waitcnt lgkmcnt(10)
v_mfma_f32_32x32x16_bf16 v[16:31], v[44:47], v[132:135], v[16:31]
s_add_u32 m0, s30, 84992
s_add_u32 s52, s51, 24576
buffer_load_dwordx4 v166, s[12:15], s52 offen lds
ds_read_b64_tr_b16 v[36:37], v161 offset:57344
ds_read_b64_tr_b16 v[38:39], v161 offset:58368
s_waitcnt lgkmcnt(10)
v_mfma_f32_32x32x16_bf16 v[0:15], v[48:51], v[136:139], v[0:15]
s_add_u32 s53, s50, 4096
buffer_load_dwordx4 v[96:99], v167, s[8:11], s50 offen offset:0
buffer_load_dwordx4 v[100:103], v167, s[8:11], s50 offen offset:1024
ds_read_b64_tr_b16 v[40:41], v160 offset:59392
ds_read_b64_tr_b16 v[42:43], v160 offset:60416
s_waitcnt lgkmcnt(10)
v_mfma_f32_32x32x16_bf16 v[16:31], v[52:55], v[136:139], v[16:31]
buffer_load_dwordx4 v[104:107], v167, s[8:11], s50 offen offset:2048
buffer_load_dwordx4 v[108:111], v167, s[8:11], s50 offen offset:3072
buffer_load_dwordx4 v[112:115], v167, s[8:11], s53 offen offset:0
ds_read_b64_tr_b16 v[44:45], v161 offset:59392
ds_read_b64_tr_b16 v[46:47], v161 offset:60416
s_waitcnt lgkmcnt(10)
v_mfma_f32_32x32x16_bf16 v[0:15], v[56:59], v[140:143], v[0:15]
buffer_load_dwordx4 v[116:119], v167, s[8:11], s53 offen offset:1024
buffer_load_dwordx4 v[120:123], v167, s[8:11], s53 offen offset:2048
buffer_load_dwordx4 v[124:127], v167, s[8:11], s53 offen offset:3072
ds_read_b64_tr_b16 v[48:49], v160 offset:61440
ds_read_b64_tr_b16 v[50:51], v160 offset:62464
s_waitcnt lgkmcnt(10)
v_mfma_f32_32x32x16_bf16 v[16:31], v[60:63], v[140:143], v[16:31]
s_add_u32 s50, s50, 57344
s_add_u32 s51, s51, 131072
ds_read_b64_tr_b16 v[52:53], v161 offset:61440
ds_read_b64_tr_b16 v[54:55], v161 offset:62464
s_waitcnt lgkmcnt(10)
v_mfma_f32_32x32x16_bf16 v[0:15], v[32:35], v[144:147], v[0:15]
ds_read_b64_tr_b16 v[56:57], v160 offset:63488
ds_read_b64_tr_b16 v[58:59], v160 offset:64512
s_waitcnt lgkmcnt(10)
v_mfma_f32_32x32x16_bf16 v[16:31], v[36:39], v[144:147], v[16:31]
ds_read_b64_tr_b16 v[60:61], v161 offset:63488
ds_read_b64_tr_b16 v[62:63], v161 offset:64512
s_waitcnt lgkmcnt(10)
v_mfma_f32_32x32x16_bf16 v[0:15], v[40:43], v[148:151], v[0:15]
s_waitcnt vmcnt(12)
s_barrier
ds_read_b64_tr_b16 v[32:33], v162 offset:0
ds_read_b64_tr_b16 v[34:35], v162 offset:1024
s_waitcnt lgkmcnt(10)
v_mfma_f32_32x32x16_bf16 v[16:31], v[44:47], v[148:151], v[16:31]
ds_read_b64_tr_b16 v[36:37], v163 offset:0
ds_read_b64_tr_b16 v[38:39], v163 offset:1024
s_waitcnt lgkmcnt(10)
v_mfma_f32_32x32x16_bf16 v[0:15], v[48:51], v[152:155], v[0:15]
ds_read_b64_tr_b16 v[40:41], v162 offset:2048
ds_read_b64_tr_b16 v[42:43], v162 offset:3072
s_waitcnt lgkmcnt(10)
v_mfma_f32_32x32x16_bf16 v[16:31], v[52:55], v[152:155], v[16:31]
ds_read_b64_tr_b16 v[44:45], v163 offset:2048
ds_read_b64_tr_b16 v[46:47], v163 offset:3072
s_waitcnt lgkmcnt(10)
v_mfma_f32_32x32x16_bf16 v[0:15], v[56:59], v[156:159], v[0:15]
ds_read_b64_tr_b16 v[48:49], v162 offset:4096
ds_read_b64_tr_b16 v[50:51], v162 offset:5120
s_waitcnt lgkmcnt(10)
v_mfma_f32_32x32x16_bf16 v[16:31], v[60:63], v[156:159], v[16:31]
ds_read_b64_tr_b16 v[52:53], v163 offset:4096
ds_read_b64_tr_b16 v[54:55], v163 offset:5120
s_waitcnt lgkmcnt(10)
v_mfma_f32_32x32x16_bf16 v[0:15], v[32:35], v[64:67], v[0:15]
s_add_u32 m0, s30, 98304
s_add_u32 s52, s51, 0
buffer_load_dwordx4 v166, s[12:15], s52 offen lds
ds_read_b64_tr_b16 v[56:57], v162 offset:6144
ds_read_b64_tr_b16 v[58:59], v162 offset:7168
s_waitcnt lgkmcnt(10)
v_mfma_f32_32x32x16_bf16 v[16:31], v[36:39], v[64:67], v[16:31]
s_add_u32 m0, s30, 99328
s_add_u32 s52, s51, 8192
buffer_load_dwordx4 v166, s[12:15], s52 offen lds
ds_read_b64_tr_b16 v[60:61], v163 offset:6144
ds_read_b64_tr_b16 v[62:63], v163 offset:7168
s_waitcnt lgkmcnt(10)
v_mfma_f32_32x32x16_bf16 v[0:15], v[40:43], v[68:71], v[0:15]
s_add_u32 m0, s30, 100352
s_add_u32 s52, s51, 16384
buffer_load_dwordx4 v166, s[12:15], s52 offen lds
ds_read_b64_tr_b16 v[32:33], v162 offset:8192
ds_read_b64_tr_b16 v[34:35], v162 offset:9216
s_waitcnt lgkmcnt(10)
v_mfma_f32_32x32x16_bf16 v[16:31], v[44:47], v[68:71], v[16:31]
s_add_u32 m0, s30, 101376
s_add_u32 s52, s51, 24576
buffer_load_dwordx4 v166, s[12:15], s52 offen lds
ds_read_b64_tr_b16 v[36:37], v163 offset:8192
ds_read_b64_tr_b16 v[38:39], v163 offset:9216
s_waitcnt lgkmcnt(10)
v_mfma_f32_32x32x16_bf16 v[0:15], v[48:51], v[72:75], v[0:15]
s_add_u32 s53, s50, 4096
buffer_load_dwordx4 v[128:131], v167, s[8:11], s50 offen offset:0
buffer_load_dwordx4 v[132:135], v167, s[8:11], s50 offen offset:1024
ds_read_b64_tr_b16 v[40:41], v162 offset:10240
ds_read_b64_tr_b16 v[42:43], v162 offset:11264
s_waitcnt lgkmcnt(10)
v_mfma_f32_32x32x16_bf16 v[16:31], v[52:55], v[72:75], v[16:31]
buffer_load_dwordx4 v[136:139], v167, s[8:11], s50 offen offset:2048
buffer_load_dwordx4 v[140:143], v167, s[8:11], s50 offen offset:3072
buffer_load_dwordx4 v[144:147], v167, s[8:11], s53 offen offset:0
ds_read_b64_tr_b16 v[44:45], v163 offset:10240
ds_read_b64_tr_b16 v[46:47], v163 offset:11264
s_waitcnt lgkmcnt(10)
v_mfma_f32_32x32x16_bf16 v[0:15], v[56:59], v[76:79], v[0:15]
buffer_load_dwordx4 v[148:151], v167, s[8:11], s53 offen offset:1024
buffer_load_dwordx4 v[152:155], v167, s[8:11], s53 offen offset:2048
buffer_load_dwordx4 v[156:159], v167, s[8:11], s53 offen offset:3072
ds_read_b64_tr_b16 v[48:49], v162 offset:12288
ds_read_b64_tr_b16 v[50:51], v162 offset:13312
s_waitcnt lgkmcnt(10)
v_mfma_f32_32x32x16_bf16 v[16:31], v[60:63], v[76:79], v[16:31]
s_add_u32 s50, s50, 57344
s_add_u32 s51, s51, 131072
ds_read_b64_tr_b16 v[52:53], v163 offset:12288
ds_read_b64_tr_b16 v[54:55], v163 offset:13312
s_waitcnt lgkmcnt(10)
v_mfma_f32_32x32x16_bf16 v[0:15], v[32:35], v[80:83], v[0:15]
ds_read_b64_tr_b16 v[56:57], v162 offset:14336
ds_read_b64_tr_b16 v[58:59], v162 offset:15360
s_waitcnt lgkmcnt(10)
v_mfma_f32_32x32x16_bf16 v[16:31], v[36:39], v[80:83], v[16:31]
ds_read_b64_tr_b16 v[60:61], v163 offset:14336
ds_read_b64_tr_b16 v[62:63], v163 offset:15360
s_waitcnt lgkmcnt(10)
v_mfma_f32_32x32x16_bf16 v[0:15], v[40:43], v[84:87], v[0:15]
s_waitcnt vmcnt(12)
s_barrier
ds_read_b64_tr_b16 v[32:33], v162 offset:16384
ds_read_b64_tr_b16 v[34:35], v162 offset:17408
s_waitcnt lgkmcnt(10)
v_mfma_f32_32x32x16_bf16 v[16:31], v[44:47], v[84:87], v[16:31]
ds_read_b64_tr_b16 v[36:37], v163 offset:16384
ds_read_b64_tr_b16 v[38:39], v163 offset:17408
s_waitcnt lgkmcnt(10)
v_mfma_f32_32x32x16_bf16 v[0:15], v[48:51], v[88:91], v[0:15]
ds_read_b64_tr_b16 v[40:41], v162 offset:18432
ds_read_b64_tr_b16 v[42:43], v162 offset:19456
s_waitcnt lgkmcnt(10)
v_mfma_f32_32x32x16_bf16 v[16:31], v[52:55], v[88:91], v[16:31]
ds_read_b64_tr_b16 v[44:45], v163 offset:18432
ds_read_b64_tr_b16 v[46:47], v163 offset:19456
s_waitcnt lgkmcnt(10)
v_mfma_f32_32x32x16_bf16 v[0:15], v[56:59], v[92:95], v[0:15]
ds_read_b64_tr_b16 v[48:49], v162 offset:20480
ds_read_b64_tr_b16 v[50:51], v162 offset:21504
s_waitcnt lgkmcnt(10)
v_mfma_f32_32x32x16_bf16 v[16:31], v[60:63], v[92:95], v[16:31]
ds_read_b64_tr_b16 v[52:53], v163 offset:20480
ds_read_b64_tr_b16 v[54:55], v163 offset:21504
s_waitcnt lgkmcnt(10)
v_mfma_f32_32x32x16_bf16 v[0:15], v[32:35], v[96:99], v[0:15]
s_add_u32 m0, s30, 114688
s_add_u32 s52, s51, 0
buffer_load_dwordx4 v166, s[12:15], s52 offen lds
ds_read_b64_tr_b16 v[56:57], v162 offset:22528
ds_read_b64_tr_b16 v[58:59], v162 offset:23552
s_waitcnt lgkmcnt(10)
v_mfma_f32_32x32x16_bf16 v[16:31], v[36:39], v[96:99], v[16:31]
s_add_u32 m0, s30, 115712
s_add_u32 s52, s51, 8192
buffer_load_dwordx4 v166, s[12:15], s52 offen lds
ds_read_b64_tr_b16 v[60:61], v163 offset:22528
ds_read_b64_tr_b16 v[62:63], v163 offset:23552
s_waitcnt lgkmcnt(10)
v_mfma_f32_32x32x16_bf16 v[0:15], v[40:43], v[100:103], v[0:15]
s_add_u32 m0, s30, 116736
s_add_u32 s52, s51, 16384
buffer_load_dwordx4 v166, s[12:15], s52 offen lds
ds_read_b64_tr_b16 v[32:33], v162 offset:24576
ds_read_b64_tr_b16 v[34:35], v162 offset:25600
s_waitcnt lgkmcnt(10)
v_mfma_f32_32x32x16_bf16 v[16:31], v[44:47], v[100:103], v[16:31]
s_add_u32 m0, s30, 117760
s_add_u32 s52, s51, 24576
buffer_load_dwordx4 v166, s[12:15], s52 offen lds
ds_read_b64_tr_b16 v[36:37], v163 offset:24576
ds_read_b64_tr_b16 v[38:39], v163 offset:25600
s_waitcnt lgkmcnt(10)
v_mfma_f32_32x32x16_bf16 v[0:15], v[48:51], v[104:107], v[0:15]
s_add_u32 s53, s50, 4096
buffer_load_dwordx4 v[64:67], v167, s[8:11], s50 offen offset:0
buffer_load_dwordx4 v[68:71], v167, s[8:11], s50 offen offset:1024
ds_read_b64_tr_b16 v[40:41], v162 offset:26624
ds_read_b64_tr_b16 v[42:43], v162 offset:27648
s_waitcnt lgkmcnt(10)
v_mfma_f32_32x32x16_bf16 v[16:31], v[52:55], v[104:107], v[16:31]
buffer_load_dwordx4 v[72:75], v167, s[8:11], s50 offen offset:2048
buffer_load_dwordx4 v[76:79], v167, s[8:11], s50 offen offset:3072
buffer_load_dwordx4 v[80:83], v167, s[8:11], s53 offen offset:0
ds_read_b64_tr_b16 v[44:45], v163 offset:26624
ds_read_b64_tr_b16 v[46:47], v163 offset:27648
s_waitcnt lgkmcnt(10)
v_mfma_f32_32x32x16_bf16 v[0:15], v[56:59], v[108:111], v[0:15]
buffer_load_dwordx4 v[84:87], v167, s[8:11], s53 offen offset:1024
buffer_load_dwordx4 v[88:91], v167, s[8:11], s53 offen offset:2048
buffer_load_dwordx4 v[92:95], v167, s[8:11], s53 offen offset:3072
ds_read_b64_tr_b16 v[48:49], v162 offset:28672
ds_read_b64_tr_b16 v[50:51], v162 offset:29696
s_waitcnt lgkmcnt(10)
v_mfma_f32_32x32x16_bf16 v[16:31], v[60:63], v[108:111], v[16:31]
s_add_u32 s50, s50, 57344
s_add_u32 s51, s51, 131072
ds_read_b64_tr_b16 v[52:53], v163 offset:28672
ds_read_b64_tr_b16 v[54:55], v163 offset:29696
s_waitcnt lgkmcnt(10)
v_mfma_f32_32x32x16_bf16 v[0:15], v[32:35], v[112:115], v[0:15]
ds_read_b64_tr_b16 v[56:57], v162 offset:30720
ds_read_b64_tr_b16 v[58:59], v162 offset:31744
s_waitcnt lgkmcnt(10)
v_mfma_f32_32x32x16_bf16 v[16:31], v[36:39], v[112:115], v[16:31]
ds_read_b64_tr_b16 v[60:61], v163 offset:30720
ds_read_b64_tr_b16 v[62:63], v163 offset:31744
s_waitcnt lgkmcnt(10)
v_mfma_f32_32x32x16_bf16 v[0:15], v[40:43], v[116:119], v[0:15]
s_waitcnt vmcnt(12)
s_barrier
ds_read_b64_tr_b16 v[32:33], v162 offset:32768
ds_read_b64_tr_b16 v[34:35], v162 offset:33792
s_waitcnt lgkmcnt(10)
v_mfma_f32_32x32x16_bf16 v[16:31], v[44:47], v[116:119], v[16:31]
ds_read_b64_tr_b16 v[36:37], v163 offset:32768
ds_read_b64_tr_b16 v[38:39], v163 offset:33792
s_waitcnt lgkmcnt(10)
v_mfma_f32_32x32x16_bf16 v[0:15], v[48:51], v[120:123], v[0:15]
ds_read_b64_tr_b16 v[40:41], v162 offset:34816
ds_read_b64_tr_b16 v[42:43], v162 offset:35840
s_waitcnt lgkmcnt(10)
v_mfma_f32_32x32x16_bf16 v[16:31], v[52:55], v[120:123], v[16:31]
ds_read_b64_tr_b16 v[44:45], v163 offset:34816
ds_read_b64_tr_b16 v[46:47], v163 offset:35840
s_waitcnt lgkmcnt(10)
v_mfma_f32_32x32x16_bf16 v[0:15], v[56:59], v[124:127], v[0:15]
ds_read_b64_tr_b16 v[48:49], v162 offset:36864
ds_read_b64_tr_b16 v[50:51], v162 offset:37888
s_waitcnt lgkmcnt(10)
v_mfma_f32_32x32x16_bf16 v[16:31], v[60:63], v[124:127], v[16:31]
ds_read_b64_tr_b16 v[52:53], v163 offset:36864
ds_read_b64_tr_b16 v[54:55], v163 offset:37888
s_waitcnt lgkmcnt(10)
v_mfma_f32_32x32x16_bf16 v[0:15], v[32:35], v[128:131], v[0:15]
s_add_u32 m0, s30, 0
s_add_u32 s52, s51, 0
buffer_load_dwordx4 v166, s[12:15], s52 offen lds
ds_read_b64_tr_b16 v[56:57], v162 offset:38912
ds_read_b64_tr_b16 v[58:59], v162 offset:39936
s_waitcnt lgkmcnt(10)
v_mfma_f32_32x32x16_bf16 v[16:31], v[36:39], v[128:131], v[16:31]
s_add_u32 m0, s30, 1024
s_add_u32 s52, s51, 8192
buffer_load_dwordx4 v166, s[12:15], s52 offen lds
ds_read_b64_tr_b16 v[60:61], v163 offset:38912
ds_read_b64_tr_b16 v[62:63], v163 offset:39936
s_waitcnt lgkmcnt(10)
v_mfma_f32_32x32x16_bf16 v[0:15], v[40:43], v[132:135], v[0:15]
s_add_u32 m0, s30, 2048
s_add_u32 s52, s51, 16384
buffer_load_dwordx4 v166, s[12:15], s52 offen lds
ds_read_b64_tr_b16 v[32:33], v162 offset:40960
ds_read_b64_tr_b16 v[34:35], v162 offset:41984
s_waitcnt lgkmcnt(10)
v_mfma_f32_32x32x16_bf16 v[16:31], v[44:47], v[132:135], v[16:31]
s_add_u32 m0, s30, 3072
s_add_u32 s52, s51, 24576
buffer_load_dwordx4 v166, s[12:15], s52 offen lds
ds_read_b64_tr_b16 v[36:37], v163 offset:40960
ds_read_b64_tr_b16 v[38:39], v163 offset:41984
s_waitcnt lgkmcnt(10)
v_mfma_f32_32x32x16_bf16 v[0:15], v[48:51], v[136:139], v[0:15]
s_add_u32 s53, s50, 4096
buffer_load_dwordx4 v[96:99], v167, s[8:11], s50 offen offset:0
buffer_load_dwordx4 v[100:103], v167, s[8:11], s50 offen offset:1024
ds_read_b64_tr_b16 v[40:41], v162 offset:43008
ds_read_b64_tr_b16 v[42:43], v162 offset:44032
s_waitcnt lgkmcnt(10)
v_mfma_f32_32x32x16_bf16 v[16:31], v[52:55], v[136:139], v[16:31]
buffer_load_dwordx4 v[104:107], v167, s[8:11], s50 offen offset:2048
buffer_load_dwordx4 v[108:111], v167, s[8:11], s50 offen offset:3072
buffer_load_dwordx4 v[112:115], v167, s[8:11], s53 offen offset:0
ds_read_b64_tr_b16 v[44:45], v163 offset:43008
ds_read_b64_tr_b16 v[46:47], v163 offset:44032
s_waitcnt lgkmcnt(10)
v_mfma_f32_32x32x16_bf16 v[0:15], v[56:59], v[140:143], v[0:15]
buffer_load_dwordx4 v[116:119], v167, s[8:11], s53 offen offset:1024
buffer_load_dwordx4 v[120:123], v167, s[8:11], s53 offen offset:2048
buffer_load_dwordx4 v[124:127], v167, s[8:11], s53 offen offset:3072
ds_read_b64_tr_b16 v[48:49], v162 offset:45056
ds_read_b64_tr_b16 v[50:51], v162 offset:46080
s_waitcnt lgkmcnt(10)
v_mfma_f32_32x32x16_bf16 v[16:31], v[60:63], v[140:143], v[16:31]
s_add_u32 s50, s50, 57344
s_add_u32 s51, s51, 131072
ds_read_b64_tr_b16 v[52:53], v163 offset:45056
ds_read_b64_tr_b16 v[54:55], v163 offset:46080
s_waitcnt lgkmcnt(10)
v_mfma_f32_32x32x16_bf16 v[0:15], v[32:35], v[144:147], v[0:15]
ds_read_b64_tr_b16 v[56:57], v162 offset:47104
ds_read_b64_tr_b16 v[58:59], v162 offset:48128
s_waitcnt lgkmcnt(10)
v_mfma_f32_32x32x16_bf16 v[16:31], v[36:39], v[144:147], v[16:31]
ds_read_b64_tr_b16 v[60:61], v163 offset:47104
ds_read_b64_tr_b16 v[62:63], v163 offset:48128
s_waitcnt lgkmcnt(10)
v_mfma_f32_32x32x16_bf16 v[0:15], v[40:43], v[148:151], v[0:15]
s_waitcnt vmcnt(12)
s_barrier
ds_read_b64_tr_b16 v[32:33], v162 offset:49152
ds_read_b64_tr_b16 v[34:35], v162 offset:50176
s_waitcnt lgkmcnt(10)
v_mfma_f32_32x32x16_bf16 v[16:31], v[44:47], v[148:151], v[16:31]
ds_read_b64_tr_b16 v[36:37], v163 offset:49152
ds_read_b64_tr_b16 v[38:39], v163 offset:50176
s_waitcnt lgkmcnt(10)
v_mfma_f32_32x32x16_bf16 v[0:15], v[48:51], v[152:155], v[0:15]
ds_read_b64_tr_b16 v[40:41], v162 offset:51200
ds_read_b64_tr_b16 v[42:43], v162 offset:52224
s_waitcnt lgkmcnt(10)
v_mfma_f32_32x32x16_bf16 v[16:31], v[52:55], v[152:155], v[16:31]
ds_read_b64_tr_b16 v[44:45], v163 offset:51200
ds_read_b64_tr_b16 v[46:47], v163 offset:52224
s_waitcnt lgkmcnt(10)
v_mfma_f32_32x32x16_bf16 v[0:15], v[56:59], v[156:159], v[0:15]
ds_read_b64_tr_b16 v[48:49], v162 offset:53248
ds_read_b64_tr_b16 v[50:51], v162 offset:54272
s_waitcnt lgkmcnt(10)
v_mfma_f32_32x32x16_bf16 v[16:31], v[60:63], v[156:159], v[16:31]
ds_read_b64_tr_b16 v[52:53], v163 offset:53248
ds_read_b64_tr_b16 v[54:55], v163 offset:54272
s_waitcnt lgkmcnt(10)
v_mfma_f32_32x32x16_bf16 v[0:15], v[32:35], v[64:67], v[0:15]
s_add_u32 m0, s30, 16384
s_add_u32 s52, s51, 0
buffer_load_dwordx4 v166, s[12:15], s52 offen lds
ds_read_b64_tr_b16 v[56:57], v162 offset:55296
ds_read_b64_tr_b16 v[58:59], v162 offset:56320
s_waitcnt lgkmcnt(10)
v_mfma_f32_32x32x16_bf16 v[16:31], v[36:39], v[64:67], v[16:31]
s_add_u32 m0, s30, 17408
s_add_u32 s52, s51, 8192
buffer_load_dwordx4 v166, s[12:15], s52 offen lds
ds_read_b64_tr_b16 v[60:61], v163 offset:55296
ds_read_b64_tr_b16 v[62:63], v163 offset:56320
s_waitcnt lgkmcnt(10)
v_mfma_f32_32x32x16_bf16 v[0:15], v[40:43], v[68:71], v[0:15]
s_add_u32 m0, s30, 18432
s_add_u32 s52, s51, 16384
buffer_load_dwordx4 v166, s[12:15], s52 offen lds
ds_read_b64_tr_b16 v[32:33], v162 offset:57344
ds_read_b64_tr_b16 v[34:35], v162 offset:58368
s_waitcnt lgkmcnt(10)
v_mfma_f32_32x32x16_bf16 v[16:31], v[44:47], v[68:71], v[16:31]
s_add_u32 m0, s30, 19456
s_add_u32 s52, s51, 24576
buffer_load_dwordx4 v166, s[12:15], s52 offen lds
ds_read_b64_tr_b16 v[36:37], v163 offset:57344
ds_read_b64_tr_b16 v[38:39], v163 offset:58368
s_waitcnt lgkmcnt(10)
v_mfma_f32_32x32x16_bf16 v[0:15], v[48:51], v[72:75], v[0:15]
s_add_u32 s53, s50, 4096
buffer_load_dwordx4 v[128:131], v167, s[8:11], s50 offen offset:0
buffer_load_dwordx4 v[132:135], v167, s[8:11], s50 offen offset:1024
ds_read_b64_tr_b16 v[40:41], v162 offset:59392
ds_read_b64_tr_b16 v[42:43], v162 offset:60416
s_waitcnt lgkmcnt(10)
v_mfma_f32_32x32x16_bf16 v[16:31], v[52:55], v[72:75], v[16:31]
buffer_load_dwordx4 v[136:139], v167, s[8:11], s50 offen offset:2048
buffer_load_dwordx4 v[140:143], v167, s[8:11], s50 offen offset:3072
buffer_load_dwordx4 v[144:147], v167, s[8:11], s53 offen offset:0
ds_read_b64_tr_b16 v[44:45], v163 offset:59392
ds_read_b64_tr_b16 v[46:47], v163 offset:60416
s_waitcnt lgkmcnt(10)
v_mfma_f32_32x32x16_bf16 v[0:15], v[56:59], v[76:79], v[0:15]
buffer_load_dwordx4 v[148:151], v167, s[8:11], s53 offen offset:1024
buffer_load_dwordx4 v[152:155], v167, s[8:11], s53 offen offset:2048
buffer_load_dwordx4 v[156:159], v167, s[8:11], s53 offen offset:3072
ds_read_b64_tr_b16 v[48:49], v162 offset:61440
ds_read_b64_tr_b16 v[50:51], v162 offset:62464
s_waitcnt lgkmcnt(10)
v_mfma_f32_32x32x16_bf16 v[16:31], v[60:63], v[76:79], v[16:31]
s_add_u32 s50, s50, 57344
s_add_u32 s51, s51, 131072
ds_read_b64_tr_b16 v[52:53], v163 offset:61440
ds_read_b64_tr_b16 v[54:55], v163 offset:62464
s_waitcnt lgkmcnt(10)
v_mfma_f32_32x32x16_bf16 v[0:15], v[32:35], v[80:83], v[0:15]
ds_read_b64_tr_b16 v[56:57], v162 offset:63488
ds_read_b64_tr_b16 v[58:59], v162 offset:64512
s_waitcnt lgkmcnt(10)
v_mfma_f32_32x32x16_bf16 v[16:31], v[36:39], v[80:83], v[16:31]
ds_read_b64_tr_b16 v[60:61], v163 offset:63488
ds_read_b64_tr_b16 v[62:63], v163 offset:64512
s_waitcnt lgkmcnt(10)
v_mfma_f32_32x32x16_bf16 v[0:15], v[40:43], v[84:87], v[0:15]
s_waitcnt vmcnt(12)
s_barrier
ds_read_b64_tr_b16 v[32:33], v160 offset:0
ds_read_b64_tr_b16 v[34:35], v160 offset:1024
s_waitcnt lgkmcnt(10)
v_mfma_f32_32x32x16_bf16 v[16:31], v[44:47], v[84:87], v[16:31]
ds_read_b64_tr_b16 v[36:37], v161 offset:0
ds_read_b64_tr_b16 v[38:39], v161 offset:1024
s_waitcnt lgkmcnt(10)
v_mfma_f32_32x32x16_bf16 v[0:15], v[48:51], v[88:91], v[0:15]
ds_read_b64_tr_b16 v[40:41], v160 offset:2048
ds_read_b64_tr_b16 v[42:43], v160 offset:3072
s_waitcnt lgkmcnt(10)
v_mfma_f32_32x32x16_bf16 v[16:31], v[52:55], v[88:91], v[16:31]
ds_read_b64_tr_b16 v[44:45], v161 offset:2048
ds_read_b64_tr_b16 v[46:47], v161 offset:3072
s_waitcnt lgkmcnt(10)
v_mfma_f32_32x32x16_bf16 v[0:15], v[56:59], v[92:95], v[0:15]
ds_read_b64_tr_b16 v[48:49], v160 offset:4096
ds_read_b64_tr_b16 v[50:51], v160 offset:5120
s_waitcnt lgkmcnt(10)
v_mfma_f32_32x32x16_bf16 v[16:31], v[60:63], v[92:95], v[16:31]
ds_read_b64_tr_b16 v[52:53], v161 offset:4096
ds_read_b64_tr_b16 v[54:55], v161 offset:5120
s_waitcnt lgkmcnt(10)
v_mfma_f32_32x32x16_bf16 v[0:15], v[32:35], v[96:99], v[0:15]
s_add_u32 m0, s30, 32768
s_add_u32 s52, s51, 0
buffer_load_dwordx4 v166, s[12:15], s52 offen lds
ds_read_b64_tr_b16 v[56:57], v160 offset:6144
ds_read_b64_tr_b16 v[58:59], v160 offset:7168
s_waitcnt lgkmcnt(10)
v_mfma_f32_32x32x16_bf16 v[16:31], v[36:39], v[96:99], v[16:31]
s_add_u32 m0, s30, 33792
s_add_u32 s52, s51, 8192
buffer_load_dwordx4 v166, s[12:15], s52 offen lds
ds_read_b64_tr_b16 v[60:61], v161 offset:6144
ds_read_b64_tr_b16 v[62:63], v161 offset:7168
s_waitcnt lgkmcnt(10)
v_mfma_f32_32x32x16_bf16 v[0:15], v[40:43], v[100:103], v[0:15]
s_add_u32 m0, s30, 34816
s_add_u32 s52, s51, 16384
buffer_load_dwordx4 v166, s[12:15], s52 offen lds
ds_read_b64_tr_b16 v[32:33], v160 offset:8192
ds_read_b64_tr_b16 v[34:35], v160 offset:9216
s_waitcnt lgkmcnt(10)
v_mfma_f32_32x32x16_bf16 v[16:31], v[44:47], v[100:103], v[16:31]
s_add_u32 m0, s30, 35840
s_add_u32 s52, s51, 24576
buffer_load_dwordx4 v166, s[12:15], s52 offen lds
ds_read_b64_tr_b16 v[36:37], v161 offset:8192
ds_read_b64_tr_b16 v[38:39], v161 offset:9216
s_waitcnt lgkmcnt(10)
v_mfma_f32_32x32x16_bf16 v[0:15], v[48:51], v[104:107], v[0:15]
s_add_u32 s53, s50, 4096
buffer_load_dwordx4 v[64:67], v167, s[8:11], s50 offen offset:0
buffer_load_dwordx4 v[68:71], v167, s[8:11], s50 offen offset:1024
ds_read_b64_tr_b16 v[40:41], v160 offset:10240
ds_read_b64_tr_b16 v[42:43], v160 offset:11264
s_waitcnt lgkmcnt(10)
v_mfma_f32_32x32x16_bf16 v[16:31], v[52:55], v[104:107], v[16:31]
buffer_load_dwordx4 v[72:75], v167, s[8:11], s50 offen offset:2048
buffer_load_dwordx4 v[76:79], v167, s[8:11], s50 offen offset:3072
buffer_load_dwordx4 v[80:83], v167, s[8:11], s53 offen offset:0
ds_read_b64_tr_b16 v[44:45], v161 offset:10240
ds_read_b64_tr_b16 v[46:47], v161 offset:11264
s_waitcnt lgkmcnt(10)
v_mfma_f32_32x32x16_bf16 v[0:15], v[56:59], v[108:111], v[0:15]
buffer_load_dwordx4 v[84:87], v167, s[8:11], s53 offen offset:1024
buffer_load_dwordx4 v[88:91], v167, s[8:11], s53 offen offset:2048
buffer_load_dwordx4 v[92:95], v167, s[8:11], s53 offen offset:3072
ds_read_b64_tr_b16 v[48:49], v160 offset:12288
ds_read_b64_tr_b16 v[50:51], v160 offset:13312
s_waitcnt lgkmcnt(10)
v_mfma_f32_32x32x16_bf16 v[16:31], v[60:63], v[108:111], v[16:31]
s_add_u32 s50, s50, 57344
s_add_u32 s51, s51, 131072
ds_read_b64_tr_b16 v[52:53], v161 offset:12288
ds_read_b64_tr_b16 v[54:55], v161 offset:13312
s_waitcnt lgkmcnt(10)
v_mfma_f32_32x32x16_bf16 v[0:15], v[32:35], v[112:115], v[0:15]
ds_read_b64_tr_b16 v[56:57], v160 offset:14336
ds_read_b64_tr_b16 v[58:59], v160 offset:15360
s_waitcnt lgkmcnt(10)
v_mfma_f32_32x32x16_bf16 v[16:31], v[36:39], v[112:115], v[16:31]
ds_read_b64_tr_b16 v[60:61], v161 offset:14336
ds_read_b64_tr_b16 v[62:63], v161 offset:15360
s_waitcnt lgkmcnt(10)
v_mfma_f32_32x32x16_bf16 v[0:15], v[40:43], v[116:119], v[0:15]
s_waitcnt vmcnt(12)
s_barrier
ds_read_b64_tr_b16 v[32:33], v160 offset:16384
ds_read_b64_tr_b16 v[34:35], v160 offset:17408
s_waitcnt lgkmcnt(10)
v_mfma_f32_32x32x16_bf16 v[16:31], v[44:47], v[116:119], v[16:31]
ds_read_b64_tr_b16 v[36:37], v161 offset:16384
ds_read_b64_tr_b16 v[38:39], v161 offset:17408
s_waitcnt lgkmcnt(10)
v_mfma_f32_32x32x16_bf16 v[0:15], v[48:51], v[120:123], v[0:15]
ds_read_b64_tr_b16 v[40:41], v160 offset:18432
ds_read_b64_tr_b16 v[42:43], v160 offset:19456
s_waitcnt lgkmcnt(10)
v_mfma_f32_32x32x16_bf16 v[16:31], v[52:55], v[120:123], v[16:31]
ds_read_b64_tr_b16 v[44:45], v161 offset:18432
ds_read_b64_tr_b16 v[46:47], v161 offset:19456
s_waitcnt lgkmcnt(10)
v_mfma_f32_32x32x16_bf16 v[0:15], v[56:59], v[124:127], v[0:15]
ds_read_b64_tr_b16 v[48:49], v160 offset:20480
ds_read_b64_tr_b16 v[50:51], v160 offset:21504
s_waitcnt lgkmcnt(10)
v_mfma_f32_32x32x16_bf16 v[16:31], v[60:63], v[124:127], v[16:31]
ds_read_b64_tr_b16 v[52:53], v161 offset:20480
ds_read_b64_tr_b16 v[54:55], v161 offset:21504
s_waitcnt lgkmcnt(10)
v_mfma_f32_32x32x16_bf16 v[0:15], v[32:35], v[128:131], v[0:15]
s_add_u32 m0, s30, 49152
s_add_u32 s52, s51, 0
buffer_load_dwordx4 v166, s[12:15], s52 offen lds
ds_read_b64_tr_b16 v[56:57], v160 offset:22528
ds_read_b64_tr_b16 v[58:59], v160 offset:23552
s_waitcnt lgkmcnt(10)
v_mfma_f32_32x32x16_bf16 v[16:31], v[36:39], v[128:131], v[16:31]
s_add_u32 m0, s30, 50176
s_add_u32 s52, s51, 8192
buffer_load_dwordx4 v166, s[12:15], s52 offen lds
ds_read_b64_tr_b16 v[60:61], v161 offset:22528
ds_read_b64_tr_b16 v[62:63], v161 offset:23552
s_waitcnt lgkmcnt(10)
v_mfma_f32_32x32x16_bf16 v[0:15], v[40:43], v[132:135], v[0:15]
s_add_u32 m0, s30, 51200
s_add_u32 s52, s51, 16384
buffer_load_dwordx4 v166, s[12:15], s52 offen lds
ds_read_b64_tr_b16 v[32:33], v160 offset:24576
ds_read_b64_tr_b16 v[34:35], v160 offset:25600
s_waitcnt lgkmcnt(10)
v_mfma_f32_32x32x16_bf16 v[16:31], v[44:47], v[132:135], v[16:31]
s_add_u32 m0, s30, 52224
s_add_u32 s52, s51, 24576
buffer_load_dwordx4 v166, s[12:15], s52 offen lds
ds_read_b64_tr_b16 v[36:37], v161 offset:24576
ds_read_b64_tr_b16 v[38:39], v161 offset:25600
s_waitcnt lgkmcnt(10)
v_mfma_f32_32x32x16_bf16 v[0:15], v[48:51], v[136:139], v[0:15]
s_add_u32 s53, s50, 4096
buffer_load_dwordx4 v[96:99], v167, s[8:11], s50 offen offset:0
buffer_load_dwordx4 v[100:103], v167, s[8:11], s50 offen offset:1024
ds_read_b64_tr_b16 v[40:41], v160 offset:26624
ds_read_b64_tr_b16 v[42:43], v160 offset:27648
s_waitcnt lgkmcnt(10)
v_mfma_f32_32x32x16_bf16 v[16:31], v[52:55], v[136:139], v[16:31]
buffer_load_dwordx4 v[104:107], v167, s[8:11], s50 offen offset:2048
buffer_load_dwordx4 v[108:111], v167, s[8:11], s50 offen offset:3072
buffer_load_dwordx4 v[112:115], v167, s[8:11], s53 offen offset:0
ds_read_b64_tr_b16 v[44:45], v161 offset:26624
ds_read_b64_tr_b16 v[46:47], v161 offset:27648
s_waitcnt lgkmcnt(10)
v_mfma_f32_32x32x16_bf16 v[0:15], v[56:59], v[140:143], v[0:15]
buffer_load_dwordx4 v[116:119], v167, s[8:11], s53 offen offset:1024
buffer_load_dwordx4 v[120:123], v167, s[8:11], s53 offen offset:2048
buffer_load_dwordx4 v[124:127], v167, s[8:11], s53 offen offset:3072
ds_read_b64_tr_b16 v[48:49], v160 offset:28672
ds_read_b64_tr_b16 v[50:51], v160 offset:29696
s_waitcnt lgkmcnt(10)
v_mfma_f32_32x32x16_bf16 v[16:31], v[60:63], v[140:143], v[16:31]
s_add_u32 s50, s50, 57344
s_add_u32 s51, s51, 131072
ds_read_b64_tr_b16 v[52:53], v161 offset:28672
ds_read_b64_tr_b16 v[54:55], v161 offset:29696
s_waitcnt lgkmcnt(10)
v_mfma_f32_32x32x16_bf16 v[0:15], v[32:35], v[144:147], v[0:15]
ds_read_b64_tr_b16 v[56:57], v160 offset:30720
ds_read_b64_tr_b16 v[58:59], v160 offset:31744
s_waitcnt lgkmcnt(10)
v_mfma_f32_32x32x16_bf16 v[16:31], v[36:39], v[144:147], v[16:31]
ds_read_b64_tr_b16 v[60:61], v161 offset:30720
ds_read_b64_tr_b16 v[62:63], v161 offset:31744
s_waitcnt lgkmcnt(10)
v_mfma_f32_32x32x16_bf16 v[0:15], v[40:43], v[148:151], v[0:15]
s_waitcnt vmcnt(12)
s_barrier
ds_read_b64_tr_b16 v[32:33], v160 offset:32768
ds_read_b64_tr_b16 v[34:35], v160 offset:33792
s_waitcnt lgkmcnt(10)
v_mfma_f32_32x32x16_bf16 v[16:31], v[44:47], v[148:151], v[16:31]
ds_read_b64_tr_b16 v[36:37], v161 offset:32768
ds_read_b64_tr_b16 v[38:39], v161 offset:33792
s_waitcnt lgkmcnt(10)
v_mfma_f32_32x32x16_bf16 v[0:15], v[48:51], v[152:155], v[0:15]
ds_read_b64_tr_b16 v[40:41], v160 offset:34816
ds_read_b64_tr_b16 v[42:43], v160 offset:35840
s_waitcnt lgkmcnt(10)
v_mfma_f32_32x32x16_bf16 v[16:31], v[52:55], v[152:155], v[16:31]
ds_read_b64_tr_b16 v[44:45], v161 offset:34816
ds_read_b64_tr_b16 v[46:47], v161 offset:35840
s_waitcnt lgkmcnt(10)
v_mfma_f32_32x32x16_bf16 v[0:15], v[56:59], v[156:159], v[0:15]
ds_read_b64_tr_b16 v[48:49], v160 offset:36864
ds_read_b64_tr_b16 v[50:51], v160 offset:37888
s_waitcnt lgkmcnt(10)
v_mfma_f32_32x32x16_bf16 v[16:31], v[60:63], v[156:159], v[16:31]
ds_read_b64_tr_b16 v[52:53], v161 offset:36864
ds_read_b64_tr_b16 v[54:55], v161 offset:37888
s_waitcnt lgkmcnt(10)
v_mfma_f32_32x32x16_bf16 v[0:15], v[32:35], v[64:67], v[0:15]
s_add_u32 m0, s30, 65536
s_add_u32 s52, s51, 0
buffer_load_dwordx4 v166, s[12:15], s52 offen lds
ds_read_b64_tr_b16 v[56:57], v160 offset:38912
ds_read_b64_tr_b16 v[58:59], v160 offset:39936
s_waitcnt lgkmcnt(10)
v_mfma_f32_32x32x16_bf16 v[16:31], v[36:39], v[64:67], v[16:31]
s_add_u32 m0, s30, 66560
s_add_u32 s52, s51, 8192
buffer_load_dwordx4 v166, s[12:15], s52 offen lds
ds_read_b64_tr_b16 v[60:61], v161 offset:38912
ds_read_b64_tr_b16 v[62:63], v161 offset:39936
s_waitcnt lgkmcnt(10)
v_mfma_f32_32x32x16_bf16 v[0:15], v[40:43], v[68:71], v[0:15]
s_add_u32 m0, s30, 67584
s_add_u32 s52, s51, 16384
buffer_load_dwordx4 v166, s[12:15], s52 offen lds
ds_read_b64_tr_b16 v[32:33], v160 offset:40960
ds_read_b64_tr_b16 v[34:35], v160 offset:41984
s_waitcnt lgkmcnt(10)
v_mfma_f32_32x32x16_bf16 v[16:31], v[44:47], v[68:71], v[16:31]
s_add_u32 m0, s30, 68608
s_add_u32 s52, s51, 24576
buffer_load_dwordx4 v166, s[12:15], s52 offen lds
ds_read_b64_tr_b16 v[36:37], v161 offset:40960
ds_read_b64_tr_b16 v[38:39], v161 offset:41984
s_waitcnt lgkmcnt(10)
v_mfma_f32_32x32x16_bf16 v[0:15], v[48:51], v[72:75], v[0:15]
s_add_u32 s53, s50, 4096
buffer_load_dwordx4 v[128:131], v167, s[8:11], s50 offen offset:0
buffer_load_dwordx4 v[132:135], v167, s[8:11], s50 offen offset:1024
ds_read_b64_tr_b16 v[40:41], v160 offset:43008
ds_read_b64_tr_b16 v[42:43], v160 offset:44032
s_waitcnt lgkmcnt(10)
v_mfma_f32_32x32x16_bf16 v[16:31], v[52:55], v[72:75], v[16:31]
buffer_load_dwordx4 v[136:139], v167, s[8:11], s50 offen offset:2048
buffer_load_dwordx4 v[140:143], v167, s[8:11], s50 offen offset:3072
buffer_load_dwordx4 v[144:147], v167, s[8:11], s53 offen offset:0
ds_read_b64_tr_b16 v[44:45], v161 offset:43008
ds_read_b64_tr_b16 v[46:47], v161 offset:44032
s_waitcnt lgkmcnt(10)
v_mfma_f32_32x32x16_bf16 v[0:15], v[56:59], v[76:79], v[0:15]
buffer_load_dwordx4 v[148:151], v167, s[8:11], s53 offen offset:1024
buffer_load_dwordx4 v[152:155], v167, s[8:11], s53 offen offset:2048
buffer_load_dwordx4 v[156:159], v167, s[8:11], s53 offen offset:3072
ds_read_b64_tr_b16 v[48:49], v160 offset:45056
ds_read_b64_tr_b16 v[50:51], v160 offset:46080
s_waitcnt lgkmcnt(10)
v_mfma_f32_32x32x16_bf16 v[16:31], v[60:63], v[76:79], v[16:31]
s_add_u32 s50, s50, 57344
s_add_u32 s51, s51, 131072
ds_read_b64_tr_b16 v[52:53], v161 offset:45056
ds_read_b64_tr_b16 v[54:55], v161 offset:46080
s_waitcnt lgkmcnt(10)
v_mfma_f32_32x32x16_bf16 v[0:15], v[32:35], v[80:83], v[0:15]
ds_read_b64_tr_b16 v[56:57], v160 offset:47104
ds_read_b64_tr_b16 v[58:59], v160 offset:48128
s_waitcnt lgkmcnt(10)
v_mfma_f32_32x32x16_bf16 v[16:31], v[36:39], v[80:83], v[16:31]
ds_read_b64_tr_b16 v[60:61], v161 offset:47104
ds_read_b64_tr_b16 v[62:63], v161 offset:48128
s_waitcnt lgkmcnt(10)
v_mfma_f32_32x32x16_bf16 v[0:15], v[40:43], v[84:87], v[0:15]
s_waitcnt vmcnt(12)
s_barrier
ds_read_b64_tr_b16 v[32:33], v160 offset:49152
ds_read_b64_tr_b16 v[34:35], v160 offset:50176
s_waitcnt lgkmcnt(10)
v_mfma_f32_32x32x16_bf16 v[16:31], v[44:47], v[84:87], v[16:31]
ds_read_b64_tr_b16 v[36:37], v161 offset:49152
ds_read_b64_tr_b16 v[38:39], v161 offset:50176
s_waitcnt lgkmcnt(10)
v_mfma_f32_32x32x16_bf16 v[0:15], v[48:51], v[88:91], v[0:15]
ds_read_b64_tr_b16 v[40:41], v160 offset:51200
ds_read_b64_tr_b16 v[42:43], v160 offset:52224
s_waitcnt lgkmcnt(10)
v_mfma_f32_32x32x16_bf16 v[16:31], v[52:55], v[88:91], v[16:31]
ds_read_b64_tr_b16 v[44:45], v161 offset:51200
ds_read_b64_tr_b16 v[46:47], v161 offset:52224
s_waitcnt lgkmcnt(10)
v_mfma_f32_32x32x16_bf16 v[0:15], v[56:59], v[92:95], v[0:15]
ds_read_b64_tr_b16 v[48:49], v160 offset:53248
ds_read_b64_tr_b16 v[50:51], v160 offset:54272
s_waitcnt lgkmcnt(10)
v_mfma_f32_32x32x16_bf16 v[16:31], v[60:63], v[92:95], v[16:31]
ds_read_b64_tr_b16 v[52:53], v161 offset:53248
ds_read_b64_tr_b16 v[54:55], v161 offset:54272
s_waitcnt lgkmcnt(10)
v_mfma_f32_32x32x16_bf16 v[0:15], v[32:35], v[96:99], v[0:15]
s_add_u32 m0, s30, 81920
s_add_u32 s52, s51, 0
buffer_load_dwordx4 v166, s[12:15], s52 offen lds
ds_read_b64_tr_b16 v[56:57], v160 offset:55296
ds_read_b64_tr_b16 v[58:59], v160 offset:56320
s_waitcnt lgkmcnt(10)
v_mfma_f32_32x32x16_bf16 v[16:31], v[36:39], v[96:99], v[16:31]
s_add_u32 m0, s30, 82944
s_add_u32 s52, s51, 8192
buffer_load_dwordx4 v166, s[12:15], s52 offen lds
ds_read_b64_tr_b16 v[60:61], v161 offset:55296
ds_read_b64_tr_b16 v[62:63], v161 offset:56320
s_waitcnt lgkmcnt(10)
v_mfma_f32_32x32x16_bf16 v[0:15], v[40:43], v[100:103], v[0:15]
s_add_u32 m0, s30, 83968
s_add_u32 s52, s51, 16384
buffer_load_dwordx4 v166, s[12:15], s52 offen lds
ds_read_b64_tr_b16 v[32:33], v160 offset:57344
ds_read_b64_tr_b16 v[34:35], v160 offset:58368
s_waitcnt lgkmcnt(10)
v_mfma_f32_32x32x16_bf16 v[16:31], v[44:47], v[100:103], v[16:31]
s_add_u32 m0, s30, 84992
s_add_u32 s52, s51, 24576
buffer_load_dwordx4 v166, s[12:15], s52 offen lds
ds_read_b64_tr_b16 v[36:37], v161 offset:57344
ds_read_b64_tr_b16 v[38:39], v161 offset:58368
s_waitcnt lgkmcnt(10)
v_mfma_f32_32x32x16_bf16 v[0:15], v[48:51], v[104:107], v[0:15]
s_add_u32 s53, s50, 4096
buffer_load_dwordx4 v[64:67], v167, s[8:11], s50 offen offset:0
buffer_load_dwordx4 v[68:71], v167, s[8:11], s50 offen offset:1024
ds_read_b64_tr_b16 v[40:41], v160 offset:59392
ds_read_b64_tr_b16 v[42:43], v160 offset:60416
s_waitcnt lgkmcnt(10)
v_mfma_f32_32x32x16_bf16 v[16:31], v[52:55], v[104:107], v[16:31]
buffer_load_dwordx4 v[72:75], v167, s[8:11], s50 offen offset:2048
buffer_load_dwordx4 v[76:79], v167, s[8:11], s50 offen offset:3072
buffer_load_dwordx4 v[80:83], v167, s[8:11], s53 offen offset:0
ds_read_b64_tr_b16 v[44:45], v161 offset:59392
ds_read_b64_tr_b16 v[46:47], v161 offset:60416
s_waitcnt lgkmcnt(10)
v_mfma_f32_32x32x16_bf16 v[0:15], v[56:59], v[108:111], v[0:15]
buffer_load_dwordx4 v[84:87], v167, s[8:11], s53 offen offset:1024
buffer_load_dwordx4 v[88:91], v167, s[8:11], s53 offen offset:2048
buffer_load_dwordx4 v[92:95], v167, s[8:11], s53 offen offset:3072
ds_read_b64_tr_b16 v[48:49], v160 offset:61440
ds_read_b64_tr_b16 v[50:51], v160 offset:62464
s_waitcnt lgkmcnt(10)
v_mfma_f32_32x32x16_bf16 v[16:31], v[60:63], v[108:111], v[16:31]
s_add_u32 s50, s50, 57344
s_add_u32 s51, s51, 131072
ds_read_b64_tr_b16 v[52:53], v161 offset:61440
ds_read_b64_tr_b16 v[54:55], v161 offset:62464
s_waitcnt lgkmcnt(10)
v_mfma_f32_32x32x16_bf16 v[0:15], v[32:35], v[112:115], v[0:15]
ds_read_b64_tr_b16 v[56:57], v160 offset:63488
ds_read_b64_tr_b16 v[58:59], v160 offset:64512
s_waitcnt lgkmcnt(10)
v_mfma_f32_32x32x16_bf16 v[16:31], v[36:39], v[112:115], v[16:31]
ds_read_b64_tr_b16 v[60:61], v161 offset:63488
ds_read_b64_tr_b16 v[62:63], v161 offset:64512
s_waitcnt lgkmcnt(10)
v_mfma_f32_32x32x16_bf16 v[0:15], v[40:43], v[116:119], v[0:15]
s_waitcnt vmcnt(12)
s_barrier
ds_read_b64_tr_b16 v[32:33], v162 offset:0
ds_read_b64_tr_b16 v[34:35], v162 offset:1024
s_waitcnt lgkmcnt(10)
v_mfma_f32_32x32x16_bf16 v[16:31], v[44:47], v[116:119], v[16:31]
ds_read_b64_tr_b16 v[36:37], v163 offset:0
ds_read_b64_tr_b16 v[38:39], v163 offset:1024
s_waitcnt lgkmcnt(10)
v_mfma_f32_32x32x16_bf16 v[0:15], v[48:51], v[120:123], v[0:15]
ds_read_b64_tr_b16 v[40:41], v162 offset:2048
ds_read_b64_tr_b16 v[42:43], v162 offset:3072
s_waitcnt lgkmcnt(10)
v_mfma_f32_32x32x16_bf16 v[16:31], v[52:55], v[120:123], v[16:31]
ds_read_b64_tr_b16 v[44:45], v163 offset:2048
ds_read_b64_tr_b16 v[46:47], v163 offset:3072
s_waitcnt lgkmcnt(10)
v_mfma_f32_32x32x16_bf16 v[0:15], v[56:59], v[124:127], v[0:15]
ds_read_b64_tr_b16 v[48:49], v162 offset:4096
ds_read_b64_tr_b16 v[50:51], v162 offset:5120
s_waitcnt lgkmcnt(10)
v_mfma_f32_32x32x16_bf16 v[16:31], v[60:63], v[124:127], v[16:31]
ds_read_b64_tr_b16 v[52:53], v163 offset:4096
ds_read_b64_tr_b16 v[54:55], v163 offset:5120
s_waitcnt lgkmcnt(10)
v_mfma_f32_32x32x16_bf16 v[0:15], v[32:35], v[128:131], v[0:15]
s_add_u32 m0, s30, 98304
s_add_u32 s52, s51, 0
buffer_load_dwordx4 v166, s[12:15], s52 offen lds
ds_read_b64_tr_b16 v[56:57], v162 offset:6144
ds_read_b64_tr_b16 v[58:59], v162 offset:7168
s_waitcnt lgkmcnt(10)
v_mfma_f32_32x32x16_bf16 v[16:31], v[36:39], v[128:131], v[16:31]
s_add_u32 m0, s30, 99328
s_add_u32 s52, s51, 8192
buffer_load_dwordx4 v166, s[12:15], s52 offen lds
ds_read_b64_tr_b16 v[60:61], v163 offset:6144
ds_read_b64_tr_b16 v[62:63], v163 offset:7168
s_waitcnt lgkmcnt(10)
v_mfma_f32_32x32x16_bf16 v[0:15], v[40:43], v[132:135], v[0:15]
s_add_u32 m0, s30, 100352
s_add_u32 s52, s51, 16384
buffer_load_dwordx4 v166, s[12:15], s52 offen lds
ds_read_b64_tr_b16 v[32:33], v162 offset:8192
ds_read_b64_tr_b16 v[34:35], v162 offset:9216
s_waitcnt lgkmcnt(10)
v_mfma_f32_32x32x16_bf16 v[16:31], v[44:47], v[132:135], v[16:31]
s_add_u32 m0, s30, 101376
s_add_u32 s52, s51, 24576
buffer_load_dwordx4 v166, s[12:15], s52 offen lds
ds_read_b64_tr_b16 v[36:37], v163 offset:8192
ds_read_b64_tr_b16 v[38:39], v163 offset:9216
s_waitcnt lgkmcnt(10)
v_mfma_f32_32x32x16_bf16 v[0:15], v[48:51], v[136:139], v[0:15]
s_add_u32 s53, s50, 4096
buffer_load_dwordx4 v[96:99], v167, s[8:11], s50 offen offset:0
buffer_load_dwordx4 v[100:103], v167, s[8:11], s50 offen offset:1024
ds_read_b64_tr_b16 v[40:41], v162 offset:10240
ds_read_b64_tr_b16 v[42:43], v162 offset:11264
s_waitcnt lgkmcnt(10)
v_mfma_f32_32x32x16_bf16 v[16:31], v[52:55], v[136:139], v[16:31]
buffer_load_dwordx4 v[104:107], v167, s[8:11], s50 offen offset:2048
buffer_load_dwordx4 v[108:111], v167, s[8:11], s50 offen offset:3072
buffer_load_dwordx4 v[112:115], v167, s[8:11], s53 offen offset:0
ds_read_b64_tr_b16 v[44:45], v163 offset:10240
ds_read_b64_tr_b16 v[46:47], v163 offset:11264
s_waitcnt lgkmcnt(10)
v_mfma_f32_32x32x16_bf16 v[0:15], v[56:59], v[140:143], v[0:15]
buffer_load_dwordx4 v[116:119], v167, s[8:11], s53 offen offset:1024
buffer_load_dwordx4 v[120:123], v167, s[8:11], s53 offen offset:2048
buffer_load_dwordx4 v[124:127], v167, s[8:11], s53 offen offset:3072
ds_read_b64_tr_b16 v[48:49], v162 offset:12288
ds_read_b64_tr_b16 v[50:51], v162 offset:13312
s_waitcnt lgkmcnt(10)
v_mfma_f32_32x32x16_bf16 v[16:31], v[60:63], v[140:143], v[16:31]
s_add_u32 s50, s50, 57344
s_add_u32 s51, s51, 131072
ds_read_b64_tr_b16 v[52:53], v163 offset:12288
ds_read_b64_tr_b16 v[54:55], v163 offset:13312
s_waitcnt lgkmcnt(10)
v_mfma_f32_32x32x16_bf16 v[0:15], v[32:35], v[144:147], v[0:15]
ds_read_b64_tr_b16 v[56:57], v162 offset:14336
ds_read_b64_tr_b16 v[58:59], v162 offset:15360
s_waitcnt lgkmcnt(10)
v_mfma_f32_32x32x16_bf16 v[16:31], v[36:39], v[144:147], v[16:31]
ds_read_b64_tr_b16 v[60:61], v163 offset:14336
ds_read_b64_tr_b16 v[62:63], v163 offset:15360
s_waitcnt lgkmcnt(10)
v_mfma_f32_32x32x16_bf16 v[0:15], v[40:43], v[148:151], v[0:15]
s_waitcnt vmcnt(12)
s_barrier
ds_read_b64_tr_b16 v[32:33], v162 offset:16384
ds_read_b64_tr_b16 v[34:35], v162 offset:17408
s_waitcnt lgkmcnt(10)
v_mfma_f32_32x32x16_bf16 v[16:31], v[44:47], v[148:151], v[16:31]
ds_read_b64_tr_b16 v[36:37], v163 offset:16384
ds_read_b64_tr_b16 v[38:39], v163 offset:17408
s_waitcnt lgkmcnt(10)
v_mfma_f32_32x32x16_bf16 v[0:15], v[48:51], v[152:155], v[0:15]
ds_read_b64_tr_b16 v[40:41], v162 offset:18432
ds_read_b64_tr_b16 v[42:43], v162 offset:19456
s_waitcnt lgkmcnt(10)
v_mfma_f32_32x32x16_bf16 v[16:31], v[52:55], v[152:155], v[16:31]
ds_read_b64_tr_b16 v[44:45], v163 offset:18432
ds_read_b64_tr_b16 v[46:47], v163 offset:19456
s_waitcnt lgkmcnt(10)
v_mfma_f32_32x32x16_bf16 v[0:15], v[56:59], v[156:159], v[0:15]
ds_read_b64_tr_b16 v[48:49], v162 offset:20480
ds_read_b64_tr_b16 v[50:51], v162 offset:21504
s_waitcnt lgkmcnt(10)
v_mfma_f32_32x32x16_bf16 v[16:31], v[60:63], v[156:159], v[16:31]
ds_read_b64_tr_b16 v[52:53], v163 offset:20480
ds_read_b64_tr_b16 v[54:55], v163 offset:21504
s_waitcnt lgkmcnt(10)
v_mfma_f32_32x32x16_bf16 v[0:15], v[32:35], v[64:67], v[0:15]
s_add_u32 m0, s30, 114688
s_add_u32 s52, s51, 0
buffer_load_dwordx4 v166, s[12:15], s52 offen lds
ds_read_b64_tr_b16 v[56:57], v162 offset:22528
ds_read_b64_tr_b16 v[58:59], v162 offset:23552
s_waitcnt lgkmcnt(10)
v_mfma_f32_32x32x16_bf16 v[16:31], v[36:39], v[64:67], v[16:31]
s_add_u32 m0, s30, 115712
s_add_u32 s52, s51, 8192
buffer_load_dwordx4 v166, s[12:15], s52 offen lds
ds_read_b64_tr_b16 v[60:61], v163 offset:22528
ds_read_b64_tr_b16 v[62:63], v163 offset:23552
s_waitcnt lgkmcnt(10)
v_mfma_f32_32x32x16_bf16 v[0:15], v[40:43], v[68:71], v[0:15]
s_add_u32 m0, s30, 116736
s_add_u32 s52, s51, 16384
buffer_load_dwordx4 v166, s[12:15], s52 offen lds
ds_read_b64_tr_b16 v[32:33], v162 offset:24576
ds_read_b64_tr_b16 v[34:35], v162 offset:25600
s_waitcnt lgkmcnt(10)
v_mfma_f32_32x32x16_bf16 v[16:31], v[44:47], v[68:71], v[16:31]
s_add_u32 m0, s30, 117760
s_add_u32 s52, s51, 24576
buffer_load_dwordx4 v166, s[12:15], s52 offen lds
ds_read_b64_tr_b16 v[36:37], v163 offset:24576
ds_read_b64_tr_b16 v[38:39], v163 offset:25600
s_waitcnt lgkmcnt(10)
v_mfma_f32_32x32x16_bf16 v[0:15], v[48:51], v[72:75], v[0:15]
s_add_u32 s53, s50, 4096
buffer_load_dwordx4 v[128:131], v167, s[8:11], s50 offen offset:0
buffer_load_dwordx4 v[132:135], v167, s[8:11], s50 offen offset:1024
ds_read_b64_tr_b16 v[40:41], v162 offset:26624
ds_read_b64_tr_b16 v[42:43], v162 offset:27648
s_waitcnt lgkmcnt(10)
v_mfma_f32_32x32x16_bf16 v[16:31], v[52:55], v[72:75], v[16:31]
buffer_load_dwordx4 v[136:139], v167, s[8:11], s50 offen offset:2048
buffer_load_dwordx4 v[140:143], v167, s[8:11], s50 offen offset:3072
buffer_load_dwordx4 v[144:147], v167, s[8:11], s53 offen offset:0
ds_read_b64_tr_b16 v[44:45], v163 offset:26624
ds_read_b64_tr_b16 v[46:47], v163 offset:27648
s_waitcnt lgkmcnt(10)
v_mfma_f32_32x32x16_bf16 v[0:15], v[56:59], v[76:79], v[0:15]
buffer_load_dwordx4 v[148:151], v167, s[8:11], s53 offen offset:1024
buffer_load_dwordx4 v[152:155], v167, s[8:11], s53 offen offset:2048
buffer_load_dwordx4 v[156:159], v167, s[8:11], s53 offen offset:3072
ds_read_b64_tr_b16 v[48:49], v162 offset:28672
ds_read_b64_tr_b16 v[50:51], v162 offset:29696
s_waitcnt lgkmcnt(10)
v_mfma_f32_32x32x16_bf16 v[16:31], v[60:63], v[76:79], v[16:31]
s_add_u32 s50, s50, 57344
s_add_u32 s51, s51, 131072
ds_read_b64_tr_b16 v[52:53], v163 offset:28672
ds_read_b64_tr_b16 v[54:55], v163 offset:29696
s_waitcnt lgkmcnt(10)
v_mfma_f32_32x32x16_bf16 v[0:15], v[32:35], v[80:83], v[0:15]
ds_read_b64_tr_b16 v[56:57], v162 offset:30720
ds_read_b64_tr_b16 v[58:59], v162 offset:31744
s_waitcnt lgkmcnt(10)
v_mfma_f32_32x32x16_bf16 v[16:31], v[36:39], v[80:83], v[16:31]
ds_read_b64_tr_b16 v[60:61], v163 offset:30720
ds_read_b64_tr_b16 v[62:63], v163 offset:31744
s_waitcnt lgkmcnt(10)
v_mfma_f32_32x32x16_bf16 v[0:15], v[40:43], v[84:87], v[0:15]
s_waitcnt vmcnt(12)
s_barrier
ds_read_b64_tr_b16 v[32:33], v162 offset:32768
ds_read_b64_tr_b16 v[34:35], v162 offset:33792
s_waitcnt lgkmcnt(10)
v_mfma_f32_32x32x16_bf16 v[16:31], v[44:47], v[84:87], v[16:31]
ds_read_b64_tr_b16 v[36:37], v163 offset:32768
ds_read_b64_tr_b16 v[38:39], v163 offset:33792
s_waitcnt lgkmcnt(10)
v_mfma_f32_32x32x16_bf16 v[0:15], v[48:51], v[88:91], v[0:15]
ds_read_b64_tr_b16 v[40:41], v162 offset:34816
ds_read_b64_tr_b16 v[42:43], v162 offset:35840
s_waitcnt lgkmcnt(10)
v_mfma_f32_32x32x16_bf16 v[16:31], v[52:55], v[88:91], v[16:31]
ds_read_b64_tr_b16 v[44:45], v163 offset:34816
ds_read_b64_tr_b16 v[46:47], v163 offset:35840
s_waitcnt lgkmcnt(10)
v_mfma_f32_32x32x16_bf16 v[0:15], v[56:59], v[92:95], v[0:15]
ds_read_b64_tr_b16 v[48:49], v162 offset:36864
ds_read_b64_tr_b16 v[50:51], v162 offset:37888
s_waitcnt lgkmcnt(10)
v_mfma_f32_32x32x16_bf16 v[16:31], v[60:63], v[92:95], v[16:31]
ds_read_b64_tr_b16 v[52:53], v163 offset:36864
ds_read_b64_tr_b16 v[54:55], v163 offset:37888
s_waitcnt lgkmcnt(10)
v_mfma_f32_32x32x16_bf16 v[0:15], v[32:35], v[96:99], v[0:15]
s_add_u32 m0, s30, 0
s_add_u32 s52, s51, 0
buffer_load_dwordx4 v166, s[12:15], s52 offen lds
ds_read_b64_tr_b16 v[56:57], v162 offset:38912
ds_read_b64_tr_b16 v[58:59], v162 offset:39936
s_waitcnt lgkmcnt(10)
v_mfma_f32_32x32x16_bf16 v[16:31], v[36:39], v[96:99], v[16:31]
s_add_u32 m0, s30, 1024
s_add_u32 s52, s51, 8192
buffer_load_dwordx4 v166, s[12:15], s52 offen lds
ds_read_b64_tr_b16 v[60:61], v163 offset:38912
ds_read_b64_tr_b16 v[62:63], v163 offset:39936
s_waitcnt lgkmcnt(10)
v_mfma_f32_32x32x16_bf16 v[0:15], v[40:43], v[100:103], v[0:15]
s_add_u32 m0, s30, 2048
s_add_u32 s52, s51, 16384
buffer_load_dwordx4 v166, s[12:15], s52 offen lds
ds_read_b64_tr_b16 v[32:33], v162 offset:40960
ds_read_b64_tr_b16 v[34:35], v162 offset:41984
s_waitcnt lgkmcnt(10)
v_mfma_f32_32x32x16_bf16 v[16:31], v[44:47], v[100:103], v[16:31]
s_add_u32 m0, s30, 3072
s_add_u32 s52, s51, 24576
buffer_load_dwordx4 v166, s[12:15], s52 offen lds
ds_read_b64_tr_b16 v[36:37], v163 offset:40960
ds_read_b64_tr_b16 v[38:39], v163 offset:41984
s_waitcnt lgkmcnt(10)
v_mfma_f32_32x32x16_bf16 v[0:15], v[48:51], v[104:107], v[0:15]
s_add_u32 s53, s50, 4096
buffer_load_dwordx4 v[64:67], v167, s[8:11], s50 offen offset:0
buffer_load_dwordx4 v[68:71], v167, s[8:11], s50 offen offset:1024
ds_read_b64_tr_b16 v[40:41], v162 offset:43008
ds_read_b64_tr_b16 v[42:43], v162 offset:44032
s_waitcnt lgkmcnt(10)
v_mfma_f32_32x32x16_bf16 v[16:31], v[52:55], v[104:107], v[16:31]
buffer_load_dwordx4 v[72:75], v167, s[8:11], s50 offen offset:2048
buffer_load_dwordx4 v[76:79], v167, s[8:11], s50 offen offset:3072
buffer_load_dwordx4 v[80:83], v167, s[8:11], s53 offen offset:0
ds_read_b64_tr_b16 v[44:45], v163 offset:43008
ds_read_b64_tr_b16 v[46:47], v163 offset:44032
s_waitcnt lgkmcnt(10)
v_mfma_f32_32x32x16_bf16 v[0:15], v[56:59], v[108:111], v[0:15]
buffer_load_dwordx4 v[84:87], v167, s[8:11], s53 offen offset:1024
buffer_load_dwordx4 v[88:91], v167, s[8:11], s53 offen offset:2048
buffer_load_dwordx4 v[92:95], v167, s[8:11], s53 offen offset:3072
ds_read_b64_tr_b16 v[48:49], v162 offset:45056
ds_read_b64_tr_b16 v[50:51], v162 offset:46080
s_waitcnt lgkmcnt(10)
v_mfma_f32_32x32x16_bf16 v[16:31], v[60:63], v[108:111], v[16:31]
s_add_u32 s50, s50, 57344
s_add_u32 s51, s51, 131072
ds_read_b64_tr_b16 v[52:53], v163 offset:45056
ds_read_b64_tr_b16 v[54:55], v163 offset:46080
s_waitcnt lgkmcnt(10)
v_mfma_f32_32x32x16_bf16 v[0:15], v[32:35], v[112:115], v[0:15]
ds_read_b64_tr_b16 v[56:57], v162 offset:47104
ds_read_b64_tr_b16 v[58:59], v162 offset:48128
s_waitcnt lgkmcnt(10)
v_mfma_f32_32x32x16_bf16 v[16:31], v[36:39], v[112:115], v[16:31]
ds_read_b64_tr_b16 v[60:61], v163 offset:47104
ds_read_b64_tr_b16 v[62:63], v163 offset:48128
s_waitcnt lgkmcnt(10)
v_mfma_f32_32x32x16_bf16 v[0:15], v[40:43], v[116:119], v[0:15]
s_waitcnt vmcnt(12)
s_barrier
ds_read_b64_tr_b16 v[32:33], v162 offset:49152
ds_read_b64_tr_b16 v[34:35], v162 offset:50176
s_waitcnt lgkmcnt(10)
v_mfma_f32_32x32x16_bf16 v[16:31], v[44:47], v[116:119], v[16:31]
ds_read_b64_tr_b16 v[36:37], v163 offset:49152
ds_read_b64_tr_b16 v[38:39], v163 offset:50176
s_waitcnt lgkmcnt(10)
v_mfma_f32_32x32x16_bf16 v[0:15], v[48:51], v[120:123], v[0:15]
ds_read_b64_tr_b16 v[40:41], v162 offset:51200
ds_read_b64_tr_b16 v[42:43], v162 offset:52224
s_waitcnt lgkmcnt(10)
v_mfma_f32_32x32x16_bf16 v[16:31], v[52:55], v[120:123], v[16:31]
ds_read_b64_tr_b16 v[44:45], v163 offset:51200
ds_read_b64_tr_b16 v[46:47], v163 offset:52224
s_waitcnt lgkmcnt(10)
v_mfma_f32_32x32x16_bf16 v[0:15], v[56:59], v[124:127], v[0:15]
ds_read_b64_tr_b16 v[48:49], v162 offset:53248
ds_read_b64_tr_b16 v[50:51], v162 offset:54272
s_waitcnt lgkmcnt(10)
v_mfma_f32_32x32x16_bf16 v[16:31], v[60:63], v[124:127], v[16:31]
ds_read_b64_tr_b16 v[52:53], v163 offset:53248
ds_read_b64_tr_b16 v[54:55], v163 offset:54272
s_waitcnt lgkmcnt(10)
v_mfma_f32_32x32x16_bf16 v[0:15], v[32:35], v[128:131], v[0:15]
s_add_u32 m0, s30, 16384
s_add_u32 s52, s51, 0
buffer_load_dwordx4 v166, s[12:15], s52 offen lds
ds_read_b64_tr_b16 v[56:57], v162 offset:55296
ds_read_b64_tr_b16 v[58:59], v162 offset:56320
s_waitcnt lgkmcnt(10)
v_mfma_f32_32x32x16_bf16 v[16:31], v[36:39], v[128:131], v[16:31]
s_add_u32 m0, s30, 17408
s_add_u32 s52, s51, 8192
buffer_load_dwordx4 v166, s[12:15], s52 offen lds
ds_read_b64_tr_b16 v[60:61], v163 offset:55296
ds_read_b64_tr_b16 v[62:63], v163 offset:56320
s_waitcnt lgkmcnt(10)
v_mfma_f32_32x32x16_bf16 v[0:15], v[40:43], v[132:135], v[0:15]
s_add_u32 m0, s30, 18432
s_add_u32 s52, s51, 16384
buffer_load_dwordx4 v166, s[12:15], s52 offen lds
ds_read_b64_tr_b16 v[32:33], v162 offset:57344
ds_read_b64_tr_b16 v[34:35], v162 offset:58368
s_waitcnt lgkmcnt(10)
v_mfma_f32_32x32x16_bf16 v[16:31], v[44:47], v[132:135], v[16:31]
s_add_u32 m0, s30, 19456
s_add_u32 s52, s51, 24576
buffer_load_dwordx4 v166, s[12:15], s52 offen lds
ds_read_b64_tr_b16 v[36:37], v163 offset:57344
ds_read_b64_tr_b16 v[38:39], v163 offset:58368
s_waitcnt lgkmcnt(10)
v_mfma_f32_32x32x16_bf16 v[0:15], v[48:51], v[136:139], v[0:15]
s_add_u32 s53, s50, 4096
buffer_load_dwordx4 v[96:99], v167, s[8:11], s50 offen offset:0
buffer_load_dwordx4 v[100:103], v167, s[8:11], s50 offen offset:1024
ds_read_b64_tr_b16 v[40:41], v162 offset:59392
ds_read_b64_tr_b16 v[42:43], v162 offset:60416
s_waitcnt lgkmcnt(10)
v_mfma_f32_32x32x16_bf16 v[16:31], v[52:55], v[136:139], v[16:31]
buffer_load_dwordx4 v[104:107], v167, s[8:11], s50 offen offset:2048
buffer_load_dwordx4 v[108:111], v167, s[8:11], s50 offen offset:3072
buffer_load_dwordx4 v[112:115], v167, s[8:11], s53 offen offset:0
ds_read_b64_tr_b16 v[44:45], v163 offset:59392
ds_read_b64_tr_b16 v[46:47], v163 offset:60416
s_waitcnt lgkmcnt(10)
v_mfma_f32_32x32x16_bf16 v[0:15], v[56:59], v[140:143], v[0:15]
buffer_load_dwordx4 v[116:119], v167, s[8:11], s53 offen offset:1024
buffer_load_dwordx4 v[120:123], v167, s[8:11], s53 offen offset:2048
buffer_load_dwordx4 v[124:127], v167, s[8:11], s53 offen offset:3072
ds_read_b64_tr_b16 v[48:49], v162 offset:61440
ds_read_b64_tr_b16 v[50:51], v162 offset:62464
s_waitcnt lgkmcnt(10)
v_mfma_f32_32x32x16_bf16 v[16:31], v[60:63], v[140:143], v[16:31]
s_add_u32 s50, s50, 57344
s_add_u32 s51, s51, 131072
ds_read_b64_tr_b16 v[52:53], v163 offset:61440
ds_read_b64_tr_b16 v[54:55], v163 offset:62464
s_waitcnt lgkmcnt(10)
v_mfma_f32_32x32x16_bf16 v[0:15], v[32:35], v[144:147], v[0:15]
ds_read_b64_tr_b16 v[56:57], v162 offset:63488
ds_read_b64_tr_b16 v[58:59], v162 offset:64512
s_waitcnt lgkmcnt(10)
v_mfma_f32_32x32x16_bf16 v[16:31], v[36:39], v[144:147], v[16:31]
ds_read_b64_tr_b16 v[60:61], v163 offset:63488
ds_read_b64_tr_b16 v[62:63], v163 offset:64512
s_waitcnt lgkmcnt(10)
v_mfma_f32_32x32x16_bf16 v[0:15], v[40:43], v[148:151], v[0:15]
s_waitcnt vmcnt(12)
s_barrier
ds_read_b64_tr_b16 v[32:33], v160 offset:0
ds_read_b64_tr_b16 v[34:35], v160 offset:1024
s_waitcnt lgkmcnt(10)
v_mfma_f32_32x32x16_bf16 v[16:31], v[44:47], v[148:151], v[16:31]
ds_read_b64_tr_b16 v[36:37], v161 offset:0
ds_read_b64_tr_b16 v[38:39], v161 offset:1024
s_waitcnt lgkmcnt(10)
v_mfma_f32_32x32x16_bf16 v[0:15], v[48:51], v[152:155], v[0:15]
ds_read_b64_tr_b16 v[40:41], v160 offset:2048
ds_read_b64_tr_b16 v[42:43], v160 offset:3072
s_waitcnt lgkmcnt(10)
v_mfma_f32_32x32x16_bf16 v[16:31], v[52:55], v[152:155], v[16:31]
ds_read_b64_tr_b16 v[44:45], v161 offset:2048
ds_read_b64_tr_b16 v[46:47], v161 offset:3072
s_waitcnt lgkmcnt(10)
v_mfma_f32_32x32x16_bf16 v[0:15], v[56:59], v[156:159], v[0:15]
ds_read_b64_tr_b16 v[48:49], v160 offset:4096
ds_read_b64_tr_b16 v[50:51], v160 offset:5120
s_waitcnt lgkmcnt(10)
v_mfma_f32_32x32x16_bf16 v[16:31], v[60:63], v[156:159], v[16:31]
ds_read_b64_tr_b16 v[52:53], v161 offset:4096
ds_read_b64_tr_b16 v[54:55], v161 offset:5120
s_waitcnt lgkmcnt(10)
v_mfma_f32_32x32x16_bf16 v[0:15], v[32:35], v[64:67], v[0:15]
s_add_u32 m0, s30, 32768
s_add_u32 s52, s51, 0
buffer_load_dwordx4 v166, s[12:15], s52 offen lds
ds_read_b64_tr_b16 v[56:57], v160 offset:6144
ds_read_b64_tr_b16 v[58:59], v160 offset:7168
s_waitcnt lgkmcnt(10)
v_mfma_f32_32x32x16_bf16 v[16:31], v[36:39], v[64:67], v[16:31]
s_add_u32 m0, s30, 33792
s_add_u32 s52, s51, 8192
buffer_load_dwordx4 v166, s[12:15], s52 offen lds
ds_read_b64_tr_b16 v[60:61], v161 offset:6144
ds_read_b64_tr_b16 v[62:63], v161 offset:7168
s_waitcnt lgkmcnt(10)
v_mfma_f32_32x32x16_bf16 v[0:15], v[40:43], v[68:71], v[0:15]
s_add_u32 m0, s30, 34816
s_add_u32 s52, s51, 16384
buffer_load_dwordx4 v166, s[12:15], s52 offen lds
ds_read_b64_tr_b16 v[32:33], v160 offset:8192
ds_read_b64_tr_b16 v[34:35], v160 offset:9216
s_waitcnt lgkmcnt(10)
v_mfma_f32_32x32x16_bf16 v[16:31], v[44:47], v[68:71], v[16:31]
s_add_u32 m0, s30, 35840
s_add_u32 s52, s51, 24576
buffer_load_dwordx4 v166, s[12:15], s52 offen lds
ds_read_b64_tr_b16 v[36:37], v161 offset:8192
ds_read_b64_tr_b16 v[38:39], v161 offset:9216
s_waitcnt lgkmcnt(10)
v_mfma_f32_32x32x16_bf16 v[0:15], v[48:51], v[72:75], v[0:15]
s_add_u32 s53, s50, 4096
buffer_load_dwordx4 v[128:131], v167, s[8:11], s50 offen offset:0
buffer_load_dwordx4 v[132:135], v167, s[8:11], s50 offen offset:1024
ds_read_b64_tr_b16 v[40:41], v160 offset:10240
ds_read_b64_tr_b16 v[42:43], v160 offset:11264
s_waitcnt lgkmcnt(10)
v_mfma_f32_32x32x16_bf16 v[16:31], v[52:55], v[72:75], v[16:31]
buffer_load_dwordx4 v[136:139], v167, s[8:11], s50 offen offset:2048
buffer_load_dwordx4 v[140:143], v167, s[8:11], s50 offen offset:3072
buffer_load_dwordx4 v[144:147], v167, s[8:11], s53 offen offset:0
ds_read_b64_tr_b16 v[44:45], v161 offset:10240
ds_read_b64_tr_b16 v[46:47], v161 offset:11264
s_waitcnt lgkmcnt(10)
v_mfma_f32_32x32x16_bf16 v[0:15], v[56:59], v[76:79], v[0:15]
buffer_load_dwordx4 v[148:151], v167, s[8:11], s53 offen offset:1024
buffer_load_dwordx4 v[152:155], v167, s[8:11], s53 offen offset:2048
buffer_load_dwordx4 v[156:159], v167, s[8:11], s53 offen offset:3072
ds_read_b64_tr_b16 v[48:49], v160 offset:12288
ds_read_b64_tr_b16 v[50:51], v160 offset:13312
s_waitcnt lgkmcnt(10)
v_mfma_f32_32x32x16_bf16 v[16:31], v[60:63], v[76:79], v[16:31]
s_add_u32 s50, s50, 57344
s_add_u32 s51, s51, 131072
ds_read_b64_tr_b16 v[52:53], v161 offset:12288
ds_read_b64_tr_b16 v[54:55], v161 offset:13312
s_waitcnt lgkmcnt(10)
v_mfma_f32_32x32x16_bf16 v[0:15], v[32:35], v[80:83], v[0:15]
ds_read_b64_tr_b16 v[56:57], v160 offset:14336
ds_read_b64_tr_b16 v[58:59], v160 offset:15360
s_waitcnt lgkmcnt(10)
v_mfma_f32_32x32x16_bf16 v[16:31], v[36:39], v[80:83], v[16:31]
ds_read_b64_tr_b16 v[60:61], v161 offset:14336
ds_read_b64_tr_b16 v[62:63], v161 offset:15360
s_waitcnt lgkmcnt(10)
v_mfma_f32_32x32x16_bf16 v[0:15], v[40:43], v[84:87], v[0:15]
s_waitcnt vmcnt(12)
s_barrier
ds_read_b64_tr_b16 v[32:33], v160 offset:16384
ds_read_b64_tr_b16 v[34:35], v160 offset:17408
s_waitcnt lgkmcnt(10)
v_mfma_f32_32x32x16_bf16 v[16:31], v[44:47], v[84:87], v[16:31]
ds_read_b64_tr_b16 v[36:37], v161 offset:16384
ds_read_b64_tr_b16 v[38:39], v161 offset:17408
s_waitcnt lgkmcnt(10)
v_mfma_f32_32x32x16_bf16 v[0:15], v[48:51], v[88:91], v[0:15]
ds_read_b64_tr_b16 v[40:41], v160 offset:18432
ds_read_b64_tr_b16 v[42:43], v160 offset:19456
s_waitcnt lgkmcnt(10)
v_mfma_f32_32x32x16_bf16 v[16:31], v[52:55], v[88:91], v[16:31]
ds_read_b64_tr_b16 v[44:45], v161 offset:18432
ds_read_b64_tr_b16 v[46:47], v161 offset:19456
s_waitcnt lgkmcnt(10)
v_mfma_f32_32x32x16_bf16 v[0:15], v[56:59], v[92:95], v[0:15]
ds_read_b64_tr_b16 v[48:49], v160 offset:20480
ds_read_b64_tr_b16 v[50:51], v160 offset:21504
s_waitcnt lgkmcnt(10)
v_mfma_f32_32x32x16_bf16 v[16:31], v[60:63], v[92:95], v[16:31]
ds_read_b64_tr_b16 v[52:53], v161 offset:20480
ds_read_b64_tr_b16 v[54:55], v161 offset:21504
s_waitcnt lgkmcnt(10)
v_mfma_f32_32x32x16_bf16 v[0:15], v[32:35], v[96:99], v[0:15]
s_add_u32 m0, s30, 49152
s_add_u32 s52, s51, 0
buffer_load_dwordx4 v166, s[12:15], s52 offen lds
ds_read_b64_tr_b16 v[56:57], v160 offset:22528
ds_read_b64_tr_b16 v[58:59], v160 offset:23552
s_waitcnt lgkmcnt(10)
v_mfma_f32_32x32x16_bf16 v[16:31], v[36:39], v[96:99], v[16:31]
s_add_u32 m0, s30, 50176
s_add_u32 s52, s51, 8192
buffer_load_dwordx4 v166, s[12:15], s52 offen lds
ds_read_b64_tr_b16 v[60:61], v161 offset:22528
ds_read_b64_tr_b16 v[62:63], v161 offset:23552
s_waitcnt lgkmcnt(10)
v_mfma_f32_32x32x16_bf16 v[0:15], v[40:43], v[100:103], v[0:15]
s_add_u32 m0, s30, 51200
s_add_u32 s52, s51, 16384
buffer_load_dwordx4 v166, s[12:15], s52 offen lds
ds_read_b64_tr_b16 v[32:33], v160 offset:24576
ds_read_b64_tr_b16 v[34:35], v160 offset:25600
s_waitcnt lgkmcnt(10)
v_mfma_f32_32x32x16_bf16 v[16:31], v[44:47], v[100:103], v[16:31]
s_add_u32 m0, s30, 52224
s_add_u32 s52, s51, 24576
buffer_load_dwordx4 v166, s[12:15], s52 offen lds
ds_read_b64_tr_b16 v[36:37], v161 offset:24576
ds_read_b64_tr_b16 v[38:39], v161 offset:25600
s_waitcnt lgkmcnt(10)
v_mfma_f32_32x32x16_bf16 v[0:15], v[48:51], v[104:107], v[0:15]
s_add_u32 s53, s50, 4096
buffer_load_dwordx4 v[64:67], v167, s[8:11], s50 offen offset:0
buffer_load_dwordx4 v[68:71], v167, s[8:11], s50 offen offset:1024
ds_read_b64_tr_b16 v[40:41], v160 offset:26624
ds_read_b64_tr_b16 v[42:43], v160 offset:27648
s_waitcnt lgkmcnt(10)
v_mfma_f32_32x32x16_bf16 v[16:31], v[52:55], v[104:107], v[16:31]
buffer_load_dwordx4 v[72:75], v167, s[8:11], s50 offen offset:2048
buffer_load_dwordx4 v[76:79], v167, s[8:11], s50 offen offset:3072
buffer_load_dwordx4 v[80:83], v167, s[8:11], s53 offen offset:0
ds_read_b64_tr_b16 v[44:45], v161 offset:26624
ds_read_b64_tr_b16 v[46:47], v161 offset:27648
s_waitcnt lgkmcnt(10)
v_mfma_f32_32x32x16_bf16 v[0:15], v[56:59], v[108:111], v[0:15]
buffer_load_dwordx4 v[84:87], v167, s[8:11], s53 offen offset:1024
buffer_load_dwordx4 v[88:91], v167, s[8:11], s53 offen offset:2048
buffer_load_dwordx4 v[92:95], v167, s[8:11], s53 offen offset:3072
ds_read_b64_tr_b16 v[48:49], v160 offset:28672
ds_read_b64_tr_b16 v[50:51], v160 offset:29696
s_waitcnt lgkmcnt(10)
v_mfma_f32_32x32x16_bf16 v[16:31], v[60:63], v[108:111], v[16:31]
s_add_u32 s50, s50, 57344
s_add_u32 s51, s51, 131072
ds_read_b64_tr_b16 v[52:53], v161 offset:28672
ds_read_b64_tr_b16 v[54:55], v161 offset:29696
s_waitcnt lgkmcnt(10)
v_mfma_f32_32x32x16_bf16 v[0:15], v[32:35], v[112:115], v[0:15]
ds_read_b64_tr_b16 v[56:57], v160 offset:30720
ds_read_b64_tr_b16 v[58:59], v160 offset:31744
s_waitcnt lgkmcnt(10)
v_mfma_f32_32x32x16_bf16 v[16:31], v[36:39], v[112:115], v[16:31]
ds_read_b64_tr_b16 v[60:61], v161 offset:30720
ds_read_b64_tr_b16 v[62:63], v161 offset:31744
s_waitcnt lgkmcnt(10)
v_mfma_f32_32x32x16_bf16 v[0:15], v[40:43], v[116:119], v[0:15]
s_waitcnt vmcnt(12)
s_barrier
ds_read_b64_tr_b16 v[32:33], v160 offset:32768
ds_read_b64_tr_b16 v[34:35], v160 offset:33792
s_waitcnt lgkmcnt(10)
v_mfma_f32_32x32x16_bf16 v[16:31], v[44:47], v[116:119], v[16:31]
ds_read_b64_tr_b16 v[36:37], v161 offset:32768
ds_read_b64_tr_b16 v[38:39], v161 offset:33792
s_waitcnt lgkmcnt(10)
v_mfma_f32_32x32x16_bf16 v[0:15], v[48:51], v[120:123], v[0:15]
ds_read_b64_tr_b16 v[40:41], v160 offset:34816
ds_read_b64_tr_b16 v[42:43], v160 offset:35840
s_waitcnt lgkmcnt(10)
v_mfma_f32_32x32x16_bf16 v[16:31], v[52:55], v[120:123], v[16:31]
ds_read_b64_tr_b16 v[44:45], v161 offset:34816
ds_read_b64_tr_b16 v[46:47], v161 offset:35840
s_waitcnt lgkmcnt(10)
v_mfma_f32_32x32x16_bf16 v[0:15], v[56:59], v[124:127], v[0:15]
ds_read_b64_tr_b16 v[48:49], v160 offset:36864
ds_read_b64_tr_b16 v[50:51], v160 offset:37888
s_waitcnt lgkmcnt(10)
v_mfma_f32_32x32x16_bf16 v[16:31], v[60:63], v[124:127], v[16:31]
ds_read_b64_tr_b16 v[52:53], v161 offset:36864
ds_read_b64_tr_b16 v[54:55], v161 offset:37888
s_waitcnt lgkmcnt(10)
v_mfma_f32_32x32x16_bf16 v[0:15], v[32:35], v[128:131], v[0:15]
s_add_u32 m0, s30, 65536
s_add_u32 s52, s51, 0
buffer_load_dwordx4 v166, s[12:15], s52 offen lds
ds_read_b64_tr_b16 v[56:57], v160 offset:38912
ds_read_b64_tr_b16 v[58:59], v160 offset:39936
s_waitcnt lgkmcnt(10)
v_mfma_f32_32x32x16_bf16 v[16:31], v[36:39], v[128:131], v[16:31]
s_add_u32 m0, s30, 66560
s_add_u32 s52, s51, 8192
buffer_load_dwordx4 v166, s[12:15], s52 offen lds
ds_read_b64_tr_b16 v[60:61], v161 offset:38912
ds_read_b64_tr_b16 v[62:63], v161 offset:39936
s_waitcnt lgkmcnt(10)
v_mfma_f32_32x32x16_bf16 v[0:15], v[40:43], v[132:135], v[0:15]
s_add_u32 m0, s30, 67584
s_add_u32 s52, s51, 16384
buffer_load_dwordx4 v166, s[12:15], s52 offen lds
ds_read_b64_tr_b16 v[32:33], v160 offset:40960
ds_read_b64_tr_b16 v[34:35], v160 offset:41984
s_waitcnt lgkmcnt(10)
v_mfma_f32_32x32x16_bf16 v[16:31], v[44:47], v[132:135], v[16:31]
s_add_u32 m0, s30, 68608
s_add_u32 s52, s51, 24576
buffer_load_dwordx4 v166, s[12:15], s52 offen lds
ds_read_b64_tr_b16 v[36:37], v161 offset:40960
ds_read_b64_tr_b16 v[38:39], v161 offset:41984
s_waitcnt lgkmcnt(10)
v_mfma_f32_32x32x16_bf16 v[0:15], v[48:51], v[136:139], v[0:15]
s_add_u32 s53, s50, 4096
buffer_load_dwordx4 v[96:99], v167, s[8:11], s50 offen offset:0
buffer_load_dwordx4 v[100:103], v167, s[8:11], s50 offen offset:1024
ds_read_b64_tr_b16 v[40:41], v160 offset:43008
ds_read_b64_tr_b16 v[42:43], v160 offset:44032
s_waitcnt lgkmcnt(10)
v_mfma_f32_32x32x16_bf16 v[16:31], v[52:55], v[136:139], v[16:31]
buffer_load_dwordx4 v[104:107], v167, s[8:11], s50 offen offset:2048
buffer_load_dwordx4 v[108:111], v167, s[8:11], s50 offen offset:3072
buffer_load_dwordx4 v[112:115], v167, s[8:11], s53 offen offset:0
ds_read_b64_tr_b16 v[44:45], v161 offset:43008
ds_read_b64_tr_b16 v[46:47], v161 offset:44032
s_waitcnt lgkmcnt(10)
v_mfma_f32_32x32x16_bf16 v[0:15], v[56:59], v[140:143], v[0:15]
buffer_load_dwordx4 v[116:119], v167, s[8:11], s53 offen offset:1024
buffer_load_dwordx4 v[120:123], v167, s[8:11], s53 offen offset:2048
buffer_load_dwordx4 v[124:127], v167, s[8:11], s53 offen offset:3072
ds_read_b64_tr_b16 v[48:49], v160 offset:45056
ds_read_b64_tr_b16 v[50:51], v160 offset:46080
s_waitcnt lgkmcnt(10)
v_mfma_f32_32x32x16_bf16 v[16:31], v[60:63], v[140:143], v[16:31]
s_add_u32 s50, s50, 57344
s_add_u32 s51, s51, 131072
ds_read_b64_tr_b16 v[52:53], v161 offset:45056
ds_read_b64_tr_b16 v[54:55], v161 offset:46080
s_waitcnt lgkmcnt(10)
v_mfma_f32_32x32x16_bf16 v[0:15], v[32:35], v[144:147], v[0:15]
ds_read_b64_tr_b16 v[56:57], v160 offset:47104
ds_read_b64_tr_b16 v[58:59], v160 offset:48128
s_waitcnt lgkmcnt(10)
v_mfma_f32_32x32x16_bf16 v[16:31], v[36:39], v[144:147], v[16:31]
ds_read_b64_tr_b16 v[60:61], v161 offset:47104
ds_read_b64_tr_b16 v[62:63], v161 offset:48128
s_waitcnt lgkmcnt(10)
v_mfma_f32_32x32x16_bf16 v[0:15], v[40:43], v[148:151], v[0:15]
s_waitcnt vmcnt(12)
s_barrier
ds_read_b64_tr_b16 v[32:33], v160 offset:49152
ds_read_b64_tr_b16 v[34:35], v160 offset:50176
s_waitcnt lgkmcnt(10)
v_mfma_f32_32x32x16_bf16 v[16:31], v[44:47], v[148:151], v[16:31]
ds_read_b64_tr_b16 v[36:37], v161 offset:49152
ds_read_b64_tr_b16 v[38:39], v161 offset:50176
s_waitcnt lgkmcnt(10)
v_mfma_f32_32x32x16_bf16 v[0:15], v[48:51], v[152:155], v[0:15]
ds_read_b64_tr_b16 v[40:41], v160 offset:51200
ds_read_b64_tr_b16 v[42:43], v160 offset:52224
s_waitcnt lgkmcnt(10)
v_mfma_f32_32x32x16_bf16 v[16:31], v[52:55], v[152:155], v[16:31]
ds_read_b64_tr_b16 v[44:45], v161 offset:51200
ds_read_b64_tr_b16 v[46:47], v161 offset:52224
s_waitcnt lgkmcnt(10)
v_mfma_f32_32x32x16_bf16 v[0:15], v[56:59], v[156:159], v[0:15]
ds_read_b64_tr_b16 v[48:49], v160 offset:53248
ds_read_b64_tr_b16 v[50:51], v160 offset:54272
s_waitcnt lgkmcnt(10)
v_mfma_f32_32x32x16_bf16 v[16:31], v[60:63], v[156:159], v[16:31]
ds_read_b64_tr_b16 v[52:53], v161 offset:53248
ds_read_b64_tr_b16 v[54:55], v161 offset:54272
s_waitcnt lgkmcnt(10)
v_mfma_f32_32x32x16_bf16 v[0:15], v[32:35], v[64:67], v[0:15]
s_add_u32 m0, s30, 81920
s_add_u32 s52, s51, 0
buffer_load_dwordx4 v166, s[12:15], s52 offen lds
ds_read_b64_tr_b16 v[56:57], v160 offset:55296
ds_read_b64_tr_b16 v[58:59], v160 offset:56320
s_waitcnt lgkmcnt(10)
v_mfma_f32_32x32x16_bf16 v[16:31], v[36:39], v[64:67], v[16:31]
s_add_u32 m0, s30, 82944
s_add_u32 s52, s51, 8192
buffer_load_dwordx4 v166, s[12:15], s52 offen lds
ds_read_b64_tr_b16 v[60:61], v161 offset:55296
ds_read_b64_tr_b16 v[62:63], v161 offset:56320
s_waitcnt lgkmcnt(10)
v_mfma_f32_32x32x16_bf16 v[0:15], v[40:43], v[68:71], v[0:15]
s_add_u32 m0, s30, 83968
s_add_u32 s52, s51, 16384
buffer_load_dwordx4 v166, s[12:15], s52 offen lds
ds_read_b64_tr_b16 v[32:33], v160 offset:57344
ds_read_b64_tr_b16 v[34:35], v160 offset:58368
s_waitcnt lgkmcnt(10)
v_mfma_f32_32x32x16_bf16 v[16:31], v[44:47], v[68:71], v[16:31]
s_add_u32 m0, s30, 84992
s_add_u32 s52, s51, 24576
buffer_load_dwordx4 v166, s[12:15], s52 offen lds
ds_read_b64_tr_b16 v[36:37], v161 offset:57344
ds_read_b64_tr_b16 v[38:39], v161 offset:58368
s_waitcnt lgkmcnt(10)
v_mfma_f32_32x32x16_bf16 v[0:15], v[48:51], v[72:75], v[0:15]
s_add_u32 s53, s50, 4096
buffer_load_dwordx4 v[128:131], v167, s[8:11], s50 offen offset:0
buffer_load_dwordx4 v[132:135], v167, s[8:11], s50 offen offset:1024
ds_read_b64_tr_b16 v[40:41], v160 offset:59392
ds_read_b64_tr_b16 v[42:43], v160 offset:60416
s_waitcnt lgkmcnt(10)
v_mfma_f32_32x32x16_bf16 v[16:31], v[52:55], v[72:75], v[16:31]
buffer_load_dwordx4 v[136:139], v167, s[8:11], s50 offen offset:2048
buffer_load_dwordx4 v[140:143], v167, s[8:11], s50 offen offset:3072
buffer_load_dwordx4 v[144:147], v167, s[8:11], s53 offen offset:0
ds_read_b64_tr_b16 v[44:45], v161 offset:59392
ds_read_b64_tr_b16 v[46:47], v161 offset:60416
s_waitcnt lgkmcnt(10)
v_mfma_f32_32x32x16_bf16 v[0:15], v[56:59], v[76:79], v[0:15]
buffer_load_dwordx4 v[148:151], v167, s[8:11], s53 offen offset:1024
buffer_load_dwordx4 v[152:155], v167, s[8:11], s53 offen offset:2048
buffer_load_dwordx4 v[156:159], v167, s[8:11], s53 offen offset:3072
ds_read_b64_tr_b16 v[48:49], v160 offset:61440
ds_read_b64_tr_b16 v[50:51], v160 offset:62464
s_waitcnt lgkmcnt(10)
v_mfma_f32_32x32x16_bf16 v[16:31], v[60:63], v[76:79], v[16:31]
s_add_u32 s50, s50, 57344
s_add_u32 s51, s51, 131072
ds_read_b64_tr_b16 v[52:53], v161 offset:61440
ds_read_b64_tr_b16 v[54:55], v161 offset:62464
s_waitcnt lgkmcnt(10)
v_mfma_f32_32x32x16_bf16 v[0:15], v[32:35], v[80:83], v[0:15]
ds_read_b64_tr_b16 v[56:57], v160 offset:63488
ds_read_b64_tr_b16 v[58:59], v160 offset:64512
s_waitcnt lgkmcnt(10)
v_mfma_f32_32x32x16_bf16 v[16:31], v[36:39], v[80:83], v[16:31]
ds_read_b64_tr_b16 v[60:61], v161 offset:63488
ds_read_b64_tr_b16 v[62:63], v161 offset:64512
s_waitcnt lgkmcnt(10)
v_mfma_f32_32x32x16_bf16 v[0:15], v[40:43], v[84:87], v[0:15]
s_waitcnt vmcnt(12)
s_barrier
ds_read_b64_tr_b16 v[32:33], v162 offset:0
ds_read_b64_tr_b16 v[34:35], v162 offset:1024
s_waitcnt lgkmcnt(10)
v_mfma_f32_32x32x16_bf16 v[16:31], v[44:47], v[84:87], v[16:31]
ds_read_b64_tr_b16 v[36:37], v163 offset:0
ds_read_b64_tr_b16 v[38:39], v163 offset:1024
s_waitcnt lgkmcnt(10)
v_mfma_f32_32x32x16_bf16 v[0:15], v[48:51], v[88:91], v[0:15]
ds_read_b64_tr_b16 v[40:41], v162 offset:2048
ds_read_b64_tr_b16 v[42:43], v162 offset:3072
s_waitcnt lgkmcnt(10)
v_mfma_f32_32x32x16_bf16 v[16:31], v[52:55], v[88:91], v[16:31]
ds_read_b64_tr_b16 v[44:45], v163 offset:2048
ds_read_b64_tr_b16 v[46:47], v163 offset:3072
s_waitcnt lgkmcnt(10)
v_mfma_f32_32x32x16_bf16 v[0:15], v[56:59], v[92:95], v[0:15]
ds_read_b64_tr_b16 v[48:49], v162 offset:4096
ds_read_b64_tr_b16 v[50:51], v162 offset:5120
s_waitcnt lgkmcnt(10)
v_mfma_f32_32x32x16_bf16 v[16:31], v[60:63], v[92:95], v[16:31]
ds_read_b64_tr_b16 v[52:53], v163 offset:4096
ds_read_b64_tr_b16 v[54:55], v163 offset:5120
s_waitcnt lgkmcnt(10)
v_mfma_f32_32x32x16_bf16 v[0:15], v[32:35], v[96:99], v[0:15]
s_add_u32 m0, s30, 98304
s_add_u32 s52, s51, 0
buffer_load_dwordx4 v166, s[12:15], s52 offen lds
ds_read_b64_tr_b16 v[56:57], v162 offset:6144
ds_read_b64_tr_b16 v[58:59], v162 offset:7168
s_waitcnt lgkmcnt(10)
v_mfma_f32_32x32x16_bf16 v[16:31], v[36:39], v[96:99], v[16:31]
s_add_u32 m0, s30, 99328
s_add_u32 s52, s51, 8192
buffer_load_dwordx4 v166, s[12:15], s52 offen lds
ds_read_b64_tr_b16 v[60:61], v163 offset:6144
ds_read_b64_tr_b16 v[62:63], v163 offset:7168
s_waitcnt lgkmcnt(10)
v_mfma_f32_32x32x16_bf16 v[0:15], v[40:43], v[100:103], v[0:15]
s_add_u32 m0, s30, 100352
s_add_u32 s52, s51, 16384
buffer_load_dwordx4 v166, s[12:15], s52 offen lds
ds_read_b64_tr_b16 v[32:33], v162 offset:8192
ds_read_b64_tr_b16 v[34:35], v162 offset:9216
s_waitcnt lgkmcnt(10)
v_mfma_f32_32x32x16_bf16 v[16:31], v[44:47], v[100:103], v[16:31]
s_add_u32 m0, s30, 101376
s_add_u32 s52, s51, 24576
buffer_load_dwordx4 v166, s[12:15], s52 offen lds
ds_read_b64_tr_b16 v[36:37], v163 offset:8192
ds_read_b64_tr_b16 v[38:39], v163 offset:9216
s_waitcnt lgkmcnt(10)
v_mfma_f32_32x32x16_bf16 v[0:15], v[48:51], v[104:107], v[0:15]
s_add_u32 s53, s50, 4096
buffer_load_dwordx4 v[64:67], v167, s[8:11], s50 offen offset:0
buffer_load_dwordx4 v[68:71], v167, s[8:11], s50 offen offset:1024
ds_read_b64_tr_b16 v[40:41], v162 offset:10240
ds_read_b64_tr_b16 v[42:43], v162 offset:11264
s_waitcnt lgkmcnt(10)
v_mfma_f32_32x32x16_bf16 v[16:31], v[52:55], v[104:107], v[16:31]
buffer_load_dwordx4 v[72:75], v167, s[8:11], s50 offen offset:2048
buffer_load_dwordx4 v[76:79], v167, s[8:11], s50 offen offset:3072
buffer_load_dwordx4 v[80:83], v167, s[8:11], s53 offen offset:0
ds_read_b64_tr_b16 v[44:45], v163 offset:10240
ds_read_b64_tr_b16 v[46:47], v163 offset:11264
s_waitcnt lgkmcnt(10)
v_mfma_f32_32x32x16_bf16 v[0:15], v[56:59], v[108:111], v[0:15]
buffer_load_dwordx4 v[84:87], v167, s[8:11], s53 offen offset:1024
buffer_load_dwordx4 v[88:91], v167, s[8:11], s53 offen offset:2048
buffer_load_dwordx4 v[92:95], v167, s[8:11], s53 offen offset:3072
ds_read_b64_tr_b16 v[48:49], v162 offset:12288
ds_read_b64_tr_b16 v[50:51], v162 offset:13312
s_waitcnt lgkmcnt(10)
v_mfma_f32_32x32x16_bf16 v[16:31], v[60:63], v[108:111], v[16:31]
s_add_u32 s50, s50, 57344
s_add_u32 s51, s51, 131072
ds_read_b64_tr_b16 v[52:53], v163 offset:12288
ds_read_b64_tr_b16 v[54:55], v163 offset:13312
s_waitcnt lgkmcnt(10)
v_mfma_f32_32x32x16_bf16 v[0:15], v[32:35], v[112:115], v[0:15]
ds_read_b64_tr_b16 v[56:57], v162 offset:14336
ds_read_b64_tr_b16 v[58:59], v162 offset:15360
s_waitcnt lgkmcnt(10)
v_mfma_f32_32x32x16_bf16 v[16:31], v[36:39], v[112:115], v[16:31]
ds_read_b64_tr_b16 v[60:61], v163 offset:14336
ds_read_b64_tr_b16 v[62:63], v163 offset:15360
s_waitcnt lgkmcnt(10)
v_mfma_f32_32x32x16_bf16 v[0:15], v[40:43], v[116:119], v[0:15]
s_waitcnt vmcnt(12)
s_barrier
ds_read_b64_tr_b16 v[32:33], v162 offset:16384
ds_read_b64_tr_b16 v[34:35], v162 offset:17408
s_waitcnt lgkmcnt(10)
v_mfma_f32_32x32x16_bf16 v[16:31], v[44:47], v[116:119], v[16:31]
ds_read_b64_tr_b16 v[36:37], v163 offset:16384
ds_read_b64_tr_b16 v[38:39], v163 offset:17408
s_waitcnt lgkmcnt(10)
v_mfma_f32_32x32x16_bf16 v[0:15], v[48:51], v[120:123], v[0:15]
ds_read_b64_tr_b16 v[40:41], v162 offset:18432
ds_read_b64_tr_b16 v[42:43], v162 offset:19456
s_waitcnt lgkmcnt(10)
v_mfma_f32_32x32x16_bf16 v[16:31], v[52:55], v[120:123], v[16:31]
ds_read_b64_tr_b16 v[44:45], v163 offset:18432
ds_read_b64_tr_b16 v[46:47], v163 offset:19456
s_waitcnt lgkmcnt(10)
v_mfma_f32_32x32x16_bf16 v[0:15], v[56:59], v[124:127], v[0:15]
ds_read_b64_tr_b16 v[48:49], v162 offset:20480
ds_read_b64_tr_b16 v[50:51], v162 offset:21504
s_waitcnt lgkmcnt(10)
v_mfma_f32_32x32x16_bf16 v[16:31], v[60:63], v[124:127], v[16:31]
ds_read_b64_tr_b16 v[52:53], v163 offset:20480
ds_read_b64_tr_b16 v[54:55], v163 offset:21504
s_waitcnt lgkmcnt(10)
v_mfma_f32_32x32x16_bf16 v[0:15], v[32:35], v[128:131], v[0:15]
s_add_u32 m0, s30, 114688
s_add_u32 s52, s51, 0
buffer_load_dwordx4 v166, s[12:15], s52 offen lds
ds_read_b64_tr_b16 v[56:57], v162 offset:22528
ds_read_b64_tr_b16 v[58:59], v162 offset:23552
s_waitcnt lgkmcnt(10)
v_mfma_f32_32x32x16_bf16 v[16:31], v[36:39], v[128:131], v[16:31]
s_add_u32 m0, s30, 115712
s_add_u32 s52, s51, 8192
buffer_load_dwordx4 v166, s[12:15], s52 offen lds
ds_read_b64_tr_b16 v[60:61], v163 offset:22528
ds_read_b64_tr_b16 v[62:63], v163 offset:23552
s_waitcnt lgkmcnt(10)
v_mfma_f32_32x32x16_bf16 v[0:15], v[40:43], v[132:135], v[0:15]
s_add_u32 m0, s30, 116736
s_add_u32 s52, s51, 16384
buffer_load_dwordx4 v166, s[12:15], s52 offen lds
ds_read_b64_tr_b16 v[32:33], v162 offset:24576
ds_read_b64_tr_b16 v[34:35], v162 offset:25600
s_waitcnt lgkmcnt(10)
v_mfma_f32_32x32x16_bf16 v[16:31], v[44:47], v[132:135], v[16:31]
s_add_u32 m0, s30, 117760
s_add_u32 s52, s51, 24576
buffer_load_dwordx4 v166, s[12:15], s52 offen lds
ds_read_b64_tr_b16 v[36:37], v163 offset:24576
ds_read_b64_tr_b16 v[38:39], v163 offset:25600
s_waitcnt lgkmcnt(10)
v_mfma_f32_32x32x16_bf16 v[0:15], v[48:51], v[136:139], v[0:15]
s_add_u32 s53, s50, 4096
buffer_load_dwordx4 v[96:99], v167, s[8:11], s50 offen offset:0
buffer_load_dwordx4 v[100:103], v167, s[8:11], s50 offen offset:1024
ds_read_b64_tr_b16 v[40:41], v162 offset:26624
ds_read_b64_tr_b16 v[42:43], v162 offset:27648
s_waitcnt lgkmcnt(10)
v_mfma_f32_32x32x16_bf16 v[16:31], v[52:55], v[136:139], v[16:31]
buffer_load_dwordx4 v[104:107], v167, s[8:11], s50 offen offset:2048
buffer_load_dwordx4 v[108:111], v167, s[8:11], s50 offen offset:3072
buffer_load_dwordx4 v[112:115], v167, s[8:11], s53 offen offset:0
ds_read_b64_tr_b16 v[44:45], v163 offset:26624
ds_read_b64_tr_b16 v[46:47], v163 offset:27648
s_waitcnt lgkmcnt(10)
v_mfma_f32_32x32x16_bf16 v[0:15], v[56:59], v[140:143], v[0:15]
buffer_load_dwordx4 v[116:119], v167, s[8:11], s53 offen offset:1024
buffer_load_dwordx4 v[120:123], v167, s[8:11], s53 offen offset:2048
buffer_load_dwordx4 v[124:127], v167, s[8:11], s53 offen offset:3072
ds_read_b64_tr_b16 v[48:49], v162 offset:28672
ds_read_b64_tr_b16 v[50:51], v162 offset:29696
s_waitcnt lgkmcnt(10)
v_mfma_f32_32x32x16_bf16 v[16:31], v[60:63], v[140:143], v[16:31]
s_add_u32 s50, s50, 57344
s_add_u32 s51, s51, 131072
ds_read_b64_tr_b16 v[52:53], v163 offset:28672
ds_read_b64_tr_b16 v[54:55], v163 offset:29696
s_waitcnt lgkmcnt(10)
v_mfma_f32_32x32x16_bf16 v[0:15], v[32:35], v[144:147], v[0:15]
ds_read_b64_tr_b16 v[56:57], v162 offset:30720
ds_read_b64_tr_b16 v[58:59], v162 offset:31744
s_waitcnt lgkmcnt(10)
v_mfma_f32_32x32x16_bf16 v[16:31], v[36:39], v[144:147], v[16:31]
ds_read_b64_tr_b16 v[60:61], v163 offset:30720
ds_read_b64_tr_b16 v[62:63], v163 offset:31744
s_waitcnt lgkmcnt(10)
v_mfma_f32_32x32x16_bf16 v[0:15], v[40:43], v[148:151], v[0:15]
s_waitcnt vmcnt(12)
s_barrier
ds_read_b64_tr_b16 v[32:33], v162 offset:32768
ds_read_b64_tr_b16 v[34:35], v162 offset:33792
s_waitcnt lgkmcnt(10)
v_mfma_f32_32x32x16_bf16 v[16:31], v[44:47], v[148:151], v[16:31]
ds_read_b64_tr_b16 v[36:37], v163 offset:32768
ds_read_b64_tr_b16 v[38:39], v163 offset:33792
s_waitcnt lgkmcnt(10)
v_mfma_f32_32x32x16_bf16 v[0:15], v[48:51], v[152:155], v[0:15]
ds_read_b64_tr_b16 v[40:41], v162 offset:34816
ds_read_b64_tr_b16 v[42:43], v162 offset:35840
s_waitcnt lgkmcnt(10)
v_mfma_f32_32x32x16_bf16 v[16:31], v[52:55], v[152:155], v[16:31]
ds_read_b64_tr_b16 v[44:45], v163 offset:34816
ds_read_b64_tr_b16 v[46:47], v163 offset:35840
s_waitcnt lgkmcnt(10)
v_mfma_f32_32x32x16_bf16 v[0:15], v[56:59], v[156:159], v[0:15]
ds_read_b64_tr_b16 v[48:49], v162 offset:36864
ds_read_b64_tr_b16 v[50:51], v162 offset:37888
s_waitcnt lgkmcnt(10)
v_mfma_f32_32x32x16_bf16 v[16:31], v[60:63], v[156:159], v[16:31]
ds_read_b64_tr_b16 v[52:53], v163 offset:36864
ds_read_b64_tr_b16 v[54:55], v163 offset:37888
s_waitcnt lgkmcnt(10)
v_mfma_f32_32x32x16_bf16 v[0:15], v[32:35], v[64:67], v[0:15]
ds_read_b64_tr_b16 v[56:57], v162 offset:38912
ds_read_b64_tr_b16 v[58:59], v162 offset:39936
s_waitcnt lgkmcnt(10)
v_mfma_f32_32x32x16_bf16 v[16:31], v[36:39], v[64:67], v[16:31]
ds_read_b64_tr_b16 v[60:61], v163 offset:38912
ds_read_b64_tr_b16 v[62:63], v163 offset:39936
s_waitcnt lgkmcnt(10)
v_mfma_f32_32x32x16_bf16 v[0:15], v[40:43], v[68:71], v[0:15]
ds_read_b64_tr_b16 v[32:33], v162 offset:40960
ds_read_b64_tr_b16 v[34:35], v162 offset:41984
s_waitcnt lgkmcnt(10)
v_mfma_f32_32x32x16_bf16 v[16:31], v[44:47], v[68:71], v[16:31]
ds_read_b64_tr_b16 v[36:37], v163 offset:40960
ds_read_b64_tr_b16 v[38:39], v163 offset:41984
s_waitcnt lgkmcnt(10)
v_mfma_f32_32x32x16_bf16 v[0:15], v[48:51], v[72:75], v[0:15]
ds_read_b64_tr_b16 v[40:41], v162 offset:43008
ds_read_b64_tr_b16 v[42:43], v162 offset:44032
s_waitcnt lgkmcnt(10)
v_mfma_f32_32x32x16_bf16 v[16:31], v[52:55], v[72:75], v[16:31]
ds_read_b64_tr_b16 v[44:45], v163 offset:43008
ds_read_b64_tr_b16 v[46:47], v163 offset:44032
s_waitcnt lgkmcnt(10)
v_mfma_f32_32x32x16_bf16 v[0:15], v[56:59], v[76:79], v[0:15]
ds_read_b64_tr_b16 v[48:49], v162 offset:45056
ds_read_b64_tr_b16 v[50:51], v162 offset:46080
s_waitcnt lgkmcnt(10)
v_mfma_f32_32x32x16_bf16 v[16:31], v[60:63], v[76:79], v[16:31]
ds_read_b64_tr_b16 v[52:53], v163 offset:45056
ds_read_b64_tr_b16 v[54:55], v163 offset:46080
s_waitcnt lgkmcnt(10)
v_mfma_f32_32x32x16_bf16 v[0:15], v[32:35], v[80:83], v[0:15]
ds_read_b64_tr_b16 v[56:57], v162 offset:47104
ds_read_b64_tr_b16 v[58:59], v162 offset:48128
s_waitcnt lgkmcnt(10)
v_mfma_f32_32x32x16_bf16 v[16:31], v[36:39], v[80:83], v[16:31]
ds_read_b64_tr_b16 v[60:61], v163 offset:47104
ds_read_b64_tr_b16 v[62:63], v163 offset:48128
s_waitcnt lgkmcnt(10)
v_mfma_f32_32x32x16_bf16 v[0:15], v[40:43], v[84:87], v[0:15]
s_waitcnt vmcnt(0)
s_barrier
ds_read_b64_tr_b16 v[32:33], v162 offset:49152
ds_read_b64_tr_b16 v[34:35], v162 offset:50176
s_waitcnt lgkmcnt(10)
v_mfma_f32_32x32x16_bf16 v[16:31], v[44:47], v[84:87], v[16:31]
ds_read_b64_tr_b16 v[36:37], v163 offset:49152
ds_read_b64_tr_b16 v[38:39], v163 offset:50176
s_waitcnt lgkmcnt(10)
v_mfma_f32_32x32x16_bf16 v[0:15], v[48:51], v[88:91], v[0:15]
ds_read_b64_tr_b16 v[40:41], v162 offset:51200
ds_read_b64_tr_b16 v[42:43], v162 offset:52224
s_waitcnt lgkmcnt(10)
v_mfma_f32_32x32x16_bf16 v[16:31], v[52:55], v[88:91], v[16:31]
ds_read_b64_tr_b16 v[44:45], v163 offset:51200
ds_read_b64_tr_b16 v[46:47], v163 offset:52224
s_waitcnt lgkmcnt(10)
v_mfma_f32_32x32x16_bf16 v[0:15], v[56:59], v[92:95], v[0:15]
ds_read_b64_tr_b16 v[48:49], v162 offset:53248
ds_read_b64_tr_b16 v[50:51], v162 offset:54272
s_waitcnt lgkmcnt(10)
v_mfma_f32_32x32x16_bf16 v[16:31], v[60:63], v[92:95], v[16:31]
ds_read_b64_tr_b16 v[52:53], v163 offset:53248
ds_read_b64_tr_b16 v[54:55], v163 offset:54272
s_waitcnt lgkmcnt(10)
v_mfma_f32_32x32x16_bf16 v[0:15], v[32:35], v[96:99], v[0:15]
ds_read_b64_tr_b16 v[56:57], v162 offset:55296
ds_read_b64_tr_b16 v[58:59], v162 offset:56320
s_waitcnt lgkmcnt(10)
v_mfma_f32_32x32x16_bf16 v[16:31], v[36:39], v[96:99], v[16:31]
ds_read_b64_tr_b16 v[60:61], v163 offset:55296
ds_read_b64_tr_b16 v[62:63], v163 offset:56320
s_waitcnt lgkmcnt(10)
v_mfma_f32_32x32x16_bf16 v[0:15], v[40:43], v[100:103], v[0:15]
ds_read_b64_tr_b16 v[32:33], v162 offset:57344
ds_read_b64_tr_b16 v[34:35], v162 offset:58368
s_waitcnt lgkmcnt(10)
v_mfma_f32_32x32x16_bf16 v[16:31], v[44:47], v[100:103], v[16:31]
ds_read_b64_tr_b16 v[36:37], v163 offset:57344
ds_read_b64_tr_b16 v[38:39], v163 offset:58368
s_waitcnt lgkmcnt(10)
v_mfma_f32_32x32x16_bf16 v[0:15], v[48:51], v[104:107], v[0:15]
ds_read_b64_tr_b16 v[40:41], v162 offset:59392
ds_read_b64_tr_b16 v[42:43], v162 offset:60416
s_waitcnt lgkmcnt(10)
v_mfma_f32_32x32x16_bf16 v[16:31], v[52:55], v[104:107], v[16:31]
ds_read_b64_tr_b16 v[44:45], v163 offset:59392
ds_read_b64_tr_b16 v[46:47], v163 offset:60416
s_waitcnt lgkmcnt(10)
v_mfma_f32_32x32x16_bf16 v[0:15], v[56:59], v[108:111], v[0:15]
ds_read_b64_tr_b16 v[48:49], v162 offset:61440
ds_read_b64_tr_b16 v[50:51], v162 offset:62464
s_waitcnt lgkmcnt(10)
v_mfma_f32_32x32x16_bf16 v[16:31], v[60:63], v[108:111], v[16:31]
ds_read_b64_tr_b16 v[52:53], v163 offset:61440
ds_read_b64_tr_b16 v[54:55], v163 offset:62464
s_waitcnt lgkmcnt(10)
v_mfma_f32_32x32x16_bf16 v[0:15], v[32:35], v[112:115], v[0:15]
ds_read_b64_tr_b16 v[56:57], v162 offset:63488
ds_read_b64_tr_b16 v[58:59], v162 offset:64512
s_waitcnt lgkmcnt(10)
v_mfma_f32_32x32x16_bf16 v[16:31], v[36:39], v[112:115], v[16:31]
ds_read_b64_tr_b16 v[60:61], v163 offset:63488
ds_read_b64_tr_b16 v[62:63], v163 offset:64512
s_waitcnt lgkmcnt(10)
v_mfma_f32_32x32x16_bf16 v[0:15], v[40:43], v[116:119], v[0:15]
s_waitcnt lgkmcnt(8)
v_mfma_f32_32x32x16_bf16 v[16:31], v[44:47], v[116:119], v[16:31]
s_waitcnt lgkmcnt(6)
v_mfma_f32_32x32x16_bf16 v[0:15], v[48:51], v[120:123], v[0:15]
s_waitcnt lgkmcnt(4)
v_mfma_f32_32x32x16_bf16 v[16:31], v[52:55], v[120:123], v[16:31]
s_waitcnt lgkmcnt(2)
v_mfma_f32_32x32x16_bf16 v[0:15], v[56:59], v[124:127], v[0:15]
s_waitcnt lgkmcnt(0)
v_mfma_f32_32x32x16_bf16 v[16:31], v[60:63], v[124:127], v[16:31]
s_nop 9
v_cvt_pk_bf16_f32 v64, v0, v1
v_cvt_pk_bf16_f32 v65, v2, v3
v_cvt_pk_bf16_f32 v66, v4, v5
v_cvt_pk_bf16_f32 v67, v6, v7
v_cvt_pk_bf16_f32 v68, v8, v9
v_cvt_pk_bf16_f32 v69, v10, v11
v_cvt_pk_bf16_f32 v70, v12, v13
v_cvt_pk_bf16_f32 v71, v14, v15
buffer_store_dwordx4 v[64:67], v164, s[16:19], 0 offen offset:0
buffer_store_dwordx4 v[68:71], v164, s[16:19], 0 offen offset:16
v_cvt_pk_bf16_f32 v72, v16, v17
v_cvt_pk_bf16_f32 v73, v18, v19
v_cvt_pk_bf16_f32 v74, v20, v21
v_cvt_pk_bf16_f32 v75, v22, v23
v_cvt_pk_bf16_f32 v76, v24, v25
v_cvt_pk_bf16_f32 v77, v26, v27
v_cvt_pk_bf16_f32 v78, v28, v29
v_cvt_pk_bf16_f32 v79, v30, v31
buffer_store_dwordx4 v[72:75], v164, s[16:19], 0 offen offset:64
buffer_store_dwordx4 v[76:79], v164, s[16:19], 0 offen offset:80
s_waitcnt vmcnt(0)
K2_EXIT:
s_endpgm
.section .rodata,"a"
.p2align 6
.amdhsa_kernel attn_kernel
  .amdhsa_next_free_vgpr 256
  .amdhsa_next_free_sgpr 102
  .amdhsa_accum_offset 256
  .amdhsa_group_segment_fixed_size 0
  .amdhsa_kernarg_size 104
  .amdhsa_user_sgpr_count 2
  .amdhsa_user_sgpr_kernarg_segment_ptr 1
  .amdhsa_system_sgpr_workgroup_id_x 1
.end_amdhsa_kernel
.p2align 6
.amdhsa_kernel oproj_kernel
  .amdhsa_next_free_vgpr 168
  .amdhsa_next_free_sgpr 102
  .amdhsa_accum_offset 168
  .amdhsa_group_segment_fixed_size 0
  .amdhsa_kernarg_size 104
  .amdhsa_user_sgpr_count 2
  .amdhsa_user_sgpr_kernarg_segment_ptr 1
  .amdhsa_system_sgpr_workgroup_id_x 1
.end_amdhsa_kernel
```
